```python
import torch

def _softmax(x, axis=-1):
    return torch.softmax(x, dim=axis)
def _gelu(x):
    return torch.nn.functional.gelu(x, approximate="tanh")
def _silu(x):
    return torch.nn.functional.silu(x)
def _sigmoid(x):
    return torch.sigmoid(x)
def _layernorm(x, axis=-1, eps=1e-5):
    m = x.mean(dim=axis, keepdim=True)
    v = x.var(dim=axis, keepdim=True, unbiased=False)
    return (x - m) / torch.sqrt(v + eps)
def _scatter_add(tgt, idx, src, axis=0):
    return tgt.clone().index_add_(axis, idx, src)
def _segment_sum(src, seg, n):
    out = torch.zeros((n,) + src.shape[1:], dtype=src.dtype)
    return out.index_add_(0, seg, src)
def _pad(x, pw):
    flat = tuple(v for pair in reversed(pw) for v in pair)
    return torch.nn.functional.pad(x, flat)

kernel_name = 'recurrent_scan__spectral_fnet__dense_activation_gelu__prompt'

def setup_inputs():

    _w = (lambda a: (lambda t: t.to(torch.bfloat16) if t.is_floating_point() else t)(torch.as_tensor(a)))
    def _A_setup():
        B, S, D = 1, 2048, 1024
        ns = torch.arange(S)[:, None] * torch.arange(S)[None, :]
        nd = torch.arange(D)[:, None] * torch.arange(D)[None, :]
        Ws_re = torch.cos(-2.0 * torch.pi * ns / S).to(float)
        Ws_im = torch.sin(-2.0 * torch.pi * ns / S).to(float)
        Wd_re = torch.cos(-2.0 * torch.pi * nd / D).to(float)
        Wd_im = torch.sin(-2.0 * torch.pi * nd / D).to(float)
        return {
            "x": _w((lambda *s: torch.randn(*s, dtype=torch.bfloat16) * 0.05)(B, S, D)),
            "dft_seq_re": _w(Ws_re),
            "dft_seq_im": _w(Ws_im),
            "dft_hid_re": _w(Wd_re),
            "dft_hid_im": _w(Wd_im),
        }
    _A_in = _A_setup()

    def _B_setup():
        B, S, D, F = 1, 2048, 1024, 3584
        return {
            "x": _w((lambda *s: torch.randn(*s, dtype=torch.bfloat16) * 0.05)(B, S, D)),
            "w1": _w((lambda *s: torch.randn(*s, dtype=torch.bfloat16) * 0.2)(D, F) * (D ** -0.5)),
            "b1": _w((lambda *s: torch.randn(*s, dtype=torch.bfloat16) * 3.2)(F) * 0.01),
            "w2": _w((lambda *s: torch.randn(*s, dtype=torch.bfloat16) * 0.05)(F, D) * (F ** -0.5)),
            "b2": _w((lambda *s: torch.randn(*s, dtype=torch.bfloat16) * 0.1)(D) * 0.01),
        }
    _B_in = _B_setup()

    return {
        "A_x": _A_in["x"],
        "A_dft_seq_re": _A_in["dft_seq_re"],
        "A_dft_seq_im": _A_in["dft_seq_im"],
        "A_dft_hid_re": _A_in["dft_hid_re"],
        "A_dft_hid_im": _A_in["dft_hid_im"],
        "B_x": _B_in["x"],
        "B_w1": _B_in["w1"],
        "B_b1": _B_in["b1"],
        "B_w2": _B_in["w2"],
        "B_b2": _B_in["b2"],
    }

def reference(A_x, A_dft_seq_re, A_dft_seq_im, A_dft_hid_re, A_dft_hid_im, B_x, B_w1, B_b1, B_w2, B_b2):
    def _A_ref(x, dft_seq_re, dft_seq_im, dft_hid_re, dft_hid_im):
        a = torch.einsum("bsd,ed->bse", x, dft_hid_re)
        b = torch.einsum("bsd,ed->bse", x, dft_hid_im)
        y = torch.einsum("ts,bse->bte", dft_seq_re, a) - torch.einsum("ts,bse->bte", dft_seq_im, b)
        return y

    def _B_ref(x, w1, b1, w2, b2):
        h = torch.einsum("bsd,df->bsf", x, w1) + b1
        h = _gelu(h)
        return torch.einsum("bsf,fd->bsd", h, w2) + b2

    x = A_x
    xn = _layernorm(x, axis=-1)
    s = _A_ref(xn, A_dft_seq_re, A_dft_seq_im, A_dft_hid_re, A_dft_hid_im)
    g = _silu(_B_ref(xn, B_w1, B_b1, B_w2, B_b2))
    return x + s * g
```

```asm
; @launch kernel=kf_kernel grid=(256,1,1) block=(512,1,1) lds=139264
.amdgcn_target "amdgcn-amd-amdhsa--gfx950"
.text
.globl kf_kernel
.p2align 8
.type kf_kernel,@function
kf_kernel:
    s_cmp_ge_u32 s2, 256
    s_cbranch_scc1 kf_end
    s_load_dwordx16 s[16:31], s[0:1], 0
    s_load_dwordx8 s[32:39], s[0:1], 64
    s_load_dwordx2 s[40:41], s[0:1], 96
    v_and_b32 v1, 63, v0
    v_lshrrev_b32 v2, 6, v0
    s_nop 0
    v_readfirstlane_b32 s3, v2
    s_and_b32 s73, s2, 7
    s_lshr_b32 s87, s2, 3
    s_lshr_b32 s74, s87, 1
    s_and_b32 s75, s87, 1
    s_and_b32 s88, s73, 1
    s_lshl_b32 s88, s88, 2
    s_and_b32 s89, s74, 3
    s_add_u32 s83, s88, s89
    s_lshr_b32 s88, s73, 1
    s_lshl_b32 s88, s88, 2
    s_lshr_b32 s89, s74, 2
    s_add_u32 s84, s88, s89
    s_mov_b32 s70, s83
    s_mov_b32 s71, s84
    s_and_b32 s83, s74, 7
    s_lshr_b32 s88, s74, 3
    s_lshl_b32 s89, s73, 1
    s_add_u32 s84, s88, s89
    s_lshl_b32 s77, s71, 3
    s_add_u32 s77, s77, s70
    s_lshr_b32 s72, s3, 2
    s_and_b32 s76, s3, 3
    s_lshl_b32 s69, s3, 12
    s_mov_b32 s80, 0
    s_lshl_b32 s86, s83, 4
    s_lshl_b32 s87, s3, 1
    s_add_u32 s86, s86, s87
    s_lshl_b32 s86, s86, 15
    v_lshlrev_b32 v8, 4, v1
    v_add_u32 v8, s86, v8
    v_add_u32 v9, 32768, v8
    s_lshl_b32 s86, s2, 3
    s_add_u32 s86, s86, s3
    s_lshl_b32 s87, s86, 12
    s_lshl_b32 s86, s86, 7
    v_lshlrev_b32 v13, 7, v1
    v_add_u32 v13, s87, v13
    v_lshlrev_b32 v14, 18, v1
    v_add_u32 v14, s86, v14
    v_mov_b32 v2, 0x80000000
    s_mov_b32 vcc_lo, 0xffffffff
    s_mov_b32 vcc_hi, 0
    s_nop 0
    v_cndmask_b32 v13, v2, v13, vcc
    s_mov_b32 vcc_lo, 0xfffffff
    s_nop 0
    v_cndmask_b32 v14, v2, v14, vcc
    s_waitcnt lgkmcnt(0)
    s_mov_b32 s4, s40
    s_mov_b32 s5, s41
    s_mov_b32 s6, 4194304
    s_mov_b32 s7, 0x20000
    s_add_u32 s48, s40, 54525952
    s_addc_u32 s49, s41, 0
    s_mov_b32 s50, 32768
    s_mov_b32 s51, 0x20000
    s_mov_b32 s8, s16
    s_mov_b32 s9, s17
    s_mov_b32 s10, 4194304
    s_mov_b32 s11, 0x20000
    s_mov_b32 s12, s38
    s_mov_b32 s13, s39
    s_mov_b32 s14, 256
    s_mov_b32 s15, 0x20000
    s_lshl_b32 s86, s75, 4
    s_add_u32 s79, s86, s84
    s_lshl_b32 s86, s83, 5
    s_add_u32 s86, s86, s79
    s_lshl_b32 s86, s86, 3
    s_add_u32 s86, s86, s3
    s_lshl_b32 s87, s86, 11
    v_lshlrev_b32 v40, 4, v1
    buffer_load_dwordx4 v[48:51], v40, s[8:11], s87 offen
    buffer_load_dwordx4 v[52:55], v40, s[8:11], s87 offen offset:1024
    v_mov_b32 v44, 0
    s_lshl_b32 s87, s83, 8
    s_lshl_b32 s88, s79, 3
    s_add_u32 s60, s87, s88
    s_or_b32 s87, s2, s3
    s_cmp_lg_u32 s87, 0
    s_cbranch_scc1 kf_notok
    s_memrealtime s[88:89]
    s_waitcnt lgkmcnt(0)
    s_or_b32 s88, s88, 1
    s_xor_b32 s89, s89, 0x5bd1e995
    v_mov_b32 v42, s88
    v_mov_b32 v43, s89
    s_mov_b64 exec, 1
    buffer_store_dwordx2 v[42:43], v44, s[12:15], 0 offen sc1
    s_mov_b64 exec, -1
    s_waitcnt vmcnt(0)
kf_notok:
    s_lshr_b32 s87, s86, 4
    s_lshl_b32 s87, s87, 15
    s_and_b32 s88, s86, 8
    s_lshl_b32 s88, s88, 4
    s_add_u32 s61, s87, s88
    s_lshl_b32 s87, s3, 12
    s_add_u32 s61, s61, s87
    v_lshrrev_b32 v45, 5, v1
    v_lshlrev_b32 v45, 10, v45
    v_bfe_u32 v46, v1, 3, 2
    v_lshl_add_u32 v45, v46, 8, v45
    v_and_b32 v46, 7, v1
    v_lshl_add_u32 v45, v46, 4, v45
    s_lshl_b32 s87, s3, 4
    s_add_u32 s87, s87, 98304
    v_lshlrev_b32 v46, 7, v1
    v_add_u32 v46, s87, v46
    s_lshl_b32 s87, s3, 11
    s_add_u32 s87, s87, 98304
    v_add_u32 v47, s87, v40
    s_cmp_eq_u32 s75, 1
    s_cbranch_scc1 kf_typeO
    s_mov_b32 s68, 0
    s_cmp_eq_u32 s72, 0
    s_cselect_b32 s64, s18, s20
    s_cselect_b32 s65, s19, s21
    s_mov_b32 s66, 8388608
    s_mov_b32 s67, 0x20000
    v_lshrrev_b32 v2, 4, v1
    v_and_b32 v3, 7, v1
    v_xor_b32 v2, v2, v3
    v_lshlrev_b32 v2, 4, v2
    v_lshrrev_b32 v3, 3, v1
    v_mul_u32_u24 v3, 4096, v3
    v_add_u32 v5, v2, v3
    s_lshl_b32 s86, s76, 5
    s_lshl_b32 s87, s72, 6
    s_xor_b32 s86, s86, s87
    s_lshl_b32 s87, s71, 7
    s_add_u32 s86, s86, s87
    s_lshl_b32 s86, s86, 12
    v_add_u32 v28, s86, v5
    v_xor_b32 v29, 64, v28
    v_add_u32 v29, 32768, v29
    v_add_u32 v30, 65536, v28
    v_add_u32 v31, 65536, v29
    s_cmp_lt_u32 s84, 8
    s_cselect_b32 s44, s22, s24
    s_cselect_b32 s45, s23, s25
    s_mov_b32 s46, 2097152
    s_mov_b32 s47, 0x20000
    s_mov_b32 s52, s28
    s_mov_b32 s53, s29
    s_mov_b32 s54, 7340032
    s_mov_b32 s55, 0x20000
    s_mov_b32 s56, 0
    s_mov_b32 s57, 0
    s_lshl_b32 s81, s3, 11
    s_lshl_b32 s58, s3, 10
    s_add_u32 s58, s58, 16384
    v_lshrrev_b32 v2, 4, v1
    v_and_b32 v3, 7, v1
    v_xor_b32 v2, v2, v3
    v_lshlrev_b32 v2, 4, v2
    v_lshrrev_b32 v3, 3, v1
    v_mul_u32_u24 v3, 2048, v3
    v_add_u32 v5, v2, v3
    s_and_b32 s86, s84, 7
    s_lshl_b32 s86, s86, 7
    s_lshl_b32 s87, s3, 4
    s_add_u32 s86, s86, s87
    s_lshl_b32 s86, s86, 11
    v_add_u32 v10, s86, v5
    v_xor_b32 v11, 64, v10
    v_add_u32 v11, 16384, v11
    s_mul_i32 s85, s84, 32
    s_mov_b32 s12, s30
    s_mov_b32 s13, s31
    s_mov_b32 s14, 7168
    s_mov_b32 s15, 0x20000
    v_lshlrev_b32 v2, 4, v1
    s_lshl_b32 s86, s85, 1
    s_lshl_b32 s87, s3, 10
    s_add_u32 m0, s87, 131072
    s_nop 0
    buffer_load_dwordx4 v2, s[12:15], s86 offen lds
    v_bfe_u32 v2, v1, 4, 1
    v_lshlrev_b32 v2, 1, v2
    v_and_b32 v3, 7, v1
    v_xor_b32 v2, v2, v3
    v_lshlrev_b32 v2, 4, v2
    v_lshrrev_b32 v3, 3, v1
    v_mul_u32_u24 v3, 7168, v3
    v_add_u32 v5, v2, v3
    s_and_b32 s88, s3, 1
    s_lshl_b32 s88, s88, 6
    s_mul_i32 s86, s3, 57344
    s_lshl_b32 s87, s85, 1
    s_add_u32 s86, s86, s87
    v_xor_b32 v5, s88, v5
    v_and_b32 v2, 64, v5
    v_add_u32 v5, s86, v5
    v_cmp_eq_u32 vcc, 0, v2
    v_mov_b32 v4, 0x80000000
    s_nop 0
    v_cndmask_b32 v12, v4, v5, vcc
    v_and_b32 v2, 15, v1
    v_lshrrev_b32 v3, 1, v2
    v_lshrrev_b32 v16, 4, v1
    v_xor_b32 v3, v3, v16
    v_lshlrev_b32 v3, 4, v3
    v_lshl_add_u32 v16, v2, 7, v3
    v_xor_b32 v17, 64, v16
    v_lshrrev_b32 v2, 4, v1
    v_bfe_u32 v3, v1, 2, 2
    v_lshl_add_u32 v4, v2, 3, v3
    v_mul_u32_u24 v4, 128, v4
    v_and_b32 v2, 1, v2
    v_lshlrev_b32 v2, 1, v2
    v_lshrrev_b32 v3, 1, v3
    v_or_b32 v2, v2, v3
    v_lshlrev_b32 v2, 5, v2
    v_bfe_u32 v3, v1, 1, 1
    v_lshlrev_b32 v3, 4, v3
    v_or_b32 v2, v2, v3
    v_and_b32 v3, 1, v1
    v_lshl_add_u32 v4, v3, 3, v4
    v_xor_b32 v3, 0, v2
    v_add_u32 v20, v3, v4
    v_xor_b32 v3, 32, v2
    v_add_u32 v21, v3, v4
    v_xor_b32 v3, 64, v2
    v_add_u32 v22, v3, v4
    v_xor_b32 v3, 96, v2
    v_add_u32 v23, v3, v4
    v_and_b32 v2, 15, v1
    v_lshrrev_b32 v3, 1, v2
    v_lshrrev_b32 v18, 4, v1
    v_xor_b32 v3, v3, v18
    v_lshlrev_b32 v3, 4, v3
    v_lshl_add_u32 v18, v2, 7, v3
    v_add_u32 v18, 65536, v18
    v_xor_b32 v19, 64, v18
    v_lshrrev_b32 v2, 4, v1
    v_bfe_u32 v3, v1, 2, 2
    v_lshl_add_u32 v4, v2, 3, v3
    v_mul_u32_u24 v4, 128, v4
    v_and_b32 v2, 1, v2
    v_lshlrev_b32 v2, 1, v2
    v_lshrrev_b32 v3, 1, v3
    v_or_b32 v2, v2, v3
    v_lshlrev_b32 v2, 5, v2
    v_bfe_u32 v3, v1, 1, 1
    v_lshlrev_b32 v3, 4, v3
    v_or_b32 v2, v2, v3
    v_and_b32 v3, 1, v1
    v_lshl_add_u32 v4, v3, 3, v4
    v_add_u32 v4, 65536, v4
    v_xor_b32 v3, 0, v2
    v_add_u32 v24, v3, v4
    v_xor_b32 v3, 32, v2
    v_add_u32 v25, v3, v4
    v_xor_b32 v3, 64, v2
    v_add_u32 v26, v3, v4
    v_xor_b32 v3, 96, v2
    v_add_u32 v27, v3, v4
    s_add_u32 m0, s81, 0
    s_nop 0
    buffer_load_dwordx4 v10, s[44:47], s56 offen nt lds
    s_add_u32 m0, s81, 1024
    s_nop 0
    buffer_load_dwordx4 v11, s[44:47], s56 offen nt lds
    s_add_u32 m0, s58, 0
    s_nop 0
    buffer_load_dwordx4 v12, s[52:55], s57 offen nt lds
    s_add_u32 s56, s56, 128
    s_add_u32 m0, s81, 24576
    s_nop 0
    buffer_load_dwordx4 v10, s[44:47], s56 offen nt lds
    s_add_u32 m0, s81, 25600
    s_nop 0
    buffer_load_dwordx4 v11, s[44:47], s56 offen nt lds
    s_add_u32 s57, s57, 458752
    s_add_u32 m0, s58, 24576
    s_nop 0
    buffer_load_dwordx4 v12, s[52:55], s57 offen nt lds
    s_add_u32 s56, s56, 128
    s_add_u32 m0, s81, 49152
    s_nop 0
    buffer_load_dwordx4 v10, s[44:47], s56 offen nt lds
    s_add_u32 m0, s81, 50176
    s_nop 0
    buffer_load_dwordx4 v11, s[44:47], s56 offen nt lds
    s_add_u32 s57, s57, 458752
    s_add_u32 m0, s58, 49152
    s_nop 0
    buffer_load_dwordx4 v12, s[52:55], s57 offen nt lds
    s_add_u32 s56, s56, 128
    s_add_u32 m0, s81, 73728
    s_nop 0
    buffer_load_dwordx4 v10, s[44:47], s56 offen nt lds
    s_add_u32 m0, s81, 74752
    s_nop 0
    buffer_load_dwordx4 v11, s[44:47], s56 offen nt lds
    s_add_u32 s57, s57, 458752
    s_add_u32 m0, s58, 73728
    s_nop 0
    buffer_load_dwordx4 v12, s[52:55], s57 offen nt lds
    s_waitcnt vmcnt(14)
    v_lshlrev_b32 v56, 16, v48
    v_and_b32 v57, 0xffff0000, v48
    v_lshlrev_b32 v58, 16, v49
    v_and_b32 v59, 0xffff0000, v49
    v_lshlrev_b32 v60, 16, v50
    v_and_b32 v61, 0xffff0000, v50
    v_lshlrev_b32 v62, 16, v51
    v_and_b32 v63, 0xffff0000, v51
    s_waitcnt vmcnt(13)
    v_lshlrev_b32 v64, 16, v52
    v_and_b32 v65, 0xffff0000, v52
    v_lshlrev_b32 v66, 16, v53
    v_and_b32 v67, 0xffff0000, v53
    v_lshlrev_b32 v68, 16, v54
    v_and_b32 v69, 0xffff0000, v54
    v_lshlrev_b32 v70, 16, v55
    v_and_b32 v71, 0xffff0000, v55
    v_add_f32 v72, v56, v57
    v_add_f32 v73, v58, v59
    v_add_f32 v74, v60, v61
    v_add_f32 v75, v62, v63
    v_add_f32 v76, v64, v65
    v_add_f32 v77, v66, v67
    v_add_f32 v78, v68, v69
    v_add_f32 v79, v70, v71
    v_add_f32 v72, v72, v76
    v_add_f32 v73, v73, v77
    v_add_f32 v74, v74, v78
    v_add_f32 v75, v75, v79
    v_add_f32 v72, v72, v74
    v_add_f32 v73, v73, v75
    v_add_f32 v72, v72, v73
    s_nop 1
    v_add_f32_dpp v73, v72, v72 quad_perm:[1,0,3,2] row_mask:0xf bank_mask:0xf
    v_mov_b32 v72, v73
    s_nop 1
    v_add_f32_dpp v73, v72, v72 quad_perm:[2,3,0,1] row_mask:0xf bank_mask:0xf
    v_mov_b32 v72, v73
    s_nop 1
    v_add_f32_dpp v73, v72, v72 row_half_mirror row_mask:0xf bank_mask:0xf
    v_mov_b32 v72, v73
    s_nop 1
    v_add_f32_dpp v73, v72, v72 row_mirror row_mask:0xf bank_mask:0xf
    v_mov_b32 v72, v73
    s_nop 0
    v_readlane_b32 s86, v72, 0
    v_readlane_b32 s87, v72, 16
    v_readlane_b32 s88, v72, 32
    v_readlane_b32 s89, v72, 48
    s_nop 1
    v_mov_b32 v72, s86
    v_add_f32 v72, s87, v72
    v_add_f32 v72, s88, v72
    v_add_f32 v72, s89, v72
    v_mul_f32 v72, 0x3a800000, v72
    v_sub_f32 v84, v56, v72
    v_sub_f32 v85, v57, v72
    v_sub_f32 v86, v58, v72
    v_sub_f32 v87, v59, v72
    v_sub_f32 v88, v60, v72
    v_sub_f32 v89, v61, v72
    v_sub_f32 v90, v62, v72
    v_sub_f32 v91, v63, v72
    v_sub_f32 v92, v64, v72
    v_sub_f32 v93, v65, v72
    v_sub_f32 v94, v66, v72
    v_sub_f32 v95, v67, v72
    v_sub_f32 v96, v68, v72
    v_sub_f32 v97, v69, v72
    v_sub_f32 v98, v70, v72
    v_sub_f32 v99, v71, v72
    v_mul_f32 v74, v84, v84
    v_fmac_f32 v74, v85, v85
    v_mul_f32 v75, v86, v86
    v_fmac_f32 v75, v87, v87
    v_mul_f32 v76, v88, v88
    v_fmac_f32 v76, v89, v89
    v_mul_f32 v77, v90, v90
    v_fmac_f32 v77, v91, v91
    v_mul_f32 v78, v92, v92
    v_fmac_f32 v78, v93, v93
    v_mul_f32 v79, v94, v94
    v_fmac_f32 v79, v95, v95
    v_mul_f32 v80, v96, v96
    v_fmac_f32 v80, v97, v97
    v_mul_f32 v81, v98, v98
    v_fmac_f32 v81, v99, v99
    v_add_f32 v74, v74, v78
    v_add_f32 v75, v75, v79
    v_add_f32 v76, v76, v80
    v_add_f32 v77, v77, v81
    v_add_f32 v74, v74, v76
    v_add_f32 v75, v75, v77
    v_add_f32 v74, v74, v75
    s_nop 1
    v_add_f32_dpp v75, v74, v74 quad_perm:[1,0,3,2] row_mask:0xf bank_mask:0xf
    v_mov_b32 v74, v75
    s_nop 1
    v_add_f32_dpp v75, v74, v74 quad_perm:[2,3,0,1] row_mask:0xf bank_mask:0xf
    v_mov_b32 v74, v75
    s_nop 1
    v_add_f32_dpp v75, v74, v74 row_half_mirror row_mask:0xf bank_mask:0xf
    v_mov_b32 v74, v75
    s_nop 1
    v_add_f32_dpp v75, v74, v74 row_mirror row_mask:0xf bank_mask:0xf
    v_mov_b32 v74, v75
    s_nop 0
    v_readlane_b32 s86, v74, 0
    v_readlane_b32 s87, v74, 16
    v_readlane_b32 s88, v74, 32
    v_readlane_b32 s89, v74, 48
    s_nop 1
    v_mov_b32 v74, s86
    v_add_f32 v74, s87, v74
    v_add_f32 v74, s88, v74
    v_add_f32 v74, s89, v74
    v_mul_f32 v74, 0x3a800000, v74
    v_cvt_pk_bf16_f32 v75, v72, v74
    v_lshlrev_b32 v72, 16, v75
    v_and_b32 v74, 0xffff0000, v75
    v_add_f32 v74, 0x3727c5ac, v74
    v_cvt_pk_bf16_f32 v74, v74, v74
    v_lshlrev_b32 v74, 16, v74
    v_sqrt_f32 v74, v74
    s_nop 0
    v_cvt_pk_bf16_f32 v74, v74, v74
    v_lshlrev_b32 v74, 16, v74
    v_rcp_f32 v75, v74
    v_sub_f32 v56, v56, v72
    v_sub_f32 v57, v57, v72
    v_sub_f32 v58, v58, v72
    v_sub_f32 v59, v59, v72
    v_sub_f32 v60, v60, v72
    v_sub_f32 v61, v61, v72
    v_sub_f32 v62, v62, v72
    v_sub_f32 v63, v63, v72
    v_sub_f32 v64, v64, v72
    v_sub_f32 v65, v65, v72
    v_sub_f32 v66, v66, v72
    v_sub_f32 v67, v67, v72
    v_sub_f32 v68, v68, v72
    v_sub_f32 v69, v69, v72
    v_sub_f32 v70, v70, v72
    v_sub_f32 v71, v71, v72
    v_cvt_pk_bf16_f32 v48, v56, v57
    v_cvt_pk_bf16_f32 v49, v58, v59
    v_cvt_pk_bf16_f32 v50, v60, v61
    v_cvt_pk_bf16_f32 v51, v62, v63
    v_cvt_pk_bf16_f32 v52, v64, v65
    v_cvt_pk_bf16_f32 v53, v66, v67
    v_cvt_pk_bf16_f32 v54, v68, v69
    v_cvt_pk_bf16_f32 v55, v70, v71
    v_lshlrev_b32 v56, 16, v48
    v_and_b32 v57, 0xffff0000, v48
    v_lshlrev_b32 v58, 16, v49
    v_and_b32 v59, 0xffff0000, v49
    v_lshlrev_b32 v60, 16, v50
    v_and_b32 v61, 0xffff0000, v50
    v_lshlrev_b32 v62, 16, v51
    v_and_b32 v63, 0xffff0000, v51
    v_lshlrev_b32 v64, 16, v52
    v_and_b32 v65, 0xffff0000, v52
    v_lshlrev_b32 v66, 16, v53
    v_and_b32 v67, 0xffff0000, v53
    v_lshlrev_b32 v68, 16, v54
    v_and_b32 v69, 0xffff0000, v54
    v_lshlrev_b32 v70, 16, v55
    v_and_b32 v71, 0xffff0000, v55
    v_mul_f32 v84, v56, v75
    v_mul_f32 v85, v57, v75
    v_mul_f32 v86, v58, v75
    v_mul_f32 v87, v59, v75
    v_mul_f32 v88, v60, v75
    v_mul_f32 v89, v61, v75
    v_mul_f32 v90, v62, v75
    v_mul_f32 v91, v63, v75
    v_mul_f32 v92, v64, v75
    v_mul_f32 v93, v65, v75
    v_mul_f32 v94, v66, v75
    v_mul_f32 v95, v67, v75
    v_mul_f32 v96, v68, v75
    v_mul_f32 v97, v69, v75
    v_mul_f32 v98, v70, v75
    v_mul_f32 v99, v71, v75
    v_fma_f32 v56, -v84, v74, v56
    v_fma_f32 v57, -v85, v74, v57
    v_fma_f32 v58, -v86, v74, v58
    v_fma_f32 v59, -v87, v74, v59
    v_fma_f32 v60, -v88, v74, v60
    v_fma_f32 v61, -v89, v74, v61
    v_fma_f32 v62, -v90, v74, v62
    v_fma_f32 v63, -v91, v74, v63
    v_fma_f32 v64, -v92, v74, v64
    v_fma_f32 v65, -v93, v74, v65
    v_fma_f32 v66, -v94, v74, v66
    v_fma_f32 v67, -v95, v74, v67
    v_fma_f32 v68, -v96, v74, v68
    v_fma_f32 v69, -v97, v74, v69
    v_fma_f32 v70, -v98, v74, v70
    v_fma_f32 v71, -v99, v74, v71
    v_fmac_f32 v84, v56, v75
    v_fmac_f32 v85, v57, v75
    v_fmac_f32 v86, v58, v75
    v_fmac_f32 v87, v59, v75
    v_fmac_f32 v88, v60, v75
    v_fmac_f32 v89, v61, v75
    v_fmac_f32 v90, v62, v75
    v_fmac_f32 v91, v63, v75
    v_fmac_f32 v92, v64, v75
    v_fmac_f32 v93, v65, v75
    v_fmac_f32 v94, v66, v75
    v_fmac_f32 v95, v67, v75
    v_fmac_f32 v96, v68, v75
    v_fmac_f32 v97, v69, v75
    v_fmac_f32 v98, v70, v75
    v_fmac_f32 v99, v71, v75
    v_cvt_pk_bf16_f32 v48, v84, v85
    v_cvt_pk_bf16_f32 v49, v86, v87
    v_cvt_pk_bf16_f32 v50, v88, v89
    v_cvt_pk_bf16_f32 v51, v90, v91
    v_cvt_pk_bf16_f32 v52, v92, v93
    v_cvt_pk_bf16_f32 v53, v94, v95
    v_cvt_pk_bf16_f32 v54, v96, v97
    v_cvt_pk_bf16_f32 v55, v98, v99
    ds_write_b128 v46, v[48:51]
    ds_write_b128 v46, v[52:55] offset:8192
    s_mov_b32 s12, s38
    s_mov_b32 s13, s39
    s_mov_b32 s14, 256
    s_mov_b32 s15, 0x20000
    buffer_load_dwordx2 v[42:43], v44, s[12:15], 0 offen sc1
    s_waitcnt lgkmcnt(0)
    s_barrier
    ds_read_b128 v[48:51], v47
    ds_read_b128 v[52:55], v47 offset:1024
    s_waitcnt lgkmcnt(0)
    buffer_store_dwordx4 v[48:51], v45, s[4:7], s61 offen sc1
    buffer_store_dwordx4 v[52:55], v45, s[4:7], s61 offen offset:2048 sc1
    s_waitcnt vmcnt(0)
    s_barrier
    s_cmp_lg_u32 s3, 0
    s_cbranch_scc1 kfxy_w
    v_readfirstlane_b32 s78, v42
    v_readfirstlane_b32 s79, v43
    s_cmp_lg_u32 s78, 0
    s_cbranch_scc1 kfxy_t2
    s_mov_b32 s12, s38
    s_mov_b32 s13, s39
    s_mov_b32 s14, 256
    s_mov_b32 s15, 0x20000
    v_mov_b32 v2, 0
    s_mov_b32 s93, 400000
kfxy_t:
    buffer_load_dwordx2 v[4:5], v2, s[12:15], 0 offen sc1
    s_waitcnt vmcnt(0)
    v_readfirstlane_b32 s78, v4
    v_readfirstlane_b32 s79, v5
    s_cmp_lg_u32 s78, 0
    s_cbranch_scc1 kfxy_t2
    s_sleep 1
    s_sub_u32 s93, s93, 1
    s_cmp_lg_u32 s93, 0
    s_cbranch_scc1 kfxy_t
kfxy_t2:
    v_mov_b32 v4, s78
    v_mov_b32 v5, s79
    v_mov_b32 v2, s60
    s_mov_b64 exec, 1
    buffer_store_dwordx2 v[4:5], v2, s[48:51], 0 offen sc1
    s_mov_b64 exec, -1
    v_and_b32 v2, 31, v1
    v_lshlrev_b32 v2, 3, v2
    s_lshl_b32 s86, s83, 8
    v_add_u32 v2, s86, v2
    s_mov_b32 s93, 400000
kfxy_p:
    buffer_load_dwordx2 v[4:5], v2, s[48:51], 0 offen sc1
    s_waitcnt vmcnt(0)
    v_cmp_ne_u64 vcc, s[78:79], v[4:5]
    s_cbranch_vccz kfxy_w
    s_sleep 1
    s_sub_u32 s93, s93, 1
    s_cmp_lg_u32 s93, 0
    s_cbranch_scc1 kfxy_p
kfxy_w:
    s_barrier
    buffer_load_dwordx4 v[192:195], v8, s[4:7], s80 offen offset:0 sc1
    buffer_load_dwordx4 v[196:199], v9, s[4:7], s80 offen offset:0 sc1
    buffer_load_dwordx4 v[200:203], v8, s[4:7], s80 offen offset:1024 sc1
    buffer_load_dwordx4 v[204:207], v9, s[4:7], s80 offen offset:1024 sc1
    buffer_load_dwordx4 v[208:211], v8, s[4:7], s80 offen offset:2048 sc1
    buffer_load_dwordx4 v[212:215], v9, s[4:7], s80 offen offset:2048 sc1
    buffer_load_dwordx4 v[216:219], v8, s[4:7], s80 offen offset:3072 sc1
    buffer_load_dwordx4 v[220:223], v9, s[4:7], s80 offen offset:3072 sc1
    s_add_u32 s80, s80, 4096
    s_nop 0
    buffer_load_dwordx4 a[0:3], v8, s[4:7], s80 offen offset:0 sc1
    buffer_load_dwordx4 a[4:7], v9, s[4:7], s80 offen offset:0 sc1
    buffer_load_dwordx4 a[8:11], v8, s[4:7], s80 offen offset:1024 sc1
    buffer_load_dwordx4 a[12:15], v9, s[4:7], s80 offen offset:1024 sc1
    s_waitcnt vmcnt(21)
    s_barrier
    buffer_load_dwordx4 a[16:19], v8, s[4:7], s80 offen offset:2048 sc1
    s_add_u32 s56, s56, 128
    s_add_u32 m0, s81, 98304
    s_nop 0
    buffer_load_dwordx4 v10, s[44:47], s56 offen nt lds
    buffer_load_dwordx4 a[20:23], v9, s[4:7], s80 offen offset:2048 sc1
    s_add_u32 m0, s81, 99328
    s_nop 0
    buffer_load_dwordx4 v11, s[44:47], s56 offen nt lds
    ds_read_b128 v[112:115], v16 offset:0
    ds_read_b128 v[116:119], v16 offset:2048
    ds_read_b128 v[120:123], v16 offset:4096
    ds_read_b128 v[124:127], v16 offset:6144
    ds_read_b128 v[128:131], v16 offset:8192
    ds_read_b128 v[132:135], v16 offset:10240
    ds_read_b128 v[136:139], v16 offset:12288
    ds_read_b128 v[140:143], v16 offset:14336
    ds_read_b64_tr_b16 v[144:145], v20 offset:16384
    ds_read_b64_tr_b16 v[146:147], v20 offset:16896
    ds_read_b64_tr_b16 v[148:149], v21 offset:16384
    ds_read_b64_tr_b16 v[150:151], v21 offset:16896
    s_waitcnt vmcnt(14) lgkmcnt(0)
    v_mfma_f32_16x16x32_bf16 v[32:35], v[192:195], v[112:115], 0
    ds_read_b128 v[152:155], v17 offset:0
    v_mfma_f32_16x16x32_bf16 v[36:39], v[196:199], v[112:115], 0
    ds_read_b128 v[156:159], v17 offset:2048
    v_mfma_f32_16x16x32_bf16 v[40:43], v[192:195], v[116:119], 0
    ds_read_b128 v[160:163], v17 offset:4096
    v_mfma_f32_16x16x32_bf16 v[44:47], v[196:199], v[116:119], 0
    ds_read_b128 v[164:167], v17 offset:6144
    v_mfma_f32_16x16x32_bf16 v[48:51], v[192:195], v[120:123], 0
    ds_read_b128 v[168:171], v17 offset:8192
    buffer_load_dwordx4 a[24:27], v8, s[4:7], s80 offen offset:3072 sc1
    v_mfma_f32_16x16x32_bf16 v[52:55], v[196:199], v[120:123], 0
    ds_read_b128 v[172:175], v17 offset:10240
    v_mfma_f32_16x16x32_bf16 v[56:59], v[192:195], v[124:127], 0
    v_mfma_f32_16x16x32_bf16 v[60:63], v[196:199], v[124:127], 0
    ds_read_b128 v[176:179], v17 offset:12288
    v_mfma_f32_16x16x32_bf16 v[64:67], v[192:195], v[128:131], 0
    ds_read_b128 v[180:183], v17 offset:14336
    v_mfma_f32_16x16x32_bf16 v[68:71], v[196:199], v[128:131], 0
    ds_read_b64_tr_b16 v[184:185], v20 offset:20480
    s_add_u32 s57, s57, 458752
    s_add_u32 m0, s58, 98304
    v_mfma_f32_16x16x32_bf16 v[72:75], v[192:195], v[132:135], 0
    ds_read_b64_tr_b16 v[186:187], v20 offset:20992
    buffer_load_dwordx4 v12, s[52:55], s57 offen nt lds
    v_mfma_f32_16x16x32_bf16 v[76:79], v[196:199], v[132:135], 0
    ds_read_b64_tr_b16 v[188:189], v21 offset:20480
    v_mfma_f32_16x16x32_bf16 v[80:83], v[192:195], v[136:139], 0
    ds_read_b64_tr_b16 v[190:191], v21 offset:20992
    v_mfma_f32_16x16x32_bf16 v[84:87], v[196:199], v[136:139], 0
    v_mfma_f32_16x16x32_bf16 v[88:91], v[192:195], v[140:143], 0
    v_mfma_f32_16x16x32_bf16 v[92:95], v[196:199], v[140:143], 0
    v_mfma_f32_16x16x32_bf16 v[96:99], v[144:147], v[192:195], 0
    buffer_load_dwordx4 a[28:31], v9, s[4:7], s80 offen offset:3072 sc1
    v_mfma_f32_16x16x32_bf16 v[100:103], v[144:147], v[196:199], 0
    v_mfma_f32_16x16x32_bf16 v[104:107], v[148:151], v[192:195], 0
    v_mfma_f32_16x16x32_bf16 v[108:111], v[148:151], v[196:199], 0
    s_waitcnt vmcnt(15) lgkmcnt(0)
    s_barrier
    v_mfma_f32_16x16x32_bf16 v[32:35], v[200:203], v[152:155], v[32:35]
    ds_read_b128 v[112:115], v16 offset:24576
    v_mfma_f32_16x16x32_bf16 v[36:39], v[204:207], v[152:155], v[36:39]
    ds_read_b128 v[116:119], v16 offset:26624
    v_mfma_f32_16x16x32_bf16 v[40:43], v[200:203], v[156:159], v[40:43]
    ds_read_b128 v[120:123], v16 offset:28672
    s_add_u32 s80, s80, 4096
    v_mfma_f32_16x16x32_bf16 v[44:47], v[204:207], v[156:159], v[44:47]
    ds_read_b128 v[124:127], v16 offset:30720
    buffer_load_dwordx4 v[192:195], v8, s[4:7], s80 offen offset:0 sc1
    v_mfma_f32_16x16x32_bf16 v[48:51], v[200:203], v[160:163], v[48:51]
    ds_read_b128 v[128:131], v16 offset:32768
    v_mfma_f32_16x16x32_bf16 v[52:55], v[204:207], v[160:163], v[52:55]
    ds_read_b128 v[132:135], v16 offset:34816
    v_mfma_f32_16x16x32_bf16 v[56:59], v[200:203], v[164:167], v[56:59]
    v_mfma_f32_16x16x32_bf16 v[60:63], v[204:207], v[164:167], v[60:63]
    ds_read_b128 v[136:139], v16 offset:36864
    s_add_u32 s56, s56, 128
    s_add_u32 m0, s81, 0
    v_mfma_f32_16x16x32_bf16 v[64:67], v[200:203], v[168:171], v[64:67]
    ds_read_b128 v[140:143], v16 offset:38912
    buffer_load_dwordx4 v10, s[44:47], s56 offen nt lds
    v_mfma_f32_16x16x32_bf16 v[68:71], v[204:207], v[168:171], v[68:71]
    ds_read_b64_tr_b16 v[144:145], v20 offset:40960
    v_mfma_f32_16x16x32_bf16 v[72:75], v[200:203], v[172:175], v[72:75]
    ds_read_b64_tr_b16 v[146:147], v20 offset:41472
    v_mfma_f32_16x16x32_bf16 v[76:79], v[204:207], v[172:175], v[76:79]
    ds_read_b64_tr_b16 v[148:149], v21 offset:40960
    v_mfma_f32_16x16x32_bf16 v[80:83], v[200:203], v[176:179], v[80:83]
    ds_read_b64_tr_b16 v[150:151], v21 offset:41472
    buffer_load_dwordx4 v[196:199], v9, s[4:7], s80 offen offset:0 sc1
    v_mfma_f32_16x16x32_bf16 v[84:87], v[204:207], v[176:179], v[84:87]
    v_mfma_f32_16x16x32_bf16 v[88:91], v[200:203], v[180:183], v[88:91]
    v_mfma_f32_16x16x32_bf16 v[92:95], v[204:207], v[180:183], v[92:95]
    v_mfma_f32_16x16x32_bf16 v[96:99], v[184:187], v[200:203], v[96:99]
    s_add_u32 m0, s81, 1024
    v_mfma_f32_16x16x32_bf16 v[100:103], v[184:187], v[204:207], v[100:103]
    buffer_load_dwordx4 v11, s[44:47], s56 offen nt lds
    v_mfma_f32_16x16x32_bf16 v[104:107], v[188:191], v[200:203], v[104:107]
    v_mfma_f32_16x16x32_bf16 v[108:111], v[188:191], v[204:207], v[108:111]
    s_waitcnt vmcnt(17) lgkmcnt(0)
    v_mfma_f32_16x16x32_bf16 v[32:35], v[208:211], v[112:115], v[32:35]
    ds_read_b128 v[152:155], v17 offset:24576
    v_mfma_f32_16x16x32_bf16 v[36:39], v[212:215], v[112:115], v[36:39]
    ds_read_b128 v[156:159], v17 offset:26624
    v_mfma_f32_16x16x32_bf16 v[40:43], v[208:211], v[116:119], v[40:43]
    ds_read_b128 v[160:163], v17 offset:28672
    v_mfma_f32_16x16x32_bf16 v[44:47], v[212:215], v[116:119], v[44:47]
    ds_read_b128 v[164:167], v17 offset:30720
    v_mfma_f32_16x16x32_bf16 v[48:51], v[208:211], v[120:123], v[48:51]
    ds_read_b128 v[168:171], v17 offset:32768
    buffer_load_dwordx4 v[200:203], v8, s[4:7], s80 offen offset:1024 sc1
    v_mfma_f32_16x16x32_bf16 v[52:55], v[212:215], v[120:123], v[52:55]
    ds_read_b128 v[172:175], v17 offset:34816
    v_mfma_f32_16x16x32_bf16 v[56:59], v[208:211], v[124:127], v[56:59]
    v_mfma_f32_16x16x32_bf16 v[60:63], v[212:215], v[124:127], v[60:63]
    ds_read_b128 v[176:179], v17 offset:36864
    v_mfma_f32_16x16x32_bf16 v[64:67], v[208:211], v[128:131], v[64:67]
    ds_read_b128 v[180:183], v17 offset:38912
    v_mfma_f32_16x16x32_bf16 v[68:71], v[212:215], v[128:131], v[68:71]
    ds_read_b64_tr_b16 v[184:185], v20 offset:45056
    s_add_u32 s57, s57, 458752
    s_add_u32 m0, s58, 0
    v_mfma_f32_16x16x32_bf16 v[72:75], v[208:211], v[132:135], v[72:75]
    ds_read_b64_tr_b16 v[186:187], v20 offset:45568
    buffer_load_dwordx4 v12, s[52:55], s57 offen nt lds
    v_mfma_f32_16x16x32_bf16 v[76:79], v[212:215], v[132:135], v[76:79]
    ds_read_b64_tr_b16 v[188:189], v21 offset:45056
    v_mfma_f32_16x16x32_bf16 v[80:83], v[208:211], v[136:139], v[80:83]
    ds_read_b64_tr_b16 v[190:191], v21 offset:45568
    v_mfma_f32_16x16x32_bf16 v[84:87], v[212:215], v[136:139], v[84:87]
    v_mfma_f32_16x16x32_bf16 v[88:91], v[208:211], v[140:143], v[88:91]
    v_mfma_f32_16x16x32_bf16 v[92:95], v[212:215], v[140:143], v[92:95]
    v_mfma_f32_16x16x32_bf16 v[96:99], v[144:147], v[208:211], v[96:99]
    buffer_load_dwordx4 v[204:207], v9, s[4:7], s80 offen offset:1024 sc1
    v_mfma_f32_16x16x32_bf16 v[100:103], v[144:147], v[212:215], v[100:103]
    v_mfma_f32_16x16x32_bf16 v[104:107], v[148:151], v[208:211], v[104:107]
    v_mfma_f32_16x16x32_bf16 v[108:111], v[148:151], v[212:215], v[108:111]
    s_waitcnt vmcnt(18) lgkmcnt(0)
    s_barrier
    v_mfma_f32_16x16x32_bf16 v[32:35], v[216:219], v[152:155], v[32:35]
    ds_read_b128 v[112:115], v16 offset:49152
    v_mfma_f32_16x16x32_bf16 v[36:39], v[220:223], v[152:155], v[36:39]
    ds_read_b128 v[116:119], v16 offset:51200
    v_mfma_f32_16x16x32_bf16 v[40:43], v[216:219], v[156:159], v[40:43]
    ds_read_b128 v[120:123], v16 offset:53248
    v_mfma_f32_16x16x32_bf16 v[44:47], v[220:223], v[156:159], v[44:47]
    ds_read_b128 v[124:127], v16 offset:55296
    buffer_load_dwordx4 v[208:211], v8, s[4:7], s80 offen offset:2048 sc1
    v_mfma_f32_16x16x32_bf16 v[48:51], v[216:219], v[160:163], v[48:51]
    ds_read_b128 v[128:131], v16 offset:57344
    v_mfma_f32_16x16x32_bf16 v[52:55], v[220:223], v[160:163], v[52:55]
    ds_read_b128 v[132:135], v16 offset:59392
    v_mfma_f32_16x16x32_bf16 v[56:59], v[216:219], v[164:167], v[56:59]
    v_mfma_f32_16x16x32_bf16 v[60:63], v[220:223], v[164:167], v[60:63]
    ds_read_b128 v[136:139], v16 offset:61440
    s_add_u32 s56, s56, 128
    s_add_u32 m0, s81, 24576
    v_mfma_f32_16x16x32_bf16 v[64:67], v[216:219], v[168:171], v[64:67]
    ds_read_b128 v[140:143], v16 offset:63488
    buffer_load_dwordx4 v10, s[44:47], s56 offen nt lds
    v_mfma_f32_16x16x32_bf16 v[68:71], v[220:223], v[168:171], v[68:71]
    ds_read_b64_tr_b16 v[144:145], v24 offset:0
    v_mfma_f32_16x16x32_bf16 v[72:75], v[216:219], v[172:175], v[72:75]
    ds_read_b64_tr_b16 v[146:147], v24 offset:512
    v_mfma_f32_16x16x32_bf16 v[76:79], v[220:223], v[172:175], v[76:79]
    ds_read_b64_tr_b16 v[148:149], v25 offset:0
    v_mfma_f32_16x16x32_bf16 v[80:83], v[216:219], v[176:179], v[80:83]
    ds_read_b64_tr_b16 v[150:151], v25 offset:512
    buffer_load_dwordx4 v[212:215], v9, s[4:7], s80 offen offset:2048 sc1
    v_mfma_f32_16x16x32_bf16 v[84:87], v[220:223], v[176:179], v[84:87]
    v_mfma_f32_16x16x32_bf16 v[88:91], v[216:219], v[180:183], v[88:91]
    v_mfma_f32_16x16x32_bf16 v[92:95], v[220:223], v[180:183], v[92:95]
    v_mfma_f32_16x16x32_bf16 v[96:99], v[184:187], v[216:219], v[96:99]
    s_add_u32 m0, s81, 25600
    v_mfma_f32_16x16x32_bf16 v[100:103], v[184:187], v[220:223], v[100:103]
    buffer_load_dwordx4 v11, s[44:47], s56 offen nt lds
    v_mfma_f32_16x16x32_bf16 v[104:107], v[188:191], v[216:219], v[104:107]
    v_mfma_f32_16x16x32_bf16 v[108:111], v[188:191], v[220:223], v[108:111]
    s_waitcnt vmcnt(20) lgkmcnt(0)
    v_mfma_f32_16x16x32_bf16 v[32:35], a[0:3], v[112:115], v[32:35]
    ds_read_b128 v[152:155], v17 offset:49152
    v_mfma_f32_16x16x32_bf16 v[36:39], a[4:7], v[112:115], v[36:39]
    ds_read_b128 v[156:159], v17 offset:51200
    v_mfma_f32_16x16x32_bf16 v[40:43], a[0:3], v[116:119], v[40:43]
    ds_read_b128 v[160:163], v17 offset:53248
    v_mfma_f32_16x16x32_bf16 v[44:47], a[4:7], v[116:119], v[44:47]
    ds_read_b128 v[164:167], v17 offset:55296
    v_mfma_f32_16x16x32_bf16 v[48:51], a[0:3], v[120:123], v[48:51]
    ds_read_b128 v[168:171], v17 offset:57344
    buffer_load_dwordx4 v[216:219], v8, s[4:7], s80 offen offset:3072 sc1
    v_mfma_f32_16x16x32_bf16 v[52:55], a[4:7], v[120:123], v[52:55]
    ds_read_b128 v[172:175], v17 offset:59392
    v_mfma_f32_16x16x32_bf16 v[56:59], a[0:3], v[124:127], v[56:59]
    v_mfma_f32_16x16x32_bf16 v[60:63], a[4:7], v[124:127], v[60:63]
    ds_read_b128 v[176:179], v17 offset:61440
    v_mfma_f32_16x16x32_bf16 v[64:67], a[0:3], v[128:131], v[64:67]
    ds_read_b128 v[180:183], v17 offset:63488
    v_mfma_f32_16x16x32_bf16 v[68:71], a[4:7], v[128:131], v[68:71]
    ds_read_b64_tr_b16 v[184:185], v24 offset:4096
    s_add_u32 s57, s57, 458752
    s_add_u32 m0, s58, 24576
    v_mfma_f32_16x16x32_bf16 v[72:75], a[0:3], v[132:135], v[72:75]
    ds_read_b64_tr_b16 v[186:187], v24 offset:4608
    buffer_load_dwordx4 v12, s[52:55], s57 offen nt lds
    v_mfma_f32_16x16x32_bf16 v[76:79], a[4:7], v[132:135], v[76:79]
    ds_read_b64_tr_b16 v[188:189], v25 offset:4096
    v_mfma_f32_16x16x32_bf16 v[80:83], a[0:3], v[136:139], v[80:83]
    ds_read_b64_tr_b16 v[190:191], v25 offset:4608
    v_mfma_f32_16x16x32_bf16 v[84:87], a[4:7], v[136:139], v[84:87]
    v_mfma_f32_16x16x32_bf16 v[88:91], a[0:3], v[140:143], v[88:91]
    v_mfma_f32_16x16x32_bf16 v[92:95], a[4:7], v[140:143], v[92:95]
    v_mfma_f32_16x16x32_bf16 v[96:99], v[144:147], a[0:3], v[96:99]
    buffer_load_dwordx4 v[220:223], v9, s[4:7], s80 offen offset:3072 sc1
    v_mfma_f32_16x16x32_bf16 v[100:103], v[144:147], a[4:7], v[100:103]
    v_mfma_f32_16x16x32_bf16 v[104:107], v[148:151], a[0:3], v[104:107]
    v_mfma_f32_16x16x32_bf16 v[108:111], v[148:151], a[4:7], v[108:111]
    s_waitcnt vmcnt(21) lgkmcnt(0)
    s_barrier
    v_mfma_f32_16x16x32_bf16 v[32:35], a[8:11], v[152:155], v[32:35]
    ds_read_b128 v[112:115], v18 offset:8192
    v_mfma_f32_16x16x32_bf16 v[36:39], a[12:15], v[152:155], v[36:39]
    ds_read_b128 v[116:119], v18 offset:10240
    v_mfma_f32_16x16x32_bf16 v[40:43], a[8:11], v[156:159], v[40:43]
    ds_read_b128 v[120:123], v18 offset:12288
    s_add_u32 s80, s80, 4096
    v_mfma_f32_16x16x32_bf16 v[44:47], a[12:15], v[156:159], v[44:47]
    ds_read_b128 v[124:127], v18 offset:14336
    buffer_load_dwordx4 a[0:3], v8, s[4:7], s80 offen offset:0 sc1
    v_mfma_f32_16x16x32_bf16 v[48:51], a[8:11], v[160:163], v[48:51]
    ds_read_b128 v[128:131], v18 offset:16384
    v_mfma_f32_16x16x32_bf16 v[52:55], a[12:15], v[160:163], v[52:55]
    ds_read_b128 v[132:135], v18 offset:18432
    v_mfma_f32_16x16x32_bf16 v[56:59], a[8:11], v[164:167], v[56:59]
    v_mfma_f32_16x16x32_bf16 v[60:63], a[12:15], v[164:167], v[60:63]
    ds_read_b128 v[136:139], v18 offset:20480
    s_add_u32 s56, s56, 128
    s_add_u32 m0, s81, 49152
    v_mfma_f32_16x16x32_bf16 v[64:67], a[8:11], v[168:171], v[64:67]
    ds_read_b128 v[140:143], v18 offset:22528
    buffer_load_dwordx4 v10, s[44:47], s56 offen nt lds
    v_mfma_f32_16x16x32_bf16 v[68:71], a[12:15], v[168:171], v[68:71]
    ds_read_b64_tr_b16 v[144:145], v24 offset:24576
    v_mfma_f32_16x16x32_bf16 v[72:75], a[8:11], v[172:175], v[72:75]
    ds_read_b64_tr_b16 v[146:147], v24 offset:25088
    v_mfma_f32_16x16x32_bf16 v[76:79], a[12:15], v[172:175], v[76:79]
    ds_read_b64_tr_b16 v[148:149], v25 offset:24576
    v_mfma_f32_16x16x32_bf16 v[80:83], a[8:11], v[176:179], v[80:83]
    ds_read_b64_tr_b16 v[150:151], v25 offset:25088
    buffer_load_dwordx4 a[4:7], v9, s[4:7], s80 offen offset:0 sc1
    v_mfma_f32_16x16x32_bf16 v[84:87], a[12:15], v[176:179], v[84:87]
    v_mfma_f32_16x16x32_bf16 v[88:91], a[8:11], v[180:183], v[88:91]
    v_mfma_f32_16x16x32_bf16 v[92:95], a[12:15], v[180:183], v[92:95]
    v_mfma_f32_16x16x32_bf16 v[96:99], v[184:187], a[8:11], v[96:99]
    s_add_u32 m0, s81, 50176
    v_mfma_f32_16x16x32_bf16 v[100:103], v[184:187], a[12:15], v[100:103]
    buffer_load_dwordx4 v11, s[44:47], s56 offen nt lds
    v_mfma_f32_16x16x32_bf16 v[104:107], v[188:191], a[8:11], v[104:107]
    v_mfma_f32_16x16x32_bf16 v[108:111], v[188:191], a[12:15], v[108:111]
    s_waitcnt vmcnt(22) lgkmcnt(0)
    v_mfma_f32_16x16x32_bf16 v[32:35], a[16:19], v[112:115], v[32:35]
    ds_read_b128 v[152:155], v19 offset:8192
    v_mfma_f32_16x16x32_bf16 v[36:39], a[20:23], v[112:115], v[36:39]
    ds_read_b128 v[156:159], v19 offset:10240
    v_mfma_f32_16x16x32_bf16 v[40:43], a[16:19], v[116:119], v[40:43]
    ds_read_b128 v[160:163], v19 offset:12288
    v_mfma_f32_16x16x32_bf16 v[44:47], a[20:23], v[116:119], v[44:47]
    ds_read_b128 v[164:167], v19 offset:14336
    v_mfma_f32_16x16x32_bf16 v[48:51], a[16:19], v[120:123], v[48:51]
    ds_read_b128 v[168:171], v19 offset:16384
    buffer_load_dwordx4 a[8:11], v8, s[4:7], s80 offen offset:1024 sc1
    v_mfma_f32_16x16x32_bf16 v[52:55], a[20:23], v[120:123], v[52:55]
    ds_read_b128 v[172:175], v19 offset:18432
    v_mfma_f32_16x16x32_bf16 v[56:59], a[16:19], v[124:127], v[56:59]
    v_mfma_f32_16x16x32_bf16 v[60:63], a[20:23], v[124:127], v[60:63]
    ds_read_b128 v[176:179], v19 offset:20480
    v_mfma_f32_16x16x32_bf16 v[64:67], a[16:19], v[128:131], v[64:67]
    ds_read_b128 v[180:183], v19 offset:22528
    v_mfma_f32_16x16x32_bf16 v[68:71], a[20:23], v[128:131], v[68:71]
    ds_read_b64_tr_b16 v[184:185], v24 offset:28672
    s_add_u32 s57, s57, 458752
    s_add_u32 m0, s58, 49152
    v_mfma_f32_16x16x32_bf16 v[72:75], a[16:19], v[132:135], v[72:75]
    ds_read_b64_tr_b16 v[186:187], v24 offset:29184
    buffer_load_dwordx4 v12, s[52:55], s57 offen nt lds
    v_mfma_f32_16x16x32_bf16 v[76:79], a[20:23], v[132:135], v[76:79]
    ds_read_b64_tr_b16 v[188:189], v25 offset:28672
    v_mfma_f32_16x16x32_bf16 v[80:83], a[16:19], v[136:139], v[80:83]
    ds_read_b64_tr_b16 v[190:191], v25 offset:29184
    v_mfma_f32_16x16x32_bf16 v[84:87], a[20:23], v[136:139], v[84:87]
    v_mfma_f32_16x16x32_bf16 v[88:91], a[16:19], v[140:143], v[88:91]
    v_mfma_f32_16x16x32_bf16 v[92:95], a[20:23], v[140:143], v[92:95]
    v_mfma_f32_16x16x32_bf16 v[96:99], v[144:147], a[16:19], v[96:99]
    buffer_load_dwordx4 a[12:15], v9, s[4:7], s80 offen offset:1024 sc1
    v_mfma_f32_16x16x32_bf16 v[100:103], v[144:147], a[20:23], v[100:103]
    v_mfma_f32_16x16x32_bf16 v[104:107], v[148:151], a[16:19], v[104:107]
    v_mfma_f32_16x16x32_bf16 v[108:111], v[148:151], a[20:23], v[108:111]
    s_waitcnt vmcnt(21) lgkmcnt(0)
    s_barrier
    v_mfma_f32_16x16x32_bf16 v[32:35], a[24:27], v[152:155], v[32:35]
    ds_read_b128 v[112:115], v18 offset:32768
    v_mfma_f32_16x16x32_bf16 v[36:39], a[28:31], v[152:155], v[36:39]
    ds_read_b128 v[116:119], v18 offset:34816
    v_mfma_f32_16x16x32_bf16 v[40:43], a[24:27], v[156:159], v[40:43]
    ds_read_b128 v[120:123], v18 offset:36864
    v_mfma_f32_16x16x32_bf16 v[44:47], a[28:31], v[156:159], v[44:47]
    ds_read_b128 v[124:127], v18 offset:38912
    buffer_load_dwordx4 a[16:19], v8, s[4:7], s80 offen offset:2048 sc1
    v_mfma_f32_16x16x32_bf16 v[48:51], a[24:27], v[160:163], v[48:51]
    ds_read_b128 v[128:131], v18 offset:40960
    v_mfma_f32_16x16x32_bf16 v[52:55], a[28:31], v[160:163], v[52:55]
    ds_read_b128 v[132:135], v18 offset:43008
    v_mfma_f32_16x16x32_bf16 v[56:59], a[24:27], v[164:167], v[56:59]
    v_mfma_f32_16x16x32_bf16 v[60:63], a[28:31], v[164:167], v[60:63]
    ds_read_b128 v[136:139], v18 offset:45056
    s_add_u32 s56, s56, 128
    s_add_u32 m0, s81, 73728
    v_mfma_f32_16x16x32_bf16 v[64:67], a[24:27], v[168:171], v[64:67]
    ds_read_b128 v[140:143], v18 offset:47104
    buffer_load_dwordx4 v10, s[44:47], s56 offen nt lds
    v_mfma_f32_16x16x32_bf16 v[68:71], a[28:31], v[168:171], v[68:71]
    ds_read_b64_tr_b16 v[144:145], v24 offset:49152
    v_mfma_f32_16x16x32_bf16 v[72:75], a[24:27], v[172:175], v[72:75]
    ds_read_b64_tr_b16 v[146:147], v24 offset:49664
    v_mfma_f32_16x16x32_bf16 v[76:79], a[28:31], v[172:175], v[76:79]
    ds_read_b64_tr_b16 v[148:149], v25 offset:49152
    v_mfma_f32_16x16x32_bf16 v[80:83], a[24:27], v[176:179], v[80:83]
    ds_read_b64_tr_b16 v[150:151], v25 offset:49664
    buffer_load_dwordx4 a[20:23], v9, s[4:7], s80 offen offset:2048 sc1
    v_mfma_f32_16x16x32_bf16 v[84:87], a[28:31], v[176:179], v[84:87]
    v_mfma_f32_16x16x32_bf16 v[88:91], a[24:27], v[180:183], v[88:91]
    v_mfma_f32_16x16x32_bf16 v[92:95], a[28:31], v[180:183], v[92:95]
    v_mfma_f32_16x16x32_bf16 v[96:99], v[184:187], a[24:27], v[96:99]
    s_add_u32 m0, s81, 74752
    v_mfma_f32_16x16x32_bf16 v[100:103], v[184:187], a[28:31], v[100:103]
    buffer_load_dwordx4 v11, s[44:47], s56 offen nt lds
    v_mfma_f32_16x16x32_bf16 v[104:107], v[188:191], a[24:27], v[104:107]
    v_mfma_f32_16x16x32_bf16 v[108:111], v[188:191], a[28:31], v[108:111]
    s_waitcnt vmcnt(22) lgkmcnt(0)
    v_mfma_f32_16x16x32_bf16 v[32:35], v[192:195], v[112:115], v[32:35]
    ds_read_b128 v[152:155], v19 offset:32768
    v_mfma_f32_16x16x32_bf16 v[36:39], v[196:199], v[112:115], v[36:39]
    ds_read_b128 v[156:159], v19 offset:34816
    v_mfma_f32_16x16x32_bf16 v[40:43], v[192:195], v[116:119], v[40:43]
    ds_read_b128 v[160:163], v19 offset:36864
    v_mfma_f32_16x16x32_bf16 v[44:47], v[196:199], v[116:119], v[44:47]
    ds_read_b128 v[164:167], v19 offset:38912
    v_mfma_f32_16x16x32_bf16 v[48:51], v[192:195], v[120:123], v[48:51]
    ds_read_b128 v[168:171], v19 offset:40960
    buffer_load_dwordx4 a[24:27], v8, s[4:7], s80 offen offset:3072 sc1
    v_mfma_f32_16x16x32_bf16 v[52:55], v[196:199], v[120:123], v[52:55]
    ds_read_b128 v[172:175], v19 offset:43008
    v_mfma_f32_16x16x32_bf16 v[56:59], v[192:195], v[124:127], v[56:59]
    v_mfma_f32_16x16x32_bf16 v[60:63], v[196:199], v[124:127], v[60:63]
    ds_read_b128 v[176:179], v19 offset:45056
    v_mfma_f32_16x16x32_bf16 v[64:67], v[192:195], v[128:131], v[64:67]
    ds_read_b128 v[180:183], v19 offset:47104
    v_mfma_f32_16x16x32_bf16 v[68:71], v[196:199], v[128:131], v[68:71]
    ds_read_b64_tr_b16 v[184:185], v24 offset:53248
    s_add_u32 s57, s57, 458752
    s_add_u32 m0, s58, 73728
    v_mfma_f32_16x16x32_bf16 v[72:75], v[192:195], v[132:135], v[72:75]
    ds_read_b64_tr_b16 v[186:187], v24 offset:53760
    buffer_load_dwordx4 v12, s[52:55], s57 offen nt lds
    v_mfma_f32_16x16x32_bf16 v[76:79], v[196:199], v[132:135], v[76:79]
    ds_read_b64_tr_b16 v[188:189], v25 offset:53248
    v_mfma_f32_16x16x32_bf16 v[80:83], v[192:195], v[136:139], v[80:83]
    ds_read_b64_tr_b16 v[190:191], v25 offset:53760
    v_mfma_f32_16x16x32_bf16 v[84:87], v[196:199], v[136:139], v[84:87]
    v_mfma_f32_16x16x32_bf16 v[88:91], v[192:195], v[140:143], v[88:91]
    v_mfma_f32_16x16x32_bf16 v[92:95], v[196:199], v[140:143], v[92:95]
    v_mfma_f32_16x16x32_bf16 v[96:99], v[144:147], v[192:195], v[96:99]
    buffer_load_dwordx4 a[28:31], v9, s[4:7], s80 offen offset:3072 sc1
    v_mfma_f32_16x16x32_bf16 v[100:103], v[144:147], v[196:199], v[100:103]
    v_mfma_f32_16x16x32_bf16 v[104:107], v[148:151], v[192:195], v[104:107]
    v_mfma_f32_16x16x32_bf16 v[108:111], v[148:151], v[196:199], v[108:111]
    s_waitcnt vmcnt(21) lgkmcnt(0)
    s_barrier
    v_mfma_f32_16x16x32_bf16 v[32:35], v[200:203], v[152:155], v[32:35]
    ds_read_b128 v[112:115], v16 offset:0
    v_mfma_f32_16x16x32_bf16 v[36:39], v[204:207], v[152:155], v[36:39]
    ds_read_b128 v[116:119], v16 offset:2048
    v_mfma_f32_16x16x32_bf16 v[40:43], v[200:203], v[156:159], v[40:43]
    ds_read_b128 v[120:123], v16 offset:4096
    s_add_u32 s80, s80, 4096
    v_mfma_f32_16x16x32_bf16 v[44:47], v[204:207], v[156:159], v[44:47]
    ds_read_b128 v[124:127], v16 offset:6144
    buffer_load_dwordx4 v[192:195], v8, s[4:7], s80 offen offset:0 sc1
    v_mfma_f32_16x16x32_bf16 v[48:51], v[200:203], v[160:163], v[48:51]
    ds_read_b128 v[128:131], v16 offset:8192
    v_mfma_f32_16x16x32_bf16 v[52:55], v[204:207], v[160:163], v[52:55]
    ds_read_b128 v[132:135], v16 offset:10240
    v_mfma_f32_16x16x32_bf16 v[56:59], v[200:203], v[164:167], v[56:59]
    v_mfma_f32_16x16x32_bf16 v[60:63], v[204:207], v[164:167], v[60:63]
    ds_read_b128 v[136:139], v16 offset:12288
    s_add_u32 s56, s56, 128
    s_add_u32 m0, s81, 98304
    v_mfma_f32_16x16x32_bf16 v[64:67], v[200:203], v[168:171], v[64:67]
    ds_read_b128 v[140:143], v16 offset:14336
    buffer_load_dwordx4 v10, s[44:47], s56 offen nt lds
    v_mfma_f32_16x16x32_bf16 v[68:71], v[204:207], v[168:171], v[68:71]
    ds_read_b64_tr_b16 v[144:145], v20 offset:16384
    v_mfma_f32_16x16x32_bf16 v[72:75], v[200:203], v[172:175], v[72:75]
    ds_read_b64_tr_b16 v[146:147], v20 offset:16896
    v_mfma_f32_16x16x32_bf16 v[76:79], v[204:207], v[172:175], v[76:79]
    ds_read_b64_tr_b16 v[148:149], v21 offset:16384
    v_mfma_f32_16x16x32_bf16 v[80:83], v[200:203], v[176:179], v[80:83]
    ds_read_b64_tr_b16 v[150:151], v21 offset:16896
    buffer_load_dwordx4 v[196:199], v9, s[4:7], s80 offen offset:0 sc1
    v_mfma_f32_16x16x32_bf16 v[84:87], v[204:207], v[176:179], v[84:87]
    v_mfma_f32_16x16x32_bf16 v[88:91], v[200:203], v[180:183], v[88:91]
    v_mfma_f32_16x16x32_bf16 v[92:95], v[204:207], v[180:183], v[92:95]
    v_mfma_f32_16x16x32_bf16 v[96:99], v[184:187], v[200:203], v[96:99]
    s_add_u32 m0, s81, 99328
    v_mfma_f32_16x16x32_bf16 v[100:103], v[184:187], v[204:207], v[100:103]
    buffer_load_dwordx4 v11, s[44:47], s56 offen nt lds
    v_mfma_f32_16x16x32_bf16 v[104:107], v[188:191], v[200:203], v[104:107]
    v_mfma_f32_16x16x32_bf16 v[108:111], v[188:191], v[204:207], v[108:111]
    s_waitcnt vmcnt(22) lgkmcnt(0)
    v_mfma_f32_16x16x32_bf16 v[32:35], v[208:211], v[112:115], v[32:35]
    ds_read_b128 v[152:155], v17 offset:0
    v_mfma_f32_16x16x32_bf16 v[36:39], v[212:215], v[112:115], v[36:39]
    ds_read_b128 v[156:159], v17 offset:2048
    v_mfma_f32_16x16x32_bf16 v[40:43], v[208:211], v[116:119], v[40:43]
    ds_read_b128 v[160:163], v17 offset:4096
    v_mfma_f32_16x16x32_bf16 v[44:47], v[212:215], v[116:119], v[44:47]
    ds_read_b128 v[164:167], v17 offset:6144
    v_mfma_f32_16x16x32_bf16 v[48:51], v[208:211], v[120:123], v[48:51]
    ds_read_b128 v[168:171], v17 offset:8192
    buffer_load_dwordx4 v[200:203], v8, s[4:7], s80 offen offset:1024 sc1
    v_mfma_f32_16x16x32_bf16 v[52:55], v[212:215], v[120:123], v[52:55]
    ds_read_b128 v[172:175], v17 offset:10240
    v_mfma_f32_16x16x32_bf16 v[56:59], v[208:211], v[124:127], v[56:59]
    v_mfma_f32_16x16x32_bf16 v[60:63], v[212:215], v[124:127], v[60:63]
    ds_read_b128 v[176:179], v17 offset:12288
    v_mfma_f32_16x16x32_bf16 v[64:67], v[208:211], v[128:131], v[64:67]
    ds_read_b128 v[180:183], v17 offset:14336
    v_mfma_f32_16x16x32_bf16 v[68:71], v[212:215], v[128:131], v[68:71]
    ds_read_b64_tr_b16 v[184:185], v20 offset:20480
    s_add_u32 s57, s57, 458752
    s_add_u32 m0, s58, 98304
    v_mfma_f32_16x16x32_bf16 v[72:75], v[208:211], v[132:135], v[72:75]
    ds_read_b64_tr_b16 v[186:187], v20 offset:20992
    buffer_load_dwordx4 v12, s[52:55], s57 offen nt lds
    v_mfma_f32_16x16x32_bf16 v[76:79], v[212:215], v[132:135], v[76:79]
    ds_read_b64_tr_b16 v[188:189], v21 offset:20480
    v_mfma_f32_16x16x32_bf16 v[80:83], v[208:211], v[136:139], v[80:83]
    ds_read_b64_tr_b16 v[190:191], v21 offset:20992
    v_mfma_f32_16x16x32_bf16 v[84:87], v[212:215], v[136:139], v[84:87]
    v_mfma_f32_16x16x32_bf16 v[88:91], v[208:211], v[140:143], v[88:91]
    v_mfma_f32_16x16x32_bf16 v[92:95], v[212:215], v[140:143], v[92:95]
    v_mfma_f32_16x16x32_bf16 v[96:99], v[144:147], v[208:211], v[96:99]
    buffer_load_dwordx4 v[204:207], v9, s[4:7], s80 offen offset:1024 sc1
    v_mfma_f32_16x16x32_bf16 v[100:103], v[144:147], v[212:215], v[100:103]
    v_mfma_f32_16x16x32_bf16 v[104:107], v[148:151], v[208:211], v[104:107]
    v_mfma_f32_16x16x32_bf16 v[108:111], v[148:151], v[212:215], v[108:111]
    s_waitcnt vmcnt(21) lgkmcnt(0)
    s_barrier
    v_mfma_f32_16x16x32_bf16 v[32:35], v[216:219], v[152:155], v[32:35]
    ds_read_b128 v[112:115], v16 offset:24576
    v_mfma_f32_16x16x32_bf16 v[36:39], v[220:223], v[152:155], v[36:39]
    ds_read_b128 v[116:119], v16 offset:26624
    v_mfma_f32_16x16x32_bf16 v[40:43], v[216:219], v[156:159], v[40:43]
    ds_read_b128 v[120:123], v16 offset:28672
    v_mfma_f32_16x16x32_bf16 v[44:47], v[220:223], v[156:159], v[44:47]
    ds_read_b128 v[124:127], v16 offset:30720
    buffer_load_dwordx4 v[208:211], v8, s[4:7], s80 offen offset:2048 sc1
    v_mfma_f32_16x16x32_bf16 v[48:51], v[216:219], v[160:163], v[48:51]
    ds_read_b128 v[128:131], v16 offset:32768
    v_mfma_f32_16x16x32_bf16 v[52:55], v[220:223], v[160:163], v[52:55]
    ds_read_b128 v[132:135], v16 offset:34816
    v_mfma_f32_16x16x32_bf16 v[56:59], v[216:219], v[164:167], v[56:59]
    v_mfma_f32_16x16x32_bf16 v[60:63], v[220:223], v[164:167], v[60:63]
    ds_read_b128 v[136:139], v16 offset:36864
    s_add_u32 s56, s56, 128
    s_add_u32 m0, s81, 0
    v_mfma_f32_16x16x32_bf16 v[64:67], v[216:219], v[168:171], v[64:67]
    ds_read_b128 v[140:143], v16 offset:38912
    buffer_load_dwordx4 v10, s[44:47], s56 offen nt lds
    v_mfma_f32_16x16x32_bf16 v[68:71], v[220:223], v[168:171], v[68:71]
    ds_read_b64_tr_b16 v[144:145], v20 offset:40960
    v_mfma_f32_16x16x32_bf16 v[72:75], v[216:219], v[172:175], v[72:75]
    ds_read_b64_tr_b16 v[146:147], v20 offset:41472
    v_mfma_f32_16x16x32_bf16 v[76:79], v[220:223], v[172:175], v[76:79]
    ds_read_b64_tr_b16 v[148:149], v21 offset:40960
    v_mfma_f32_16x16x32_bf16 v[80:83], v[216:219], v[176:179], v[80:83]
    ds_read_b64_tr_b16 v[150:151], v21 offset:41472
    buffer_load_dwordx4 v[212:215], v9, s[4:7], s80 offen offset:2048 sc1
    v_mfma_f32_16x16x32_bf16 v[84:87], v[220:223], v[176:179], v[84:87]
    v_mfma_f32_16x16x32_bf16 v[88:91], v[216:219], v[180:183], v[88:91]
    v_mfma_f32_16x16x32_bf16 v[92:95], v[220:223], v[180:183], v[92:95]
    v_mfma_f32_16x16x32_bf16 v[96:99], v[184:187], v[216:219], v[96:99]
    s_add_u32 m0, s81, 1024
    v_mfma_f32_16x16x32_bf16 v[100:103], v[184:187], v[220:223], v[100:103]
    buffer_load_dwordx4 v11, s[44:47], s56 offen nt lds
    v_mfma_f32_16x16x32_bf16 v[104:107], v[188:191], v[216:219], v[104:107]
    v_mfma_f32_16x16x32_bf16 v[108:111], v[188:191], v[220:223], v[108:111]
    s_waitcnt vmcnt(22) lgkmcnt(0)
    v_mfma_f32_16x16x32_bf16 v[32:35], a[0:3], v[112:115], v[32:35]
    ds_read_b128 v[152:155], v17 offset:24576
    v_mfma_f32_16x16x32_bf16 v[36:39], a[4:7], v[112:115], v[36:39]
    ds_read_b128 v[156:159], v17 offset:26624
    v_mfma_f32_16x16x32_bf16 v[40:43], a[0:3], v[116:119], v[40:43]
    ds_read_b128 v[160:163], v17 offset:28672
    v_mfma_f32_16x16x32_bf16 v[44:47], a[4:7], v[116:119], v[44:47]
    ds_read_b128 v[164:167], v17 offset:30720
    v_mfma_f32_16x16x32_bf16 v[48:51], a[0:3], v[120:123], v[48:51]
    ds_read_b128 v[168:171], v17 offset:32768
    buffer_load_dwordx4 v[216:219], v8, s[4:7], s80 offen offset:3072 sc1
    v_mfma_f32_16x16x32_bf16 v[52:55], a[4:7], v[120:123], v[52:55]
    ds_read_b128 v[172:175], v17 offset:34816
    v_mfma_f32_16x16x32_bf16 v[56:59], a[0:3], v[124:127], v[56:59]
    v_mfma_f32_16x16x32_bf16 v[60:63], a[4:7], v[124:127], v[60:63]
    ds_read_b128 v[176:179], v17 offset:36864
    v_mfma_f32_16x16x32_bf16 v[64:67], a[0:3], v[128:131], v[64:67]
    ds_read_b128 v[180:183], v17 offset:38912
    v_mfma_f32_16x16x32_bf16 v[68:71], a[4:7], v[128:131], v[68:71]
    ds_read_b64_tr_b16 v[184:185], v20 offset:45056
    s_add_u32 s57, s57, 458752
    s_add_u32 m0, s58, 0
    v_mfma_f32_16x16x32_bf16 v[72:75], a[0:3], v[132:135], v[72:75]
    ds_read_b64_tr_b16 v[186:187], v20 offset:45568
    buffer_load_dwordx4 v12, s[52:55], s57 offen nt lds
    v_mfma_f32_16x16x32_bf16 v[76:79], a[4:7], v[132:135], v[76:79]
    ds_read_b64_tr_b16 v[188:189], v21 offset:45056
    v_mfma_f32_16x16x32_bf16 v[80:83], a[0:3], v[136:139], v[80:83]
    ds_read_b64_tr_b16 v[190:191], v21 offset:45568
    v_mfma_f32_16x16x32_bf16 v[84:87], a[4:7], v[136:139], v[84:87]
    v_mfma_f32_16x16x32_bf16 v[88:91], a[0:3], v[140:143], v[88:91]
    v_mfma_f32_16x16x32_bf16 v[92:95], a[4:7], v[140:143], v[92:95]
    v_mfma_f32_16x16x32_bf16 v[96:99], v[144:147], a[0:3], v[96:99]
    buffer_load_dwordx4 v[220:223], v9, s[4:7], s80 offen offset:3072 sc1
    v_mfma_f32_16x16x32_bf16 v[100:103], v[144:147], a[4:7], v[100:103]
    v_mfma_f32_16x16x32_bf16 v[104:107], v[148:151], a[0:3], v[104:107]
    v_mfma_f32_16x16x32_bf16 v[108:111], v[148:151], a[4:7], v[108:111]
    s_waitcnt vmcnt(21) lgkmcnt(0)
    s_barrier
    v_mfma_f32_16x16x32_bf16 v[32:35], a[8:11], v[152:155], v[32:35]
    ds_read_b128 v[112:115], v16 offset:49152
    v_mfma_f32_16x16x32_bf16 v[36:39], a[12:15], v[152:155], v[36:39]
    ds_read_b128 v[116:119], v16 offset:51200
    v_mfma_f32_16x16x32_bf16 v[40:43], a[8:11], v[156:159], v[40:43]
    ds_read_b128 v[120:123], v16 offset:53248
    s_add_u32 s80, s80, 4096
    v_mfma_f32_16x16x32_bf16 v[44:47], a[12:15], v[156:159], v[44:47]
    ds_read_b128 v[124:127], v16 offset:55296
    buffer_load_dwordx4 a[0:3], v8, s[4:7], s80 offen offset:0 sc1
    v_mfma_f32_16x16x32_bf16 v[48:51], a[8:11], v[160:163], v[48:51]
    ds_read_b128 v[128:131], v16 offset:57344
    v_mfma_f32_16x16x32_bf16 v[52:55], a[12:15], v[160:163], v[52:55]
    ds_read_b128 v[132:135], v16 offset:59392
    v_mfma_f32_16x16x32_bf16 v[56:59], a[8:11], v[164:167], v[56:59]
    v_mfma_f32_16x16x32_bf16 v[60:63], a[12:15], v[164:167], v[60:63]
    ds_read_b128 v[136:139], v16 offset:61440
    s_add_u32 s56, s56, 128
    s_add_u32 m0, s81, 24576
    v_mfma_f32_16x16x32_bf16 v[64:67], a[8:11], v[168:171], v[64:67]
    ds_read_b128 v[140:143], v16 offset:63488
    buffer_load_dwordx4 v10, s[44:47], s56 offen nt lds
    v_mfma_f32_16x16x32_bf16 v[68:71], a[12:15], v[168:171], v[68:71]
    ds_read_b64_tr_b16 v[144:145], v24 offset:0
    v_mfma_f32_16x16x32_bf16 v[72:75], a[8:11], v[172:175], v[72:75]
    ds_read_b64_tr_b16 v[146:147], v24 offset:512
    v_mfma_f32_16x16x32_bf16 v[76:79], a[12:15], v[172:175], v[76:79]
    ds_read_b64_tr_b16 v[148:149], v25 offset:0
    v_mfma_f32_16x16x32_bf16 v[80:83], a[8:11], v[176:179], v[80:83]
    ds_read_b64_tr_b16 v[150:151], v25 offset:512
    buffer_load_dwordx4 a[4:7], v9, s[4:7], s80 offen offset:0 sc1
    v_mfma_f32_16x16x32_bf16 v[84:87], a[12:15], v[176:179], v[84:87]
    v_mfma_f32_16x16x32_bf16 v[88:91], a[8:11], v[180:183], v[88:91]
    v_mfma_f32_16x16x32_bf16 v[92:95], a[12:15], v[180:183], v[92:95]
    v_mfma_f32_16x16x32_bf16 v[96:99], v[184:187], a[8:11], v[96:99]
    s_add_u32 m0, s81, 25600
    v_mfma_f32_16x16x32_bf16 v[100:103], v[184:187], a[12:15], v[100:103]
    buffer_load_dwordx4 v11, s[44:47], s56 offen nt lds
    v_mfma_f32_16x16x32_bf16 v[104:107], v[188:191], a[8:11], v[104:107]
    v_mfma_f32_16x16x32_bf16 v[108:111], v[188:191], a[12:15], v[108:111]
    s_waitcnt vmcnt(22) lgkmcnt(0)
    v_mfma_f32_16x16x32_bf16 v[32:35], a[16:19], v[112:115], v[32:35]
    ds_read_b128 v[152:155], v17 offset:49152
    v_mfma_f32_16x16x32_bf16 v[36:39], a[20:23], v[112:115], v[36:39]
    ds_read_b128 v[156:159], v17 offset:51200
    v_mfma_f32_16x16x32_bf16 v[40:43], a[16:19], v[116:119], v[40:43]
    ds_read_b128 v[160:163], v17 offset:53248
    v_mfma_f32_16x16x32_bf16 v[44:47], a[20:23], v[116:119], v[44:47]
    ds_read_b128 v[164:167], v17 offset:55296
    buffer_load_dwordx4 a[8:11], v8, s[4:7], s80 offen offset:1024 sc1
    v_mfma_f32_16x16x32_bf16 v[48:51], a[16:19], v[120:123], v[48:51]
    ds_read_b128 v[168:171], v17 offset:57344
    v_mfma_f32_16x16x32_bf16 v[52:55], a[20:23], v[120:123], v[52:55]
    ds_read_b128 v[172:175], v17 offset:59392
    v_mfma_f32_16x16x32_bf16 v[56:59], a[16:19], v[124:127], v[56:59]
    v_mfma_f32_16x16x32_bf16 v[60:63], a[20:23], v[124:127], v[60:63]
    ds_read_b128 v[176:179], v17 offset:61440
    s_add_u32 s57, s57, 458752
    s_add_u32 m0, s58, 24576
    v_mfma_f32_16x16x32_bf16 v[64:67], a[16:19], v[128:131], v[64:67]
    ds_read_b128 v[180:183], v17 offset:63488
    buffer_load_dwordx4 v12, s[52:55], s57 offen nt lds
    v_mfma_f32_16x16x32_bf16 v[68:71], a[20:23], v[128:131], v[68:71]
    ds_read_b64_tr_b16 v[184:185], v24 offset:4096
    v_mfma_f32_16x16x32_bf16 v[72:75], a[16:19], v[132:135], v[72:75]
    ds_read_b64_tr_b16 v[186:187], v24 offset:4608
    v_mfma_f32_16x16x32_bf16 v[76:79], a[20:23], v[132:135], v[76:79]
    ds_read_b64_tr_b16 v[188:189], v25 offset:4096
    v_mfma_f32_16x16x32_bf16 v[80:83], a[16:19], v[136:139], v[80:83]
    ds_read_b64_tr_b16 v[190:191], v25 offset:4608
    buffer_load_dwordx4 a[12:15], v9, s[4:7], s80 offen offset:1024 sc1
    v_mfma_f32_16x16x32_bf16 v[84:87], a[20:23], v[136:139], v[84:87]
    v_mfma_f32_16x16x32_bf16 v[88:91], a[16:19], v[140:143], v[88:91]
    v_mfma_f32_16x16x32_bf16 v[92:95], a[20:23], v[140:143], v[92:95]
    v_mfma_f32_16x16x32_bf16 v[96:99], v[144:147], a[16:19], v[96:99]
    s_mov_b32 s8, s18
    s_mov_b32 s9, s19
    s_mov_b32 s10, 8388608
    s_mov_b32 s11, 0x20000
    v_mfma_f32_16x16x32_bf16 v[100:103], v[144:147], a[20:23], v[100:103]
    buffer_load_dword v7, v13, s[8:11], 0 offen
    v_mfma_f32_16x16x32_bf16 v[104:107], v[148:151], a[16:19], v[104:107]
    v_mfma_f32_16x16x32_bf16 v[108:111], v[148:151], a[20:23], v[108:111]
    s_waitcnt vmcnt(22) lgkmcnt(0)
    s_barrier
    v_mfma_f32_16x16x32_bf16 v[32:35], a[24:27], v[152:155], v[32:35]
    ds_read_b128 v[112:115], v18 offset:8192
    v_mfma_f32_16x16x32_bf16 v[36:39], a[28:31], v[152:155], v[36:39]
    ds_read_b128 v[116:119], v18 offset:10240
    v_mfma_f32_16x16x32_bf16 v[40:43], a[24:27], v[156:159], v[40:43]
    ds_read_b128 v[120:123], v18 offset:12288
    v_mfma_f32_16x16x32_bf16 v[44:47], a[28:31], v[156:159], v[44:47]
    ds_read_b128 v[124:127], v18 offset:14336
    buffer_load_dwordx4 a[16:19], v8, s[4:7], s80 offen offset:2048 sc1
    v_mfma_f32_16x16x32_bf16 v[48:51], a[24:27], v[160:163], v[48:51]
    ds_read_b128 v[128:131], v18 offset:16384
    v_mfma_f32_16x16x32_bf16 v[52:55], a[28:31], v[160:163], v[52:55]
    ds_read_b128 v[132:135], v18 offset:18432
    v_mfma_f32_16x16x32_bf16 v[56:59], a[24:27], v[164:167], v[56:59]
    v_mfma_f32_16x16x32_bf16 v[60:63], a[28:31], v[164:167], v[60:63]
    ds_read_b128 v[136:139], v18 offset:20480
    s_add_u32 s56, s56, 128
    s_add_u32 m0, s81, 49152
    v_mfma_f32_16x16x32_bf16 v[64:67], a[24:27], v[168:171], v[64:67]
    ds_read_b128 v[140:143], v18 offset:22528
    buffer_load_dwordx4 v10, s[44:47], s56 offen nt lds
    v_mfma_f32_16x16x32_bf16 v[68:71], a[28:31], v[168:171], v[68:71]
    ds_read_b64_tr_b16 v[144:145], v24 offset:24576
    v_mfma_f32_16x16x32_bf16 v[72:75], a[24:27], v[172:175], v[72:75]
    ds_read_b64_tr_b16 v[146:147], v24 offset:25088
    v_mfma_f32_16x16x32_bf16 v[76:79], a[28:31], v[172:175], v[76:79]
    ds_read_b64_tr_b16 v[148:149], v25 offset:24576
    v_mfma_f32_16x16x32_bf16 v[80:83], a[24:27], v[176:179], v[80:83]
    ds_read_b64_tr_b16 v[150:151], v25 offset:25088
    buffer_load_dwordx4 a[20:23], v9, s[4:7], s80 offen offset:2048 sc1
    v_mfma_f32_16x16x32_bf16 v[84:87], a[28:31], v[176:179], v[84:87]
    v_mfma_f32_16x16x32_bf16 v[88:91], a[24:27], v[180:183], v[88:91]
    v_mfma_f32_16x16x32_bf16 v[92:95], a[28:31], v[180:183], v[92:95]
    v_mfma_f32_16x16x32_bf16 v[96:99], v[184:187], a[24:27], v[96:99]
    s_add_u32 m0, s81, 50176
    v_mfma_f32_16x16x32_bf16 v[100:103], v[184:187], a[28:31], v[100:103]
    buffer_load_dwordx4 v11, s[44:47], s56 offen nt lds
    v_mfma_f32_16x16x32_bf16 v[104:107], v[188:191], a[24:27], v[104:107]
    v_mfma_f32_16x16x32_bf16 v[108:111], v[188:191], a[28:31], v[108:111]
    s_waitcnt vmcnt(23) lgkmcnt(0)
    v_mfma_f32_16x16x32_bf16 v[32:35], v[192:195], v[112:115], v[32:35]
    ds_read_b128 v[152:155], v19 offset:8192
    v_mfma_f32_16x16x32_bf16 v[36:39], v[196:199], v[112:115], v[36:39]
    ds_read_b128 v[156:159], v19 offset:10240
    v_mfma_f32_16x16x32_bf16 v[40:43], v[192:195], v[116:119], v[40:43]
    ds_read_b128 v[160:163], v19 offset:12288
    v_mfma_f32_16x16x32_bf16 v[44:47], v[196:199], v[116:119], v[44:47]
    ds_read_b128 v[164:167], v19 offset:14336
    v_mfma_f32_16x16x32_bf16 v[48:51], v[192:195], v[120:123], v[48:51]
    ds_read_b128 v[168:171], v19 offset:16384
    buffer_load_dwordx4 a[24:27], v8, s[4:7], s80 offen offset:3072 sc1
    v_mfma_f32_16x16x32_bf16 v[52:55], v[196:199], v[120:123], v[52:55]
    ds_read_b128 v[172:175], v19 offset:18432
    v_mfma_f32_16x16x32_bf16 v[56:59], v[192:195], v[124:127], v[56:59]
    v_mfma_f32_16x16x32_bf16 v[60:63], v[196:199], v[124:127], v[60:63]
    ds_read_b128 v[176:179], v19 offset:20480
    v_mfma_f32_16x16x32_bf16 v[64:67], v[192:195], v[128:131], v[64:67]
    ds_read_b128 v[180:183], v19 offset:22528
    v_mfma_f32_16x16x32_bf16 v[68:71], v[196:199], v[128:131], v[68:71]
    ds_read_b64_tr_b16 v[184:185], v24 offset:28672
    s_add_u32 s57, s57, 458752
    s_add_u32 m0, s58, 49152
    v_mfma_f32_16x16x32_bf16 v[72:75], v[192:195], v[132:135], v[72:75]
    ds_read_b64_tr_b16 v[186:187], v24 offset:29184
    buffer_load_dwordx4 v12, s[52:55], s57 offen nt lds
    v_mfma_f32_16x16x32_bf16 v[76:79], v[196:199], v[132:135], v[76:79]
    ds_read_b64_tr_b16 v[188:189], v25 offset:28672
    v_mfma_f32_16x16x32_bf16 v[80:83], v[192:195], v[136:139], v[80:83]
    ds_read_b64_tr_b16 v[190:191], v25 offset:29184
    v_mfma_f32_16x16x32_bf16 v[84:87], v[196:199], v[136:139], v[84:87]
    v_mfma_f32_16x16x32_bf16 v[88:91], v[192:195], v[140:143], v[88:91]
    v_mfma_f32_16x16x32_bf16 v[92:95], v[196:199], v[140:143], v[92:95]
    v_mfma_f32_16x16x32_bf16 v[96:99], v[144:147], v[192:195], v[96:99]
    buffer_load_dwordx4 a[28:31], v9, s[4:7], s80 offen offset:3072 sc1
    v_mfma_f32_16x16x32_bf16 v[100:103], v[144:147], v[196:199], v[100:103]
    v_mfma_f32_16x16x32_bf16 v[104:107], v[148:151], v[192:195], v[104:107]
    v_mfma_f32_16x16x32_bf16 v[108:111], v[148:151], v[196:199], v[108:111]
    s_waitcnt vmcnt(22) lgkmcnt(0)
    s_barrier
    v_mfma_f32_16x16x32_bf16 v[32:35], v[200:203], v[152:155], v[32:35]
    ds_read_b128 v[112:115], v18 offset:32768
    v_mfma_f32_16x16x32_bf16 v[36:39], v[204:207], v[152:155], v[36:39]
    ds_read_b128 v[116:119], v18 offset:34816
    v_mfma_f32_16x16x32_bf16 v[40:43], v[200:203], v[156:159], v[40:43]
    ds_read_b128 v[120:123], v18 offset:36864
    s_add_u32 s80, s80, 4096
    v_mfma_f32_16x16x32_bf16 v[44:47], v[204:207], v[156:159], v[44:47]
    ds_read_b128 v[124:127], v18 offset:38912
    buffer_load_dwordx4 v[192:195], v8, s[4:7], s80 offen offset:0 sc1
    v_mfma_f32_16x16x32_bf16 v[48:51], v[200:203], v[160:163], v[48:51]
    ds_read_b128 v[128:131], v18 offset:40960
    v_mfma_f32_16x16x32_bf16 v[52:55], v[204:207], v[160:163], v[52:55]
    ds_read_b128 v[132:135], v18 offset:43008
    v_mfma_f32_16x16x32_bf16 v[56:59], v[200:203], v[164:167], v[56:59]
    v_mfma_f32_16x16x32_bf16 v[60:63], v[204:207], v[164:167], v[60:63]
    ds_read_b128 v[136:139], v18 offset:45056
    s_add_u32 s56, s56, 128
    s_add_u32 m0, s81, 73728
    v_mfma_f32_16x16x32_bf16 v[64:67], v[200:203], v[168:171], v[64:67]
    ds_read_b128 v[140:143], v18 offset:47104
    buffer_load_dwordx4 v10, s[44:47], s56 offen nt lds
    v_mfma_f32_16x16x32_bf16 v[68:71], v[204:207], v[168:171], v[68:71]
    ds_read_b64_tr_b16 v[144:145], v24 offset:49152
    v_mfma_f32_16x16x32_bf16 v[72:75], v[200:203], v[172:175], v[72:75]
    ds_read_b64_tr_b16 v[146:147], v24 offset:49664
    v_mfma_f32_16x16x32_bf16 v[76:79], v[204:207], v[172:175], v[76:79]
    ds_read_b64_tr_b16 v[148:149], v25 offset:49152
    v_mfma_f32_16x16x32_bf16 v[80:83], v[200:203], v[176:179], v[80:83]
    ds_read_b64_tr_b16 v[150:151], v25 offset:49664
    buffer_load_dwordx4 v[196:199], v9, s[4:7], s80 offen offset:0 sc1
    v_mfma_f32_16x16x32_bf16 v[84:87], v[204:207], v[176:179], v[84:87]
    v_mfma_f32_16x16x32_bf16 v[88:91], v[200:203], v[180:183], v[88:91]
    v_mfma_f32_16x16x32_bf16 v[92:95], v[204:207], v[180:183], v[92:95]
    v_mfma_f32_16x16x32_bf16 v[96:99], v[184:187], v[200:203], v[96:99]
    s_add_u32 m0, s81, 74752
    v_mfma_f32_16x16x32_bf16 v[100:103], v[184:187], v[204:207], v[100:103]
    buffer_load_dwordx4 v11, s[44:47], s56 offen nt lds
    v_mfma_f32_16x16x32_bf16 v[104:107], v[188:191], v[200:203], v[104:107]
    v_mfma_f32_16x16x32_bf16 v[108:111], v[188:191], v[204:207], v[108:111]
    s_waitcnt vmcnt(23) lgkmcnt(0)
    v_mfma_f32_16x16x32_bf16 v[32:35], v[208:211], v[112:115], v[32:35]
    ds_read_b128 v[152:155], v19 offset:32768
    v_mfma_f32_16x16x32_bf16 v[36:39], v[212:215], v[112:115], v[36:39]
    ds_read_b128 v[156:159], v19 offset:34816
    v_mfma_f32_16x16x32_bf16 v[40:43], v[208:211], v[116:119], v[40:43]
    ds_read_b128 v[160:163], v19 offset:36864
    v_mfma_f32_16x16x32_bf16 v[44:47], v[212:215], v[116:119], v[44:47]
    ds_read_b128 v[164:167], v19 offset:38912
    v_mfma_f32_16x16x32_bf16 v[48:51], v[208:211], v[120:123], v[48:51]
    ds_read_b128 v[168:171], v19 offset:40960
    buffer_load_dwordx4 v[200:203], v8, s[4:7], s80 offen offset:1024 sc1
    v_mfma_f32_16x16x32_bf16 v[52:55], v[212:215], v[120:123], v[52:55]
    ds_read_b128 v[172:175], v19 offset:43008
    v_mfma_f32_16x16x32_bf16 v[56:59], v[208:211], v[124:127], v[56:59]
    v_mfma_f32_16x16x32_bf16 v[60:63], v[212:215], v[124:127], v[60:63]
    ds_read_b128 v[176:179], v19 offset:45056
    v_mfma_f32_16x16x32_bf16 v[64:67], v[208:211], v[128:131], v[64:67]
    ds_read_b128 v[180:183], v19 offset:47104
    v_mfma_f32_16x16x32_bf16 v[68:71], v[212:215], v[128:131], v[68:71]
    ds_read_b64_tr_b16 v[184:185], v24 offset:53248
    s_add_u32 s57, s57, 458752
    s_add_u32 m0, s58, 73728
    v_mfma_f32_16x16x32_bf16 v[72:75], v[208:211], v[132:135], v[72:75]
    ds_read_b64_tr_b16 v[186:187], v24 offset:53760
    buffer_load_dwordx4 v12, s[52:55], s57 offen nt lds
    v_mfma_f32_16x16x32_bf16 v[76:79], v[212:215], v[132:135], v[76:79]
    ds_read_b64_tr_b16 v[188:189], v25 offset:53248
    v_mfma_f32_16x16x32_bf16 v[80:83], v[208:211], v[136:139], v[80:83]
    ds_read_b64_tr_b16 v[190:191], v25 offset:53760
    v_mfma_f32_16x16x32_bf16 v[84:87], v[212:215], v[136:139], v[84:87]
    v_mfma_f32_16x16x32_bf16 v[88:91], v[208:211], v[140:143], v[88:91]
    v_mfma_f32_16x16x32_bf16 v[92:95], v[212:215], v[140:143], v[92:95]
    v_mfma_f32_16x16x32_bf16 v[96:99], v[144:147], v[208:211], v[96:99]
    buffer_load_dwordx4 v[204:207], v9, s[4:7], s80 offen offset:1024 sc1
    v_mfma_f32_16x16x32_bf16 v[100:103], v[144:147], v[212:215], v[100:103]
    v_mfma_f32_16x16x32_bf16 v[104:107], v[148:151], v[208:211], v[104:107]
    v_mfma_f32_16x16x32_bf16 v[108:111], v[148:151], v[212:215], v[108:111]
    s_waitcnt vmcnt(22) lgkmcnt(0)
    s_barrier
    v_mfma_f32_16x16x32_bf16 v[32:35], v[216:219], v[152:155], v[32:35]
    ds_read_b128 v[112:115], v16 offset:0
    v_mfma_f32_16x16x32_bf16 v[36:39], v[220:223], v[152:155], v[36:39]
    ds_read_b128 v[116:119], v16 offset:2048
    v_mfma_f32_16x16x32_bf16 v[40:43], v[216:219], v[156:159], v[40:43]
    ds_read_b128 v[120:123], v16 offset:4096
    v_mfma_f32_16x16x32_bf16 v[44:47], v[220:223], v[156:159], v[44:47]
    ds_read_b128 v[124:127], v16 offset:6144
    buffer_load_dwordx4 v[208:211], v8, s[4:7], s80 offen offset:2048 sc1
    v_mfma_f32_16x16x32_bf16 v[48:51], v[216:219], v[160:163], v[48:51]
    ds_read_b128 v[128:131], v16 offset:8192
    v_mfma_f32_16x16x32_bf16 v[52:55], v[220:223], v[160:163], v[52:55]
    ds_read_b128 v[132:135], v16 offset:10240
    v_mfma_f32_16x16x32_bf16 v[56:59], v[216:219], v[164:167], v[56:59]
    v_mfma_f32_16x16x32_bf16 v[60:63], v[220:223], v[164:167], v[60:63]
    ds_read_b128 v[136:139], v16 offset:12288
    s_add_u32 s56, s56, 128
    s_add_u32 m0, s81, 98304
    v_mfma_f32_16x16x32_bf16 v[64:67], v[216:219], v[168:171], v[64:67]
    ds_read_b128 v[140:143], v16 offset:14336
    buffer_load_dwordx4 v10, s[44:47], s56 offen nt lds
    v_mfma_f32_16x16x32_bf16 v[68:71], v[220:223], v[168:171], v[68:71]
    ds_read_b64_tr_b16 v[144:145], v20 offset:16384
    v_mfma_f32_16x16x32_bf16 v[72:75], v[216:219], v[172:175], v[72:75]
    ds_read_b64_tr_b16 v[146:147], v20 offset:16896
    v_mfma_f32_16x16x32_bf16 v[76:79], v[220:223], v[172:175], v[76:79]
    ds_read_b64_tr_b16 v[148:149], v21 offset:16384
    v_mfma_f32_16x16x32_bf16 v[80:83], v[216:219], v[176:179], v[80:83]
    ds_read_b64_tr_b16 v[150:151], v21 offset:16896
    buffer_load_dwordx4 v[212:215], v9, s[4:7], s80 offen offset:2048 sc1
    v_mfma_f32_16x16x32_bf16 v[84:87], v[220:223], v[176:179], v[84:87]
    v_mfma_f32_16x16x32_bf16 v[88:91], v[216:219], v[180:183], v[88:91]
    v_mfma_f32_16x16x32_bf16 v[92:95], v[220:223], v[180:183], v[92:95]
    v_mfma_f32_16x16x32_bf16 v[96:99], v[184:187], v[216:219], v[96:99]
    s_add_u32 m0, s81, 99328
    v_mfma_f32_16x16x32_bf16 v[100:103], v[184:187], v[220:223], v[100:103]
    buffer_load_dwordx4 v11, s[44:47], s56 offen nt lds
    v_mfma_f32_16x16x32_bf16 v[104:107], v[188:191], v[216:219], v[104:107]
    v_mfma_f32_16x16x32_bf16 v[108:111], v[188:191], v[220:223], v[108:111]
    s_waitcnt vmcnt(23) lgkmcnt(0)
    v_mfma_f32_16x16x32_bf16 v[32:35], a[0:3], v[112:115], v[32:35]
    ds_read_b128 v[152:155], v17 offset:0
    v_mfma_f32_16x16x32_bf16 v[36:39], a[4:7], v[112:115], v[36:39]
    ds_read_b128 v[156:159], v17 offset:2048
    v_mfma_f32_16x16x32_bf16 v[40:43], a[0:3], v[116:119], v[40:43]
    ds_read_b128 v[160:163], v17 offset:4096
    v_mfma_f32_16x16x32_bf16 v[44:47], a[4:7], v[116:119], v[44:47]
    ds_read_b128 v[164:167], v17 offset:6144
    buffer_load_dwordx4 v[216:219], v8, s[4:7], s80 offen offset:3072 sc1
    v_mfma_f32_16x16x32_bf16 v[48:51], a[0:3], v[120:123], v[48:51]
    ds_read_b128 v[168:171], v17 offset:8192
    v_mfma_f32_16x16x32_bf16 v[52:55], a[4:7], v[120:123], v[52:55]
    ds_read_b128 v[172:175], v17 offset:10240
    v_mfma_f32_16x16x32_bf16 v[56:59], a[0:3], v[124:127], v[56:59]
    v_mfma_f32_16x16x32_bf16 v[60:63], a[4:7], v[124:127], v[60:63]
    ds_read_b128 v[176:179], v17 offset:12288
    s_add_u32 s57, s57, 458752
    s_add_u32 m0, s58, 98304
    v_mfma_f32_16x16x32_bf16 v[64:67], a[0:3], v[128:131], v[64:67]
    ds_read_b128 v[180:183], v17 offset:14336
    buffer_load_dwordx4 v12, s[52:55], s57 offen nt lds
    v_mfma_f32_16x16x32_bf16 v[68:71], a[4:7], v[128:131], v[68:71]
    ds_read_b64_tr_b16 v[184:185], v20 offset:20480
    v_mfma_f32_16x16x32_bf16 v[72:75], a[0:3], v[132:135], v[72:75]
    ds_read_b64_tr_b16 v[186:187], v20 offset:20992
    v_mfma_f32_16x16x32_bf16 v[76:79], a[4:7], v[132:135], v[76:79]
    ds_read_b64_tr_b16 v[188:189], v21 offset:20480
    v_mfma_f32_16x16x32_bf16 v[80:83], a[0:3], v[136:139], v[80:83]
    ds_read_b64_tr_b16 v[190:191], v21 offset:20992
    buffer_load_dwordx4 v[220:223], v9, s[4:7], s80 offen offset:3072 sc1
    v_mfma_f32_16x16x32_bf16 v[84:87], a[4:7], v[136:139], v[84:87]
    v_mfma_f32_16x16x32_bf16 v[88:91], a[0:3], v[140:143], v[88:91]
    v_mfma_f32_16x16x32_bf16 v[92:95], a[4:7], v[140:143], v[92:95]
    v_mfma_f32_16x16x32_bf16 v[96:99], v[144:147], a[0:3], v[96:99]
    s_mov_b32 s8, s20
    s_mov_b32 s9, s21
    s_mov_b32 s10, 8388608
    s_mov_b32 s11, 0x20000
    v_mfma_f32_16x16x32_bf16 v[100:103], v[144:147], a[4:7], v[100:103]
    buffer_load_dword v7, v13, s[8:11], 0 offen
    v_mfma_f32_16x16x32_bf16 v[104:107], v[148:151], a[0:3], v[104:107]
    v_mfma_f32_16x16x32_bf16 v[108:111], v[148:151], a[4:7], v[108:111]
    s_waitcnt vmcnt(23) lgkmcnt(0)
    s_barrier
    v_mfma_f32_16x16x32_bf16 v[32:35], a[8:11], v[152:155], v[32:35]
    ds_read_b128 v[112:115], v16 offset:24576
    v_mfma_f32_16x16x32_bf16 v[36:39], a[12:15], v[152:155], v[36:39]
    ds_read_b128 v[116:119], v16 offset:26624
    v_mfma_f32_16x16x32_bf16 v[40:43], a[8:11], v[156:159], v[40:43]
    ds_read_b128 v[120:123], v16 offset:28672
    s_add_u32 s80, s80, 4096
    v_mfma_f32_16x16x32_bf16 v[44:47], a[12:15], v[156:159], v[44:47]
    ds_read_b128 v[124:127], v16 offset:30720
    buffer_load_dwordx4 a[0:3], v8, s[4:7], s80 offen offset:0 sc1
    v_mfma_f32_16x16x32_bf16 v[48:51], a[8:11], v[160:163], v[48:51]
    ds_read_b128 v[128:131], v16 offset:32768
    v_mfma_f32_16x16x32_bf16 v[52:55], a[12:15], v[160:163], v[52:55]
    ds_read_b128 v[132:135], v16 offset:34816
    v_mfma_f32_16x16x32_bf16 v[56:59], a[8:11], v[164:167], v[56:59]
    v_mfma_f32_16x16x32_bf16 v[60:63], a[12:15], v[164:167], v[60:63]
    ds_read_b128 v[136:139], v16 offset:36864
    s_add_u32 s56, s56, 128
    s_add_u32 m0, s81, 0
    v_mfma_f32_16x16x32_bf16 v[64:67], a[8:11], v[168:171], v[64:67]
    ds_read_b128 v[140:143], v16 offset:38912
    buffer_load_dwordx4 v10, s[44:47], s56 offen nt lds
    v_mfma_f32_16x16x32_bf16 v[68:71], a[12:15], v[168:171], v[68:71]
    ds_read_b64_tr_b16 v[144:145], v20 offset:40960
    v_mfma_f32_16x16x32_bf16 v[72:75], a[8:11], v[172:175], v[72:75]
    ds_read_b64_tr_b16 v[146:147], v20 offset:41472
    v_mfma_f32_16x16x32_bf16 v[76:79], a[12:15], v[172:175], v[76:79]
    ds_read_b64_tr_b16 v[148:149], v21 offset:40960
    v_mfma_f32_16x16x32_bf16 v[80:83], a[8:11], v[176:179], v[80:83]
    ds_read_b64_tr_b16 v[150:151], v21 offset:41472
    buffer_load_dwordx4 a[4:7], v9, s[4:7], s80 offen offset:0 sc1
    v_mfma_f32_16x16x32_bf16 v[84:87], a[12:15], v[176:179], v[84:87]
    v_mfma_f32_16x16x32_bf16 v[88:91], a[8:11], v[180:183], v[88:91]
    v_mfma_f32_16x16x32_bf16 v[92:95], a[12:15], v[180:183], v[92:95]
    v_mfma_f32_16x16x32_bf16 v[96:99], v[184:187], a[8:11], v[96:99]
    s_add_u32 m0, s81, 1024
    v_mfma_f32_16x16x32_bf16 v[100:103], v[184:187], a[12:15], v[100:103]
    buffer_load_dwordx4 v11, s[44:47], s56 offen nt lds
    v_mfma_f32_16x16x32_bf16 v[104:107], v[188:191], a[8:11], v[104:107]
    v_mfma_f32_16x16x32_bf16 v[108:111], v[188:191], a[12:15], v[108:111]
    s_waitcnt vmcnt(23) lgkmcnt(0)
    v_mfma_f32_16x16x32_bf16 v[32:35], a[16:19], v[112:115], v[32:35]
    ds_read_b128 v[152:155], v17 offset:24576
    v_mfma_f32_16x16x32_bf16 v[36:39], a[20:23], v[112:115], v[36:39]
    ds_read_b128 v[156:159], v17 offset:26624
    v_mfma_f32_16x16x32_bf16 v[40:43], a[16:19], v[116:119], v[40:43]
    ds_read_b128 v[160:163], v17 offset:28672
    v_mfma_f32_16x16x32_bf16 v[44:47], a[20:23], v[116:119], v[44:47]
    ds_read_b128 v[164:167], v17 offset:30720
    v_mfma_f32_16x16x32_bf16 v[48:51], a[16:19], v[120:123], v[48:51]
    ds_read_b128 v[168:171], v17 offset:32768
    buffer_load_dwordx4 a[8:11], v8, s[4:7], s80 offen offset:1024 sc1
    v_mfma_f32_16x16x32_bf16 v[52:55], a[20:23], v[120:123], v[52:55]
    ds_read_b128 v[172:175], v17 offset:34816
    v_mfma_f32_16x16x32_bf16 v[56:59], a[16:19], v[124:127], v[56:59]
    v_mfma_f32_16x16x32_bf16 v[60:63], a[20:23], v[124:127], v[60:63]
    ds_read_b128 v[176:179], v17 offset:36864
    v_mfma_f32_16x16x32_bf16 v[64:67], a[16:19], v[128:131], v[64:67]
    ds_read_b128 v[180:183], v17 offset:38912
    v_mfma_f32_16x16x32_bf16 v[68:71], a[20:23], v[128:131], v[68:71]
    ds_read_b64_tr_b16 v[184:185], v20 offset:45056
    s_add_u32 s57, s57, 458752
    s_add_u32 m0, s58, 0
    v_mfma_f32_16x16x32_bf16 v[72:75], a[16:19], v[132:135], v[72:75]
    ds_read_b64_tr_b16 v[186:187], v20 offset:45568
    buffer_load_dwordx4 v12, s[52:55], s57 offen nt lds
    v_mfma_f32_16x16x32_bf16 v[76:79], a[20:23], v[132:135], v[76:79]
    ds_read_b64_tr_b16 v[188:189], v21 offset:45056
    v_mfma_f32_16x16x32_bf16 v[80:83], a[16:19], v[136:139], v[80:83]
    ds_read_b64_tr_b16 v[190:191], v21 offset:45568
    v_mfma_f32_16x16x32_bf16 v[84:87], a[20:23], v[136:139], v[84:87]
    v_mfma_f32_16x16x32_bf16 v[88:91], a[16:19], v[140:143], v[88:91]
    v_mfma_f32_16x16x32_bf16 v[92:95], a[20:23], v[140:143], v[92:95]
    v_mfma_f32_16x16x32_bf16 v[96:99], v[144:147], a[16:19], v[96:99]
    buffer_load_dwordx4 a[12:15], v9, s[4:7], s80 offen offset:1024 sc1
    v_mfma_f32_16x16x32_bf16 v[100:103], v[144:147], a[20:23], v[100:103]
    v_mfma_f32_16x16x32_bf16 v[104:107], v[148:151], a[16:19], v[104:107]
    v_mfma_f32_16x16x32_bf16 v[108:111], v[148:151], a[20:23], v[108:111]
    s_waitcnt vmcnt(22) lgkmcnt(0)
    s_barrier
    v_mfma_f32_16x16x32_bf16 v[32:35], a[24:27], v[152:155], v[32:35]
    ds_read_b128 v[112:115], v16 offset:49152
    v_mfma_f32_16x16x32_bf16 v[36:39], a[28:31], v[152:155], v[36:39]
    ds_read_b128 v[116:119], v16 offset:51200
    v_mfma_f32_16x16x32_bf16 v[40:43], a[24:27], v[156:159], v[40:43]
    ds_read_b128 v[120:123], v16 offset:53248
    v_mfma_f32_16x16x32_bf16 v[44:47], a[28:31], v[156:159], v[44:47]
    ds_read_b128 v[124:127], v16 offset:55296
    v_mfma_f32_16x16x32_bf16 v[48:51], a[24:27], v[160:163], v[48:51]
    ds_read_b128 v[128:131], v16 offset:57344
    v_mfma_f32_16x16x32_bf16 v[52:55], a[28:31], v[160:163], v[52:55]
    ds_read_b128 v[132:135], v16 offset:59392
    buffer_load_dwordx4 a[16:19], v8, s[4:7], s80 offen offset:2048 sc1
    v_mfma_f32_16x16x32_bf16 v[56:59], a[24:27], v[164:167], v[56:59]
    v_mfma_f32_16x16x32_bf16 v[60:63], a[28:31], v[164:167], v[60:63]
    ds_read_b128 v[136:139], v16 offset:61440
    v_mfma_f32_16x16x32_bf16 v[64:67], a[24:27], v[168:171], v[64:67]
    ds_read_b128 v[140:143], v16 offset:63488
    v_mfma_f32_16x16x32_bf16 v[68:71], a[28:31], v[168:171], v[68:71]
    ds_read_b64_tr_b16 v[144:145], v24 offset:0
    v_mfma_f32_16x16x32_bf16 v[72:75], a[24:27], v[172:175], v[72:75]
    ds_read_b64_tr_b16 v[146:147], v24 offset:512
    v_mfma_f32_16x16x32_bf16 v[76:79], a[28:31], v[172:175], v[76:79]
    ds_read_b64_tr_b16 v[148:149], v25 offset:0
    v_mfma_f32_16x16x32_bf16 v[80:83], a[24:27], v[176:179], v[80:83]
    ds_read_b64_tr_b16 v[150:151], v25 offset:512
    v_mfma_f32_16x16x32_bf16 v[84:87], a[28:31], v[176:179], v[84:87]
    v_mfma_f32_16x16x32_bf16 v[88:91], a[24:27], v[180:183], v[88:91]
    v_mfma_f32_16x16x32_bf16 v[92:95], a[28:31], v[180:183], v[92:95]
    buffer_load_dwordx4 a[20:23], v9, s[4:7], s80 offen offset:2048 sc1
    v_mfma_f32_16x16x32_bf16 v[96:99], v[184:187], a[24:27], v[96:99]
    v_mfma_f32_16x16x32_bf16 v[100:103], v[184:187], a[28:31], v[100:103]
    v_mfma_f32_16x16x32_bf16 v[104:107], v[188:191], a[24:27], v[104:107]
    v_mfma_f32_16x16x32_bf16 v[108:111], v[188:191], a[28:31], v[108:111]
    s_waitcnt vmcnt(21) lgkmcnt(0)
    v_mfma_f32_16x16x32_bf16 v[32:35], v[192:195], v[112:115], v[32:35]
    ds_read_b128 v[152:155], v17 offset:49152
    v_mfma_f32_16x16x32_bf16 v[36:39], v[196:199], v[112:115], v[36:39]
    ds_read_b128 v[156:159], v17 offset:51200
    v_mfma_f32_16x16x32_bf16 v[40:43], v[192:195], v[116:119], v[40:43]
    ds_read_b128 v[160:163], v17 offset:53248
    v_mfma_f32_16x16x32_bf16 v[44:47], v[196:199], v[116:119], v[44:47]
    ds_read_b128 v[164:167], v17 offset:55296
    v_mfma_f32_16x16x32_bf16 v[48:51], v[192:195], v[120:123], v[48:51]
    ds_read_b128 v[168:171], v17 offset:57344
    v_mfma_f32_16x16x32_bf16 v[52:55], v[196:199], v[120:123], v[52:55]
    ds_read_b128 v[172:175], v17 offset:59392
    buffer_load_dwordx4 a[24:27], v8, s[4:7], s80 offen offset:3072 sc1
    v_mfma_f32_16x16x32_bf16 v[56:59], v[192:195], v[124:127], v[56:59]
    v_mfma_f32_16x16x32_bf16 v[60:63], v[196:199], v[124:127], v[60:63]
    ds_read_b128 v[176:179], v17 offset:61440
    v_mfma_f32_16x16x32_bf16 v[64:67], v[192:195], v[128:131], v[64:67]
    ds_read_b128 v[180:183], v17 offset:63488
    v_mfma_f32_16x16x32_bf16 v[68:71], v[196:199], v[128:131], v[68:71]
    ds_read_b64_tr_b16 v[184:185], v24 offset:4096
    v_mfma_f32_16x16x32_bf16 v[72:75], v[192:195], v[132:135], v[72:75]
    ds_read_b64_tr_b16 v[186:187], v24 offset:4608
    v_mfma_f32_16x16x32_bf16 v[76:79], v[196:199], v[132:135], v[76:79]
    ds_read_b64_tr_b16 v[188:189], v25 offset:4096
    v_mfma_f32_16x16x32_bf16 v[80:83], v[192:195], v[136:139], v[80:83]
    ds_read_b64_tr_b16 v[190:191], v25 offset:4608
    v_mfma_f32_16x16x32_bf16 v[84:87], v[196:199], v[136:139], v[84:87]
    v_mfma_f32_16x16x32_bf16 v[88:91], v[192:195], v[140:143], v[88:91]
    v_mfma_f32_16x16x32_bf16 v[92:95], v[196:199], v[140:143], v[92:95]
    buffer_load_dwordx4 a[28:31], v9, s[4:7], s80 offen offset:3072 sc1
    v_mfma_f32_16x16x32_bf16 v[96:99], v[144:147], v[192:195], v[96:99]
    v_mfma_f32_16x16x32_bf16 v[100:103], v[144:147], v[196:199], v[100:103]
    v_mfma_f32_16x16x32_bf16 v[104:107], v[148:151], v[192:195], v[104:107]
    v_mfma_f32_16x16x32_bf16 v[108:111], v[148:151], v[196:199], v[108:111]
    s_waitcnt vmcnt(19) lgkmcnt(0)
    s_barrier
    v_mfma_f32_16x16x32_bf16 v[32:35], v[200:203], v[152:155], v[32:35]
    ds_read_b128 v[112:115], v18 offset:8192
    v_mfma_f32_16x16x32_bf16 v[36:39], v[204:207], v[152:155], v[36:39]
    ds_read_b128 v[116:119], v18 offset:10240
    v_mfma_f32_16x16x32_bf16 v[40:43], v[200:203], v[156:159], v[40:43]
    ds_read_b128 v[120:123], v18 offset:12288
    v_mfma_f32_16x16x32_bf16 v[44:47], v[204:207], v[156:159], v[44:47]
    ds_read_b128 v[124:127], v18 offset:14336
    v_mfma_f32_16x16x32_bf16 v[48:51], v[200:203], v[160:163], v[48:51]
    ds_read_b128 v[128:131], v18 offset:16384
    v_mfma_f32_16x16x32_bf16 v[52:55], v[204:207], v[160:163], v[52:55]
    ds_read_b128 v[132:135], v18 offset:18432
    v_mfma_f32_16x16x32_bf16 v[56:59], v[200:203], v[164:167], v[56:59]
    v_mfma_f32_16x16x32_bf16 v[60:63], v[204:207], v[164:167], v[60:63]
    ds_read_b128 v[136:139], v18 offset:20480
    v_mfma_f32_16x16x32_bf16 v[64:67], v[200:203], v[168:171], v[64:67]
    ds_read_b128 v[140:143], v18 offset:22528
    v_mfma_f32_16x16x32_bf16 v[68:71], v[204:207], v[168:171], v[68:71]
    ds_read_b64_tr_b16 v[144:145], v24 offset:24576
    v_mfma_f32_16x16x32_bf16 v[72:75], v[200:203], v[172:175], v[72:75]
    ds_read_b64_tr_b16 v[146:147], v24 offset:25088
    v_mfma_f32_16x16x32_bf16 v[76:79], v[204:207], v[172:175], v[76:79]
    ds_read_b64_tr_b16 v[148:149], v25 offset:24576
    v_mfma_f32_16x16x32_bf16 v[80:83], v[200:203], v[176:179], v[80:83]
    ds_read_b64_tr_b16 v[150:151], v25 offset:25088
    v_mfma_f32_16x16x32_bf16 v[84:87], v[204:207], v[176:179], v[84:87]
    v_mfma_f32_16x16x32_bf16 v[88:91], v[200:203], v[180:183], v[88:91]
    v_mfma_f32_16x16x32_bf16 v[92:95], v[204:207], v[180:183], v[92:95]
    v_mfma_f32_16x16x32_bf16 v[96:99], v[184:187], v[200:203], v[96:99]
    v_mfma_f32_16x16x32_bf16 v[100:103], v[184:187], v[204:207], v[100:103]
    v_mfma_f32_16x16x32_bf16 v[104:107], v[188:191], v[200:203], v[104:107]
    v_mfma_f32_16x16x32_bf16 v[108:111], v[188:191], v[204:207], v[108:111]
    s_waitcnt vmcnt(16) lgkmcnt(0)
    v_mfma_f32_16x16x32_bf16 v[32:35], v[208:211], v[112:115], v[32:35]
    ds_read_b128 v[152:155], v19 offset:8192
    v_mfma_f32_16x16x32_bf16 v[36:39], v[212:215], v[112:115], v[36:39]
    ds_read_b128 v[156:159], v19 offset:10240
    v_mfma_f32_16x16x32_bf16 v[40:43], v[208:211], v[116:119], v[40:43]
    ds_read_b128 v[160:163], v19 offset:12288
    v_mfma_f32_16x16x32_bf16 v[44:47], v[212:215], v[116:119], v[44:47]
    ds_read_b128 v[164:167], v19 offset:14336
    v_mfma_f32_16x16x32_bf16 v[48:51], v[208:211], v[120:123], v[48:51]
    ds_read_b128 v[168:171], v19 offset:16384
    v_mfma_f32_16x16x32_bf16 v[52:55], v[212:215], v[120:123], v[52:55]
    ds_read_b128 v[172:175], v19 offset:18432
    v_mfma_f32_16x16x32_bf16 v[56:59], v[208:211], v[124:127], v[56:59]
    v_mfma_f32_16x16x32_bf16 v[60:63], v[212:215], v[124:127], v[60:63]
    ds_read_b128 v[176:179], v19 offset:20480
    v_mfma_f32_16x16x32_bf16 v[64:67], v[208:211], v[128:131], v[64:67]
    ds_read_b128 v[180:183], v19 offset:22528
    v_mfma_f32_16x16x32_bf16 v[68:71], v[212:215], v[128:131], v[68:71]
    ds_read_b64_tr_b16 v[184:185], v24 offset:28672
    s_mov_b32 s8, s32
    s_mov_b32 s9, s33
    s_mov_b32 s10, 7340032
    s_mov_b32 s11, 0x20000
    v_mfma_f32_16x16x32_bf16 v[72:75], v[208:211], v[132:135], v[72:75]
    ds_read_b64_tr_b16 v[186:187], v24 offset:29184
    buffer_load_dword v7, v14, s[8:11], 0 offen
    v_mfma_f32_16x16x32_bf16 v[76:79], v[212:215], v[132:135], v[76:79]
    ds_read_b64_tr_b16 v[188:189], v25 offset:28672
    v_mfma_f32_16x16x32_bf16 v[80:83], v[208:211], v[136:139], v[80:83]
    ds_read_b64_tr_b16 v[190:191], v25 offset:29184
    v_mfma_f32_16x16x32_bf16 v[84:87], v[212:215], v[136:139], v[84:87]
    v_mfma_f32_16x16x32_bf16 v[88:91], v[208:211], v[140:143], v[88:91]
    v_mfma_f32_16x16x32_bf16 v[92:95], v[212:215], v[140:143], v[92:95]
    v_mfma_f32_16x16x32_bf16 v[96:99], v[144:147], v[208:211], v[96:99]
    v_mfma_f32_16x16x32_bf16 v[100:103], v[144:147], v[212:215], v[100:103]
    v_mfma_f32_16x16x32_bf16 v[104:107], v[148:151], v[208:211], v[104:107]
    v_mfma_f32_16x16x32_bf16 v[108:111], v[148:151], v[212:215], v[108:111]
    s_waitcnt vmcnt(13) lgkmcnt(0)
    s_barrier
    v_mfma_f32_16x16x32_bf16 v[32:35], v[216:219], v[152:155], v[32:35]
    ds_read_b128 v[112:115], v18 offset:32768
    v_mfma_f32_16x16x32_bf16 v[36:39], v[220:223], v[152:155], v[36:39]
    ds_read_b128 v[116:119], v18 offset:34816
    v_mfma_f32_16x16x32_bf16 v[40:43], v[216:219], v[156:159], v[40:43]
    ds_read_b128 v[120:123], v18 offset:36864
    v_mfma_f32_16x16x32_bf16 v[44:47], v[220:223], v[156:159], v[44:47]
    ds_read_b128 v[124:127], v18 offset:38912
    v_mfma_f32_16x16x32_bf16 v[48:51], v[216:219], v[160:163], v[48:51]
    ds_read_b128 v[128:131], v18 offset:40960
    v_mfma_f32_16x16x32_bf16 v[52:55], v[220:223], v[160:163], v[52:55]
    ds_read_b128 v[132:135], v18 offset:43008
    v_mfma_f32_16x16x32_bf16 v[56:59], v[216:219], v[164:167], v[56:59]
    v_mfma_f32_16x16x32_bf16 v[60:63], v[220:223], v[164:167], v[60:63]
    ds_read_b128 v[136:139], v18 offset:45056
    v_mfma_f32_16x16x32_bf16 v[64:67], v[216:219], v[168:171], v[64:67]
    ds_read_b128 v[140:143], v18 offset:47104
    v_mfma_f32_16x16x32_bf16 v[68:71], v[220:223], v[168:171], v[68:71]
    ds_read_b64_tr_b16 v[144:145], v24 offset:49152
    v_mfma_f32_16x16x32_bf16 v[72:75], v[216:219], v[172:175], v[72:75]
    ds_read_b64_tr_b16 v[146:147], v24 offset:49664
    v_mfma_f32_16x16x32_bf16 v[76:79], v[220:223], v[172:175], v[76:79]
    ds_read_b64_tr_b16 v[148:149], v25 offset:49152
    v_mfma_f32_16x16x32_bf16 v[80:83], v[216:219], v[176:179], v[80:83]
    ds_read_b64_tr_b16 v[150:151], v25 offset:49664
    v_mfma_f32_16x16x32_bf16 v[84:87], v[220:223], v[176:179], v[84:87]
    v_mfma_f32_16x16x32_bf16 v[88:91], v[216:219], v[180:183], v[88:91]
    v_mfma_f32_16x16x32_bf16 v[92:95], v[220:223], v[180:183], v[92:95]
    v_mfma_f32_16x16x32_bf16 v[96:99], v[184:187], v[216:219], v[96:99]
    v_mfma_f32_16x16x32_bf16 v[100:103], v[184:187], v[220:223], v[100:103]
    v_mfma_f32_16x16x32_bf16 v[104:107], v[188:191], v[216:219], v[104:107]
    v_mfma_f32_16x16x32_bf16 v[108:111], v[188:191], v[220:223], v[108:111]
    s_waitcnt vmcnt(9) lgkmcnt(0)
    v_mfma_f32_16x16x32_bf16 v[32:35], a[0:3], v[112:115], v[32:35]
    ds_read_b128 v[152:155], v19 offset:32768
    v_mfma_f32_16x16x32_bf16 v[36:39], a[4:7], v[112:115], v[36:39]
    ds_read_b128 v[156:159], v19 offset:34816
    v_mfma_f32_16x16x32_bf16 v[40:43], a[0:3], v[116:119], v[40:43]
    ds_read_b128 v[160:163], v19 offset:36864
    v_mfma_f32_16x16x32_bf16 v[44:47], a[4:7], v[116:119], v[44:47]
    ds_read_b128 v[164:167], v19 offset:38912
    v_mfma_f32_16x16x32_bf16 v[48:51], a[0:3], v[120:123], v[48:51]
    ds_read_b128 v[168:171], v19 offset:40960
    v_mfma_f32_16x16x32_bf16 v[52:55], a[4:7], v[120:123], v[52:55]
    ds_read_b128 v[172:175], v19 offset:43008
    v_mfma_f32_16x16x32_bf16 v[56:59], a[0:3], v[124:127], v[56:59]
    v_mfma_f32_16x16x32_bf16 v[60:63], a[4:7], v[124:127], v[60:63]
    ds_read_b128 v[176:179], v19 offset:45056
    v_mfma_f32_16x16x32_bf16 v[64:67], a[0:3], v[128:131], v[64:67]
    ds_read_b128 v[180:183], v19 offset:47104
    v_mfma_f32_16x16x32_bf16 v[68:71], a[4:7], v[128:131], v[68:71]
    ds_read_b64_tr_b16 v[184:185], v24 offset:53248
    v_mfma_f32_16x16x32_bf16 v[72:75], a[0:3], v[132:135], v[72:75]
    ds_read_b64_tr_b16 v[186:187], v24 offset:53760
    v_mfma_f32_16x16x32_bf16 v[76:79], a[4:7], v[132:135], v[76:79]
    ds_read_b64_tr_b16 v[188:189], v25 offset:53248
    v_mfma_f32_16x16x32_bf16 v[80:83], a[0:3], v[136:139], v[80:83]
    ds_read_b64_tr_b16 v[190:191], v25 offset:53760
    v_mfma_f32_16x16x32_bf16 v[84:87], a[4:7], v[136:139], v[84:87]
    v_mfma_f32_16x16x32_bf16 v[88:91], a[0:3], v[140:143], v[88:91]
    v_mfma_f32_16x16x32_bf16 v[92:95], a[4:7], v[140:143], v[92:95]
    v_mfma_f32_16x16x32_bf16 v[96:99], v[144:147], a[0:3], v[96:99]
    v_mfma_f32_16x16x32_bf16 v[100:103], v[144:147], a[4:7], v[100:103]
    v_mfma_f32_16x16x32_bf16 v[104:107], v[148:151], a[0:3], v[104:107]
    v_mfma_f32_16x16x32_bf16 v[108:111], v[148:151], a[4:7], v[108:111]
    s_waitcnt vmcnt(5) lgkmcnt(0)
    s_barrier
    v_mfma_f32_16x16x32_bf16 v[32:35], a[8:11], v[152:155], v[32:35]
    ds_read_b128 v[112:115], v16 offset:0
    v_mfma_f32_16x16x32_bf16 v[36:39], a[12:15], v[152:155], v[36:39]
    ds_read_b128 v[116:119], v16 offset:2048
    v_mfma_f32_16x16x32_bf16 v[40:43], a[8:11], v[156:159], v[40:43]
    ds_read_b128 v[120:123], v16 offset:4096
    v_mfma_f32_16x16x32_bf16 v[44:47], a[12:15], v[156:159], v[44:47]
    ds_read_b128 v[124:127], v16 offset:6144
    v_mfma_f32_16x16x32_bf16 v[48:51], a[8:11], v[160:163], v[48:51]
    ds_read_b128 v[128:131], v16 offset:8192
    v_mfma_f32_16x16x32_bf16 v[52:55], a[12:15], v[160:163], v[52:55]
    ds_read_b128 v[132:135], v16 offset:10240
    v_mfma_f32_16x16x32_bf16 v[56:59], a[8:11], v[164:167], v[56:59]
    v_mfma_f32_16x16x32_bf16 v[60:63], a[12:15], v[164:167], v[60:63]
    ds_read_b128 v[136:139], v16 offset:12288
    v_mfma_f32_16x16x32_bf16 v[64:67], a[8:11], v[168:171], v[64:67]
    ds_read_b128 v[140:143], v16 offset:14336
    v_mfma_f32_16x16x32_bf16 v[68:71], a[12:15], v[168:171], v[68:71]
    ds_read_b64_tr_b16 v[144:145], v20 offset:16384
    v_mfma_f32_16x16x32_bf16 v[72:75], a[8:11], v[172:175], v[72:75]
    ds_read_b64_tr_b16 v[146:147], v20 offset:16896
    v_mfma_f32_16x16x32_bf16 v[76:79], a[12:15], v[172:175], v[76:79]
    ds_read_b64_tr_b16 v[148:149], v21 offset:16384
    v_mfma_f32_16x16x32_bf16 v[80:83], a[8:11], v[176:179], v[80:83]
    ds_read_b64_tr_b16 v[150:151], v21 offset:16896
    v_mfma_f32_16x16x32_bf16 v[84:87], a[12:15], v[176:179], v[84:87]
    v_mfma_f32_16x16x32_bf16 v[88:91], a[8:11], v[180:183], v[88:91]
    v_mfma_f32_16x16x32_bf16 v[92:95], a[12:15], v[180:183], v[92:95]
    v_mfma_f32_16x16x32_bf16 v[96:99], v[184:187], a[8:11], v[96:99]
    v_mfma_f32_16x16x32_bf16 v[100:103], v[184:187], a[12:15], v[100:103]
    v_mfma_f32_16x16x32_bf16 v[104:107], v[188:191], a[8:11], v[104:107]
    v_mfma_f32_16x16x32_bf16 v[108:111], v[188:191], a[12:15], v[108:111]
    s_waitcnt vmcnt(3) lgkmcnt(0)
    v_mfma_f32_16x16x32_bf16 v[32:35], a[16:19], v[112:115], v[32:35]
    ds_read_b128 v[152:155], v17 offset:0
    v_mfma_f32_16x16x32_bf16 v[36:39], a[20:23], v[112:115], v[36:39]
    ds_read_b128 v[156:159], v17 offset:2048
    v_mfma_f32_16x16x32_bf16 v[40:43], a[16:19], v[116:119], v[40:43]
    ds_read_b128 v[160:163], v17 offset:4096
    v_mfma_f32_16x16x32_bf16 v[44:47], a[20:23], v[116:119], v[44:47]
    ds_read_b128 v[164:167], v17 offset:6144
    v_mfma_f32_16x16x32_bf16 v[48:51], a[16:19], v[120:123], v[48:51]
    ds_read_b128 v[168:171], v17 offset:8192
    v_mfma_f32_16x16x32_bf16 v[52:55], a[20:23], v[120:123], v[52:55]
    ds_read_b128 v[172:175], v17 offset:10240
    v_mfma_f32_16x16x32_bf16 v[56:59], a[16:19], v[124:127], v[56:59]
    v_mfma_f32_16x16x32_bf16 v[60:63], a[20:23], v[124:127], v[60:63]
    ds_read_b128 v[176:179], v17 offset:12288
    v_mfma_f32_16x16x32_bf16 v[64:67], a[16:19], v[128:131], v[64:67]
    ds_read_b128 v[180:183], v17 offset:14336
    v_mfma_f32_16x16x32_bf16 v[68:71], a[20:23], v[128:131], v[68:71]
    ds_read_b64_tr_b16 v[184:185], v20 offset:20480
    v_mfma_f32_16x16x32_bf16 v[72:75], a[16:19], v[132:135], v[72:75]
    ds_read_b64_tr_b16 v[186:187], v20 offset:20992
    v_mfma_f32_16x16x32_bf16 v[76:79], a[20:23], v[132:135], v[76:79]
    ds_read_b64_tr_b16 v[188:189], v21 offset:20480
    v_mfma_f32_16x16x32_bf16 v[80:83], a[16:19], v[136:139], v[80:83]
    ds_read_b64_tr_b16 v[190:191], v21 offset:20992
    v_mfma_f32_16x16x32_bf16 v[84:87], a[20:23], v[136:139], v[84:87]
    v_mfma_f32_16x16x32_bf16 v[88:91], a[16:19], v[140:143], v[88:91]
    v_mfma_f32_16x16x32_bf16 v[92:95], a[20:23], v[140:143], v[92:95]
    v_mfma_f32_16x16x32_bf16 v[96:99], v[144:147], a[16:19], v[96:99]
    v_mfma_f32_16x16x32_bf16 v[100:103], v[144:147], a[20:23], v[100:103]
    v_mfma_f32_16x16x32_bf16 v[104:107], v[148:151], a[16:19], v[104:107]
    v_mfma_f32_16x16x32_bf16 v[108:111], v[148:151], a[20:23], v[108:111]
    s_waitcnt vmcnt(1) lgkmcnt(0)
    v_mfma_f32_16x16x32_bf16 v[32:35], a[24:27], v[152:155], v[32:35]
    v_mfma_f32_16x16x32_bf16 v[36:39], a[28:31], v[152:155], v[36:39]
    v_mfma_f32_16x16x32_bf16 v[40:43], a[24:27], v[156:159], v[40:43]
    v_mfma_f32_16x16x32_bf16 v[44:47], a[28:31], v[156:159], v[44:47]
    v_mfma_f32_16x16x32_bf16 v[48:51], a[24:27], v[160:163], v[48:51]
    v_mfma_f32_16x16x32_bf16 v[52:55], a[28:31], v[160:163], v[52:55]
    v_mfma_f32_16x16x32_bf16 v[56:59], a[24:27], v[164:167], v[56:59]
    v_mfma_f32_16x16x32_bf16 v[60:63], a[28:31], v[164:167], v[60:63]
    v_mfma_f32_16x16x32_bf16 v[64:67], a[24:27], v[168:171], v[64:67]
    v_mfma_f32_16x16x32_bf16 v[68:71], a[28:31], v[168:171], v[68:71]
    v_mfma_f32_16x16x32_bf16 v[72:75], a[24:27], v[172:175], v[72:75]
    v_mfma_f32_16x16x32_bf16 v[76:79], a[28:31], v[172:175], v[76:79]
    v_mfma_f32_16x16x32_bf16 v[80:83], a[24:27], v[176:179], v[80:83]
    v_mfma_f32_16x16x32_bf16 v[84:87], a[28:31], v[176:179], v[84:87]
    v_mfma_f32_16x16x32_bf16 v[88:91], a[24:27], v[180:183], v[88:91]
    v_mfma_f32_16x16x32_bf16 v[92:95], a[28:31], v[180:183], v[92:95]
    v_mfma_f32_16x16x32_bf16 v[96:99], v[184:187], a[24:27], v[96:99]
    v_mfma_f32_16x16x32_bf16 v[100:103], v[184:187], a[28:31], v[100:103]
    v_mfma_f32_16x16x32_bf16 v[104:107], v[188:191], a[24:27], v[104:107]
    v_mfma_f32_16x16x32_bf16 v[108:111], v[188:191], a[28:31], v[108:111]
    s_barrier
    s_add_u32 m0, s69, 0
    s_nop 0
    buffer_load_dwordx4 v28, s[64:67], s68 offen lds
    s_add_u32 m0, s69, 1024
    s_nop 0
    buffer_load_dwordx4 v29, s[64:67], s68 offen lds
    s_add_u32 m0, s69, 2048
    s_nop 0
    buffer_load_dwordx4 v30, s[64:67], s68 offen lds
    s_add_u32 m0, s69, 3072
    s_nop 0
    buffer_load_dwordx4 v31, s[64:67], s68 offen lds
    s_add_u32 s68, s68, 128
    s_add_u32 m0, s69, 32768
    s_nop 0
    buffer_load_dwordx4 v28, s[64:67], s68 offen lds
    s_add_u32 m0, s69, 33792
    s_nop 0
    buffer_load_dwordx4 v29, s[64:67], s68 offen lds
    s_add_u32 m0, s69, 34816
    s_nop 0
    buffer_load_dwordx4 v30, s[64:67], s68 offen lds
    s_add_u32 m0, s69, 35840
    s_nop 0
    buffer_load_dwordx4 v31, s[64:67], s68 offen lds
    s_add_u32 s68, s68, 128
    s_add_u32 m0, s69, 65536
    s_nop 0
    buffer_load_dwordx4 v28, s[64:67], s68 offen lds
    s_add_u32 m0, s69, 66560
    s_nop 0
    buffer_load_dwordx4 v29, s[64:67], s68 offen lds
    s_add_u32 m0, s69, 67584
    s_nop 0
    buffer_load_dwordx4 v30, s[64:67], s68 offen lds
    s_add_u32 m0, s69, 68608
    s_nop 0
    buffer_load_dwordx4 v31, s[64:67], s68 offen lds
    s_add_u32 s8, s40, 4194304
    s_addc_u32 s9, s41, 0
    s_mov_b32 s10, 8388608
    s_mov_b32 s11, 0x20000
    v_lshrrev_b32 v2, 4, v1
    v_and_b32 v3, 1, v2
    v_lshlrev_b32 v3, 1, v3
    v_lshrrev_b32 v2, 1, v2
    v_or_b32 v2, v2, v3
    v_lshlrev_b32 v2, 8, v2
    v_and_b32 v3, 15, v1
    v_lshl_add_u32 v2, v3, 4, v2
    s_lshl_b32 s86, s83, 3
    s_add_u32 s86, s86, s3
    s_lshr_b32 s87, s84, 3
    s_lshl_b32 s87, s87, 6
    s_add_u32 s86, s86, s87
    s_and_b32 s87, s84, 7
    s_lshl_b32 s87, s87, 10
    s_add_u32 s86, s86, s87
    s_lshl_b32 s86, s86, 10
    v_add_u32 v2, s86, v2
    v_cvt_pk_bf16_f32 v112, v32, v33
    v_cvt_pk_bf16_f32 v113, v34, v35
    v_cvt_pk_bf16_f32 v114, v36, v37
    v_cvt_pk_bf16_f32 v115, v38, v39
    s_mov_b32 s87, 0
    s_nop 0
    v_permlane16_swap_b32 v112, v114
    v_permlane16_swap_b32 v113, v115
    buffer_store_dwordx4 v[112:115], v2, s[8:11], s87 offen sc1
    v_cvt_pk_bf16_f32 v116, v40, v41
    v_cvt_pk_bf16_f32 v117, v42, v43
    v_cvt_pk_bf16_f32 v118, v44, v45
    v_cvt_pk_bf16_f32 v119, v46, v47
    s_mov_b32 s87, 131072
    s_nop 0
    v_permlane16_swap_b32 v116, v118
    v_permlane16_swap_b32 v117, v119
    buffer_store_dwordx4 v[116:119], v2, s[8:11], s87 offen sc1
    v_cvt_pk_bf16_f32 v120, v48, v49
    v_cvt_pk_bf16_f32 v121, v50, v51
    v_cvt_pk_bf16_f32 v122, v52, v53
    v_cvt_pk_bf16_f32 v123, v54, v55
    s_mov_b32 s87, 262144
    s_nop 0
    v_permlane16_swap_b32 v120, v122
    v_permlane16_swap_b32 v121, v123
    buffer_store_dwordx4 v[120:123], v2, s[8:11], s87 offen sc1
    v_cvt_pk_bf16_f32 v124, v56, v57
    v_cvt_pk_bf16_f32 v125, v58, v59
    v_cvt_pk_bf16_f32 v126, v60, v61
    v_cvt_pk_bf16_f32 v127, v62, v63
    s_mov_b32 s87, 393216
    s_nop 0
    v_permlane16_swap_b32 v124, v126
    v_permlane16_swap_b32 v125, v127
    buffer_store_dwordx4 v[124:127], v2, s[8:11], s87 offen sc1
    v_cvt_pk_bf16_f32 v128, v64, v65
    v_cvt_pk_bf16_f32 v129, v66, v67
    v_cvt_pk_bf16_f32 v130, v68, v69
    v_cvt_pk_bf16_f32 v131, v70, v71
    s_mov_b32 s87, 524288
    s_nop 0
    v_permlane16_swap_b32 v128, v130
    v_permlane16_swap_b32 v129, v131
    buffer_store_dwordx4 v[128:131], v2, s[8:11], s87 offen sc1
    v_cvt_pk_bf16_f32 v132, v72, v73
    v_cvt_pk_bf16_f32 v133, v74, v75
    v_cvt_pk_bf16_f32 v134, v76, v77
    v_cvt_pk_bf16_f32 v135, v78, v79
    s_mov_b32 s87, 655360
    s_nop 0
    v_permlane16_swap_b32 v132, v134
    v_permlane16_swap_b32 v133, v135
    buffer_store_dwordx4 v[132:135], v2, s[8:11], s87 offen sc1
    v_cvt_pk_bf16_f32 v136, v80, v81
    v_cvt_pk_bf16_f32 v137, v82, v83
    v_cvt_pk_bf16_f32 v138, v84, v85
    v_cvt_pk_bf16_f32 v139, v86, v87
    s_mov_b32 s87, 786432
    s_nop 0
    v_permlane16_swap_b32 v136, v138
    v_permlane16_swap_b32 v137, v139
    buffer_store_dwordx4 v[136:139], v2, s[8:11], s87 offen sc1
    v_cvt_pk_bf16_f32 v140, v88, v89
    v_cvt_pk_bf16_f32 v141, v90, v91
    v_cvt_pk_bf16_f32 v142, v92, v93
    v_cvt_pk_bf16_f32 v143, v94, v95
    s_mov_b32 s87, 917504
    s_nop 0
    v_permlane16_swap_b32 v140, v142
    v_permlane16_swap_b32 v141, v143
    buffer_store_dwordx4 v[140:143], v2, s[8:11], s87 offen sc1
    s_nop 1
    s_add_u32 s8, s40, 12582912
    s_addc_u32 s9, s41, 0
    s_mov_b32 s10, 14680064
    s_mov_b32 s11, 0x20000
    v_lshrrev_b32 v2, 4, v1
    s_lshl_b32 s87, s3, 10
    s_add_u32 s87, s87, 131072
    v_lshlrev_b32 v3, 3, v2
    v_add_u32 v3, s87, v3
    ds_read_b64 v[8:9], v3 offset:0
    ds_read_b64 v[10:11], v3 offset:32
    s_mov_b32 s90, 0xbdd2d3e8
    v_mov_b32 v5, 0xc0135761
    v_and_b32 v3, 1, v2
    v_lshlrev_b32 v3, 1, v3
    v_lshrrev_b32 v4, 1, v2
    v_or_b32 v3, v3, v4
    v_lshlrev_b32 v3, 8, v3
    v_and_b32 v4, 15, v1
    v_lshl_add_u32 v4, v4, 4, v3
    s_lshl_b32 s86, s83, 4
    s_lshl_b32 s87, s3, 1
    s_add_u32 s86, s86, s87
    s_mul_i32 s86, s86, 114688
    s_lshl_b32 s87, s85, 5
    s_add_u32 s86, s86, s87
    s_mov_b32 s91, s90
    v_mov_b32 v2, v5
    v_mov_b32 v3, v5
    s_waitcnt lgkmcnt(0)
    v_lshlrev_b32 v144, 16, v8
    v_and_b32 v145, 0xffff0000, v8
    v_lshlrev_b32 v146, 16, v9
    v_and_b32 v147, 0xffff0000, v9
    v_lshlrev_b32 v148, 16, v10
    v_and_b32 v149, 0xffff0000, v10
    v_lshlrev_b32 v150, 16, v11
    v_and_b32 v151, 0xffff0000, v11
    v_cvt_pk_bf16_f32 v152, v96, v97
    v_cvt_pk_bf16_f32 v153, v98, v99
    v_cvt_pk_bf16_f32 v154, v104, v105
    v_cvt_pk_bf16_f32 v155, v106, v107
    v_cvt_pk_bf16_f32 v156, v100, v101
    v_cvt_pk_bf16_f32 v157, v102, v103
    v_cvt_pk_bf16_f32 v158, v108, v109
    v_cvt_pk_bf16_f32 v159, v110, v111
    v_lshlrev_b32 v160, 16, v152
    v_and_b32 v161, 0xffff0000, v152
    v_lshlrev_b32 v162, 16, v153
    v_and_b32 v163, 0xffff0000, v153
    v_lshlrev_b32 v164, 16, v154
    v_and_b32 v165, 0xffff0000, v154
    v_lshlrev_b32 v166, 16, v155
    v_and_b32 v167, 0xffff0000, v155
    v_lshlrev_b32 v168, 16, v156
    v_and_b32 v169, 0xffff0000, v156
    v_lshlrev_b32 v170, 16, v157
    v_and_b32 v171, 0xffff0000, v157
    v_lshlrev_b32 v172, 16, v158
    v_and_b32 v173, 0xffff0000, v158
    v_lshlrev_b32 v174, 16, v159
    v_and_b32 v175, 0xffff0000, v159
    v_pk_add_f32 v[160:161], v[160:161], v[144:145]
    v_pk_add_f32 v[162:163], v[162:163], v[146:147]
    v_pk_add_f32 v[164:165], v[164:165], v[148:149]
    v_pk_add_f32 v[166:167], v[166:167], v[150:151]
    v_pk_add_f32 v[168:169], v[168:169], v[144:145]
    v_pk_add_f32 v[170:171], v[170:171], v[146:147]
    v_pk_add_f32 v[172:173], v[172:173], v[148:149]
    v_pk_add_f32 v[174:175], v[174:175], v[150:151]
    v_cvt_pk_bf16_f32 v152, v160, v161
    v_cvt_pk_bf16_f32 v153, v162, v163
    v_cvt_pk_bf16_f32 v154, v164, v165
    v_cvt_pk_bf16_f32 v155, v166, v167
    v_cvt_pk_bf16_f32 v156, v168, v169
    v_cvt_pk_bf16_f32 v157, v170, v171
    v_cvt_pk_bf16_f32 v158, v172, v173
    v_cvt_pk_bf16_f32 v159, v174, v175
    v_lshlrev_b32 v160, 16, v152
    v_and_b32 v161, 0xffff0000, v152
    v_lshlrev_b32 v162, 16, v153
    v_and_b32 v163, 0xffff0000, v153
    v_lshlrev_b32 v164, 16, v154
    v_and_b32 v165, 0xffff0000, v154
    v_lshlrev_b32 v166, 16, v155
    v_and_b32 v167, 0xffff0000, v155
    v_lshlrev_b32 v168, 16, v156
    v_and_b32 v169, 0xffff0000, v156
    v_lshlrev_b32 v170, 16, v157
    v_and_b32 v171, 0xffff0000, v157
    v_lshlrev_b32 v172, 16, v158
    v_and_b32 v173, 0xffff0000, v158
    v_lshlrev_b32 v174, 16, v159
    v_and_b32 v175, 0xffff0000, v159
    v_pk_mul_f32 v[176:177], v[160:161], v[160:161]
    v_pk_mul_f32 v[178:179], v[162:163], v[162:163]
    v_pk_mul_f32 v[180:181], v[164:165], v[164:165]
    v_pk_mul_f32 v[182:183], v[166:167], v[166:167]
    v_pk_mul_f32 v[184:185], v[168:169], v[168:169]
    v_pk_mul_f32 v[186:187], v[170:171], v[170:171]
    v_pk_mul_f32 v[188:189], v[172:173], v[172:173]
    v_pk_mul_f32 v[190:191], v[174:175], v[174:175]
    v_pk_fma_f32 v[176:177], v[176:177], s[90:91], v[2:3]
    v_pk_fma_f32 v[178:179], v[178:179], s[90:91], v[2:3]
    v_pk_fma_f32 v[180:181], v[180:181], s[90:91], v[2:3]
    v_pk_fma_f32 v[182:183], v[182:183], s[90:91], v[2:3]
    v_pk_fma_f32 v[184:185], v[184:185], s[90:91], v[2:3]
    v_pk_fma_f32 v[186:187], v[186:187], s[90:91], v[2:3]
    v_pk_fma_f32 v[188:189], v[188:189], s[90:91], v[2:3]
    v_pk_fma_f32 v[190:191], v[190:191], s[90:91], v[2:3]
    v_pk_mul_f32 v[176:177], v[176:177], v[160:161]
    v_pk_mul_f32 v[178:179], v[178:179], v[162:163]
    v_pk_mul_f32 v[180:181], v[180:181], v[164:165]
    v_pk_mul_f32 v[182:183], v[182:183], v[166:167]
    v_pk_mul_f32 v[184:185], v[184:185], v[168:169]
    v_pk_mul_f32 v[186:187], v[186:187], v[170:171]
    v_pk_mul_f32 v[188:189], v[188:189], v[172:173]
    v_pk_mul_f32 v[190:191], v[190:191], v[174:175]
    v_exp_f32 v176, v176
    v_exp_f32 v177, v177
    v_exp_f32 v178, v178
    v_exp_f32 v179, v179
    v_exp_f32 v180, v180
    v_exp_f32 v181, v181
    v_exp_f32 v182, v182
    v_exp_f32 v183, v183
    v_exp_f32 v184, v184
    v_exp_f32 v185, v185
    v_exp_f32 v186, v186
    v_exp_f32 v187, v187
    v_exp_f32 v188, v188
    v_exp_f32 v189, v189
    v_exp_f32 v190, v190
    v_exp_f32 v191, v191
    v_pk_add_f32 v[176:177], v[176:177], 1.0 op_sel_hi:[1,0]
    v_pk_add_f32 v[178:179], v[178:179], 1.0 op_sel_hi:[1,0]
    v_pk_add_f32 v[180:181], v[180:181], 1.0 op_sel_hi:[1,0]
    v_pk_add_f32 v[182:183], v[182:183], 1.0 op_sel_hi:[1,0]
    v_pk_add_f32 v[184:185], v[184:185], 1.0 op_sel_hi:[1,0]
    v_pk_add_f32 v[186:187], v[186:187], 1.0 op_sel_hi:[1,0]
    v_pk_add_f32 v[188:189], v[188:189], 1.0 op_sel_hi:[1,0]
    v_pk_add_f32 v[190:191], v[190:191], 1.0 op_sel_hi:[1,0]
    v_rcp_f32 v176, v176
    v_rcp_f32 v177, v177
    v_rcp_f32 v178, v178
    v_rcp_f32 v179, v179
    v_rcp_f32 v180, v180
    v_rcp_f32 v181, v181
    v_rcp_f32 v182, v182
    v_rcp_f32 v183, v183
    v_rcp_f32 v184, v184
    v_rcp_f32 v185, v185
    v_rcp_f32 v186, v186
    v_rcp_f32 v187, v187
    v_rcp_f32 v188, v188
    v_rcp_f32 v189, v189
    v_rcp_f32 v190, v190
    v_rcp_f32 v191, v191
    v_pk_mul_f32 v[176:177], v[176:177], v[160:161]
    v_pk_mul_f32 v[178:179], v[178:179], v[162:163]
    v_pk_mul_f32 v[180:181], v[180:181], v[164:165]
    v_pk_mul_f32 v[182:183], v[182:183], v[166:167]
    v_pk_mul_f32 v[184:185], v[184:185], v[168:169]
    v_pk_mul_f32 v[186:187], v[186:187], v[170:171]
    v_pk_mul_f32 v[188:189], v[188:189], v[172:173]
    v_pk_mul_f32 v[190:191], v[190:191], v[174:175]
    v_cvt_pk_bf16_f32 v152, v176, v177
    v_cvt_pk_bf16_f32 v153, v178, v179
    v_cvt_pk_bf16_f32 v154, v180, v181
    v_cvt_pk_bf16_f32 v155, v182, v183
    v_cvt_pk_bf16_f32 v156, v184, v185
    v_cvt_pk_bf16_f32 v157, v186, v187
    v_cvt_pk_bf16_f32 v158, v188, v189
    v_cvt_pk_bf16_f32 v159, v190, v191
    s_add_u32 s87, s86, 0
    s_nop 0
    v_permlane16_swap_b32 v152, v154
    v_permlane16_swap_b32 v153, v155
    buffer_store_dwordx4 v[152:155], v4, s[8:11], s87 offen sc1
    s_add_u32 s87, s86, 114688
    v_permlane16_swap_b32 v156, v158
    v_permlane16_swap_b32 v157, v159
    buffer_store_dwordx4 v[156:159], v4, s[8:11], s87 offen sc1
    s_waitcnt vmcnt(0)
    s_barrier
    s_cmp_lg_u32 s3, 0
    s_cbranch_scc1 sf_1
    v_mov_b32 v6, s78
    v_mov_b32 v7, s79
    s_mov_b64 exec, 1
    s_lshl_b32 s86, s84, 7
    s_lshl_b32 s87, s83, 3
    s_add_u32 s86, s86, s87
    s_add_u32 s86, s86, 4096
    v_mov_b32 v5, s86
    buffer_store_dwordx2 v[6:7], v5, s[48:51], 0 offen sc1
    s_lshl_b32 s86, s83, 8
    s_lshl_b32 s87, s84, 3
    s_add_u32 s86, s86, s87
    s_add_u32 s86, s86, 8192
    v_mov_b32 v5, s86
    buffer_store_dwordx2 v[6:7], v5, s[48:51], 0 offen sc1
    s_mov_b64 exec, -1
sf_1:
    s_lshl_b32 s80, s72, 16
    s_add_u32 s4, s40, 4194304
    s_addc_u32 s5, s41, 0
    s_mov_b32 s6, 8388608
    s_mov_b32 s7, 0x20000
    s_lshl_b32 s86, s70, 3
    s_lshl_b32 s87, s76, 1
    s_add_u32 s86, s86, s87
    s_lshl_b32 s86, s86, 17
    v_lshlrev_b32 v8, 4, v1
    v_add_u32 v8, s86, v8
    v_add_u32 v9, 131072, v8
    s_lshl_b32 s86, s72, 14
    v_and_b32 v2, 15, v1
    v_lshrrev_b32 v3, 1, v2
    v_lshrrev_b32 v20, 4, v1
    v_xor_b32 v3, v3, v20
    v_lshlrev_b32 v3, 4, v3
    v_lshl_add_u32 v20, v2, 7, v3
    v_xor_b32 v21, 64, v20
    v_add_u32 v20, s86, v20
    v_add_u32 v21, s86, v21
    v_and_b32 v2, 15, v1
    v_lshrrev_b32 v3, 1, v2
    v_lshrrev_b32 v22, 4, v1
    v_xor_b32 v3, v3, v22
    v_lshlrev_b32 v3, 4, v3
    v_lshl_add_u32 v22, v2, 7, v3
    v_add_u32 v22, 65536, v22
    v_xor_b32 v23, 64, v22
    v_add_u32 v22, s86, v22
    v_add_u32 v23, s86, v23
    s_cmp_lg_u32 s3, 0
    s_cbranch_scc1 kf_Y2_w
    v_bfe_u32 v3, v1, 3, 1
    v_lshlrev_b32 v3, 10, v3
    v_and_b32 v2, 7, v1
    v_lshl_add_u32 v2, v2, 3, v3
    s_lshl_b32 s86, s70, 7
    s_add_u32 s86, s86, 4096
    v_add_u32 v2, s86, v2
    s_mov_b32 s93, 400000
kf_Y2_p:
    buffer_load_dwordx2 v[4:5], v2, s[48:51], 0 offen sc1
    s_waitcnt vmcnt(0)
    v_cmp_ne_u64 vcc, s[78:79], v[4:5]
    s_cbranch_vccz kf_Y2_w
    s_sleep 1
    s_sub_u32 s93, s93, 1
    s_cmp_lg_u32 s93, 0
    s_cbranch_scc1 kf_Y2_p
kf_Y2_w:
    s_barrier
    buffer_load_dwordx4 v[160:163], v8, s[4:7], s80 offen offset:0 sc1
    buffer_load_dwordx4 v[164:167], v9, s[4:7], s80 offen offset:0 sc1
    buffer_load_dwordx4 v[168:171], v8, s[4:7], s80 offen offset:1024 sc1
    buffer_load_dwordx4 v[172:175], v9, s[4:7], s80 offen offset:1024 sc1
    s_waitcnt vmcnt(12)
    s_barrier
    buffer_load_dwordx4 v[176:179], v8, s[4:7], s80 offen offset:2048 sc1
    s_add_u32 s68, s68, 128
    s_add_u32 m0, s69, 98304
    s_nop 0
    buffer_load_dwordx4 v28, s[64:67], s68 offen lds
    buffer_load_dwordx4 v[180:183], v9, s[4:7], s80 offen offset:2048 sc1
    s_add_u32 m0, s69, 99328
    s_nop 0
    buffer_load_dwordx4 v29, s[64:67], s68 offen lds
    ds_read_b128 v[96:99], v20 offset:0
    ds_read_b128 v[100:103], v20 offset:2048
    ds_read_b128 v[104:107], v20 offset:4096
    ds_read_b128 v[108:111], v20 offset:6144
    ds_read_b128 v[112:115], v20 offset:8192
    ds_read_b128 v[116:119], v20 offset:10240
    ds_read_b128 v[120:123], v20 offset:12288
    ds_read_b128 v[124:127], v20 offset:14336
    s_waitcnt vmcnt(6) lgkmcnt(0)
    v_mfma_f32_16x16x32_bf16 v[32:35], v[160:163], v[96:99], 0
    ds_read_b128 v[128:131], v21 offset:0
    v_mfma_f32_16x16x32_bf16 v[64:67], v[164:167], v[96:99], 0
    ds_read_b128 v[132:135], v21 offset:2048
    v_mfma_f32_16x16x32_bf16 v[36:39], v[160:163], v[100:103], 0
    ds_read_b128 v[136:139], v21 offset:4096
    buffer_load_dwordx4 v[184:187], v8, s[4:7], s80 offen offset:3072 sc1
    v_mfma_f32_16x16x32_bf16 v[68:71], v[164:167], v[100:103], 0
    v_mfma_f32_16x16x32_bf16 v[40:43], v[160:163], v[104:107], 0
    ds_read_b128 v[140:143], v21 offset:6144
    v_mfma_f32_16x16x32_bf16 v[72:75], v[164:167], v[104:107], 0
    ds_read_b128 v[144:147], v21 offset:8192
    s_add_u32 m0, s69, 100352
    v_mfma_f32_16x16x32_bf16 v[44:47], v[160:163], v[108:111], 0
    ds_read_b128 v[148:151], v21 offset:10240
    buffer_load_dwordx4 v30, s[64:67], s68 offen lds
    v_mfma_f32_16x16x32_bf16 v[76:79], v[164:167], v[108:111], 0
    v_mfma_f32_16x16x32_bf16 v[48:51], v[160:163], v[112:115], 0
    ds_read_b128 v[152:155], v21 offset:12288
    v_mfma_f32_16x16x32_bf16 v[80:83], v[164:167], v[112:115], 0
    ds_read_b128 v[156:159], v21 offset:14336
    v_mfma_f32_16x16x32_bf16 v[52:55], v[160:163], v[116:119], 0
    buffer_load_dwordx4 v[188:191], v9, s[4:7], s80 offen offset:3072 sc1
    v_mfma_f32_16x16x32_bf16 v[84:87], v[164:167], v[116:119], 0
    v_mfma_f32_16x16x32_bf16 v[56:59], v[160:163], v[120:123], 0
    v_mfma_f32_16x16x32_bf16 v[88:91], v[164:167], v[120:123], 0
    s_add_u32 m0, s69, 101376
    v_mfma_f32_16x16x32_bf16 v[60:63], v[160:163], v[124:127], 0
    buffer_load_dwordx4 v31, s[64:67], s68 offen lds
    v_mfma_f32_16x16x32_bf16 v[92:95], v[164:167], v[124:127], 0
    s_waitcnt vmcnt(8) lgkmcnt(0)
    s_barrier
    v_mfma_f32_16x16x32_bf16 v[32:35], v[168:171], v[128:131], v[32:35]
    ds_read_b128 v[96:99], v20 offset:32768
    v_mfma_f32_16x16x32_bf16 v[64:67], v[172:175], v[128:131], v[64:67]
    ds_read_b128 v[100:103], v20 offset:34816
    s_add_u32 s80, s80, 4096
    v_mfma_f32_16x16x32_bf16 v[36:39], v[168:171], v[132:135], v[36:39]
    ds_read_b128 v[104:107], v20 offset:36864
    buffer_load_dwordx4 v[160:163], v8, s[4:7], s80 offen offset:0 sc1
    v_mfma_f32_16x16x32_bf16 v[68:71], v[172:175], v[132:135], v[68:71]
    v_mfma_f32_16x16x32_bf16 v[40:43], v[168:171], v[136:139], v[40:43]
    ds_read_b128 v[108:111], v20 offset:38912
    v_mfma_f32_16x16x32_bf16 v[72:75], v[172:175], v[136:139], v[72:75]
    ds_read_b128 v[112:115], v20 offset:40960
    s_add_u32 s68, s68, 128
    s_add_u32 m0, s69, 0
    v_mfma_f32_16x16x32_bf16 v[44:47], v[168:171], v[140:143], v[44:47]
    ds_read_b128 v[116:119], v20 offset:43008
    buffer_load_dwordx4 v28, s[64:67], s68 offen lds
    v_mfma_f32_16x16x32_bf16 v[76:79], v[172:175], v[140:143], v[76:79]
    v_mfma_f32_16x16x32_bf16 v[48:51], v[168:171], v[144:147], v[48:51]
    ds_read_b128 v[120:123], v20 offset:45056
    v_mfma_f32_16x16x32_bf16 v[80:83], v[172:175], v[144:147], v[80:83]
    ds_read_b128 v[124:127], v20 offset:47104
    v_mfma_f32_16x16x32_bf16 v[52:55], v[168:171], v[148:151], v[52:55]
    buffer_load_dwordx4 v[164:167], v9, s[4:7], s80 offen offset:0 sc1
    v_mfma_f32_16x16x32_bf16 v[84:87], v[172:175], v[148:151], v[84:87]
    v_mfma_f32_16x16x32_bf16 v[56:59], v[168:171], v[152:155], v[56:59]
    v_mfma_f32_16x16x32_bf16 v[88:91], v[172:175], v[152:155], v[88:91]
    s_add_u32 m0, s69, 1024
    v_mfma_f32_16x16x32_bf16 v[60:63], v[168:171], v[156:159], v[60:63]
    buffer_load_dwordx4 v29, s[64:67], s68 offen lds
    v_mfma_f32_16x16x32_bf16 v[92:95], v[172:175], v[156:159], v[92:95]
    s_waitcnt vmcnt(9) lgkmcnt(0)
    v_mfma_f32_16x16x32_bf16 v[32:35], v[176:179], v[96:99], v[32:35]
    ds_read_b128 v[128:131], v21 offset:32768
    v_mfma_f32_16x16x32_bf16 v[64:67], v[180:183], v[96:99], v[64:67]
    ds_read_b128 v[132:135], v21 offset:34816
    v_mfma_f32_16x16x32_bf16 v[36:39], v[176:179], v[100:103], v[36:39]
    ds_read_b128 v[136:139], v21 offset:36864
    buffer_load_dwordx4 v[168:171], v8, s[4:7], s80 offen offset:1024 sc1
    v_mfma_f32_16x16x32_bf16 v[68:71], v[180:183], v[100:103], v[68:71]
    v_mfma_f32_16x16x32_bf16 v[40:43], v[176:179], v[104:107], v[40:43]
    ds_read_b128 v[140:143], v21 offset:38912
    v_mfma_f32_16x16x32_bf16 v[72:75], v[180:183], v[104:107], v[72:75]
    ds_read_b128 v[144:147], v21 offset:40960
    s_add_u32 m0, s69, 2048
    v_mfma_f32_16x16x32_bf16 v[44:47], v[176:179], v[108:111], v[44:47]
    ds_read_b128 v[148:151], v21 offset:43008
    buffer_load_dwordx4 v30, s[64:67], s68 offen lds
    v_mfma_f32_16x16x32_bf16 v[76:79], v[180:183], v[108:111], v[76:79]
    v_mfma_f32_16x16x32_bf16 v[48:51], v[176:179], v[112:115], v[48:51]
    ds_read_b128 v[152:155], v21 offset:45056
    v_mfma_f32_16x16x32_bf16 v[80:83], v[180:183], v[112:115], v[80:83]
    ds_read_b128 v[156:159], v21 offset:47104
    v_mfma_f32_16x16x32_bf16 v[52:55], v[176:179], v[116:119], v[52:55]
    buffer_load_dwordx4 v[172:175], v9, s[4:7], s80 offen offset:1024 sc1
    v_mfma_f32_16x16x32_bf16 v[84:87], v[180:183], v[116:119], v[84:87]
    v_mfma_f32_16x16x32_bf16 v[56:59], v[176:179], v[120:123], v[56:59]
    v_mfma_f32_16x16x32_bf16 v[88:91], v[180:183], v[120:123], v[88:91]
    s_add_u32 m0, s69, 3072
    v_mfma_f32_16x16x32_bf16 v[60:63], v[176:179], v[124:127], v[60:63]
    buffer_load_dwordx4 v31, s[64:67], s68 offen lds
    v_mfma_f32_16x16x32_bf16 v[92:95], v[180:183], v[124:127], v[92:95]
    s_waitcnt vmcnt(9) lgkmcnt(0)
    s_barrier
    v_mfma_f32_16x16x32_bf16 v[32:35], v[184:187], v[128:131], v[32:35]
    ds_read_b128 v[96:99], v22 offset:0
    v_mfma_f32_16x16x32_bf16 v[64:67], v[188:191], v[128:131], v[64:67]
    ds_read_b128 v[100:103], v22 offset:2048
    v_mfma_f32_16x16x32_bf16 v[36:39], v[184:187], v[132:135], v[36:39]
    ds_read_b128 v[104:107], v22 offset:4096
    buffer_load_dwordx4 v[176:179], v8, s[4:7], s80 offen offset:2048 sc1
    v_mfma_f32_16x16x32_bf16 v[68:71], v[188:191], v[132:135], v[68:71]
    v_mfma_f32_16x16x32_bf16 v[40:43], v[184:187], v[136:139], v[40:43]
    ds_read_b128 v[108:111], v22 offset:6144
    v_mfma_f32_16x16x32_bf16 v[72:75], v[188:191], v[136:139], v[72:75]
    ds_read_b128 v[112:115], v22 offset:8192
    s_add_u32 s68, s68, 128
    s_add_u32 m0, s69, 32768
    v_mfma_f32_16x16x32_bf16 v[44:47], v[184:187], v[140:143], v[44:47]
    ds_read_b128 v[116:119], v22 offset:10240
    buffer_load_dwordx4 v28, s[64:67], s68 offen lds
    v_mfma_f32_16x16x32_bf16 v[76:79], v[188:191], v[140:143], v[76:79]
    v_mfma_f32_16x16x32_bf16 v[48:51], v[184:187], v[144:147], v[48:51]
    ds_read_b128 v[120:123], v22 offset:12288
    v_mfma_f32_16x16x32_bf16 v[80:83], v[188:191], v[144:147], v[80:83]
    ds_read_b128 v[124:127], v22 offset:14336
    v_mfma_f32_16x16x32_bf16 v[52:55], v[184:187], v[148:151], v[52:55]
    buffer_load_dwordx4 v[180:183], v9, s[4:7], s80 offen offset:2048 sc1
    v_mfma_f32_16x16x32_bf16 v[84:87], v[188:191], v[148:151], v[84:87]
    v_mfma_f32_16x16x32_bf16 v[56:59], v[184:187], v[152:155], v[56:59]
    v_mfma_f32_16x16x32_bf16 v[88:91], v[188:191], v[152:155], v[88:91]
    s_add_u32 m0, s69, 33792
    v_mfma_f32_16x16x32_bf16 v[60:63], v[184:187], v[156:159], v[60:63]
    buffer_load_dwordx4 v29, s[64:67], s68 offen lds
    v_mfma_f32_16x16x32_bf16 v[92:95], v[188:191], v[156:159], v[92:95]
    s_waitcnt vmcnt(9) lgkmcnt(0)
    v_mfma_f32_16x16x32_bf16 v[32:35], v[160:163], v[96:99], v[32:35]
    ds_read_b128 v[128:131], v23 offset:0
    v_mfma_f32_16x16x32_bf16 v[64:67], v[164:167], v[96:99], v[64:67]
    ds_read_b128 v[132:135], v23 offset:2048
    v_mfma_f32_16x16x32_bf16 v[36:39], v[160:163], v[100:103], v[36:39]
    ds_read_b128 v[136:139], v23 offset:4096
    buffer_load_dwordx4 v[184:187], v8, s[4:7], s80 offen offset:3072 sc1
    v_mfma_f32_16x16x32_bf16 v[68:71], v[164:167], v[100:103], v[68:71]
    v_mfma_f32_16x16x32_bf16 v[40:43], v[160:163], v[104:107], v[40:43]
    ds_read_b128 v[140:143], v23 offset:6144
    v_mfma_f32_16x16x32_bf16 v[72:75], v[164:167], v[104:107], v[72:75]
    ds_read_b128 v[144:147], v23 offset:8192
    s_add_u32 m0, s69, 34816
    v_mfma_f32_16x16x32_bf16 v[44:47], v[160:163], v[108:111], v[44:47]
    ds_read_b128 v[148:151], v23 offset:10240
    buffer_load_dwordx4 v30, s[64:67], s68 offen lds
    v_mfma_f32_16x16x32_bf16 v[76:79], v[164:167], v[108:111], v[76:79]
    v_mfma_f32_16x16x32_bf16 v[48:51], v[160:163], v[112:115], v[48:51]
    ds_read_b128 v[152:155], v23 offset:12288
    v_mfma_f32_16x16x32_bf16 v[80:83], v[164:167], v[112:115], v[80:83]
    ds_read_b128 v[156:159], v23 offset:14336
    v_mfma_f32_16x16x32_bf16 v[52:55], v[160:163], v[116:119], v[52:55]
    buffer_load_dwordx4 v[188:191], v9, s[4:7], s80 offen offset:3072 sc1
    v_mfma_f32_16x16x32_bf16 v[84:87], v[164:167], v[116:119], v[84:87]
    v_mfma_f32_16x16x32_bf16 v[56:59], v[160:163], v[120:123], v[56:59]
    v_mfma_f32_16x16x32_bf16 v[88:91], v[164:167], v[120:123], v[88:91]
    s_add_u32 m0, s69, 35840
    v_mfma_f32_16x16x32_bf16 v[60:63], v[160:163], v[124:127], v[60:63]
    buffer_load_dwordx4 v31, s[64:67], s68 offen lds
    v_mfma_f32_16x16x32_bf16 v[92:95], v[164:167], v[124:127], v[92:95]
    s_waitcnt vmcnt(9) lgkmcnt(0)
    s_barrier
    v_mfma_f32_16x16x32_bf16 v[32:35], v[168:171], v[128:131], v[32:35]
    ds_read_b128 v[96:99], v22 offset:32768
    v_mfma_f32_16x16x32_bf16 v[64:67], v[172:175], v[128:131], v[64:67]
    ds_read_b128 v[100:103], v22 offset:34816
    s_add_u32 s80, s80, 4096
    v_mfma_f32_16x16x32_bf16 v[36:39], v[168:171], v[132:135], v[36:39]
    ds_read_b128 v[104:107], v22 offset:36864
    buffer_load_dwordx4 v[160:163], v8, s[4:7], s80 offen offset:0 sc1
    v_mfma_f32_16x16x32_bf16 v[68:71], v[172:175], v[132:135], v[68:71]
    v_mfma_f32_16x16x32_bf16 v[40:43], v[168:171], v[136:139], v[40:43]
    ds_read_b128 v[108:111], v22 offset:38912
    v_mfma_f32_16x16x32_bf16 v[72:75], v[172:175], v[136:139], v[72:75]
    ds_read_b128 v[112:115], v22 offset:40960
    s_add_u32 s68, s68, 128
    s_add_u32 m0, s69, 65536
    v_mfma_f32_16x16x32_bf16 v[44:47], v[168:171], v[140:143], v[44:47]
    ds_read_b128 v[116:119], v22 offset:43008
    buffer_load_dwordx4 v28, s[64:67], s68 offen lds
    v_mfma_f32_16x16x32_bf16 v[76:79], v[172:175], v[140:143], v[76:79]
    v_mfma_f32_16x16x32_bf16 v[48:51], v[168:171], v[144:147], v[48:51]
    ds_read_b128 v[120:123], v22 offset:45056
    v_mfma_f32_16x16x32_bf16 v[80:83], v[172:175], v[144:147], v[80:83]
    ds_read_b128 v[124:127], v22 offset:47104
    v_mfma_f32_16x16x32_bf16 v[52:55], v[168:171], v[148:151], v[52:55]
    buffer_load_dwordx4 v[164:167], v9, s[4:7], s80 offen offset:0 sc1
    v_mfma_f32_16x16x32_bf16 v[84:87], v[172:175], v[148:151], v[84:87]
    v_mfma_f32_16x16x32_bf16 v[56:59], v[168:171], v[152:155], v[56:59]
    v_mfma_f32_16x16x32_bf16 v[88:91], v[172:175], v[152:155], v[88:91]
    s_add_u32 m0, s69, 66560
    v_mfma_f32_16x16x32_bf16 v[60:63], v[168:171], v[156:159], v[60:63]
    buffer_load_dwordx4 v29, s[64:67], s68 offen lds
    v_mfma_f32_16x16x32_bf16 v[92:95], v[172:175], v[156:159], v[92:95]
    s_waitcnt vmcnt(9) lgkmcnt(0)
    v_mfma_f32_16x16x32_bf16 v[32:35], v[176:179], v[96:99], v[32:35]
    ds_read_b128 v[128:131], v23 offset:32768
    v_mfma_f32_16x16x32_bf16 v[64:67], v[180:183], v[96:99], v[64:67]
    ds_read_b128 v[132:135], v23 offset:34816
    v_mfma_f32_16x16x32_bf16 v[36:39], v[176:179], v[100:103], v[36:39]
    ds_read_b128 v[136:139], v23 offset:36864
    buffer_load_dwordx4 v[168:171], v8, s[4:7], s80 offen offset:1024 sc1
    v_mfma_f32_16x16x32_bf16 v[68:71], v[180:183], v[100:103], v[68:71]
    v_mfma_f32_16x16x32_bf16 v[40:43], v[176:179], v[104:107], v[40:43]
    ds_read_b128 v[140:143], v23 offset:38912
    v_mfma_f32_16x16x32_bf16 v[72:75], v[180:183], v[104:107], v[72:75]
    ds_read_b128 v[144:147], v23 offset:40960
    s_add_u32 m0, s69, 67584
    v_mfma_f32_16x16x32_bf16 v[44:47], v[176:179], v[108:111], v[44:47]
    ds_read_b128 v[148:151], v23 offset:43008
    buffer_load_dwordx4 v30, s[64:67], s68 offen lds
    v_mfma_f32_16x16x32_bf16 v[76:79], v[180:183], v[108:111], v[76:79]
    v_mfma_f32_16x16x32_bf16 v[48:51], v[176:179], v[112:115], v[48:51]
    ds_read_b128 v[152:155], v23 offset:45056
    v_mfma_f32_16x16x32_bf16 v[80:83], v[180:183], v[112:115], v[80:83]
    ds_read_b128 v[156:159], v23 offset:47104
    v_mfma_f32_16x16x32_bf16 v[52:55], v[176:179], v[116:119], v[52:55]
    buffer_load_dwordx4 v[172:175], v9, s[4:7], s80 offen offset:1024 sc1
    v_mfma_f32_16x16x32_bf16 v[84:87], v[180:183], v[116:119], v[84:87]
    v_mfma_f32_16x16x32_bf16 v[56:59], v[176:179], v[120:123], v[56:59]
    v_mfma_f32_16x16x32_bf16 v[88:91], v[180:183], v[120:123], v[88:91]
    s_add_u32 m0, s69, 68608
    v_mfma_f32_16x16x32_bf16 v[60:63], v[176:179], v[124:127], v[60:63]
    buffer_load_dwordx4 v31, s[64:67], s68 offen lds
    v_mfma_f32_16x16x32_bf16 v[92:95], v[180:183], v[124:127], v[92:95]
    s_waitcnt vmcnt(9) lgkmcnt(0)
    s_barrier
    v_mfma_f32_16x16x32_bf16 v[32:35], v[184:187], v[128:131], v[32:35]
    ds_read_b128 v[96:99], v20 offset:0
    v_mfma_f32_16x16x32_bf16 v[64:67], v[188:191], v[128:131], v[64:67]
    ds_read_b128 v[100:103], v20 offset:2048
    v_mfma_f32_16x16x32_bf16 v[36:39], v[184:187], v[132:135], v[36:39]
    ds_read_b128 v[104:107], v20 offset:4096
    buffer_load_dwordx4 v[176:179], v8, s[4:7], s80 offen offset:2048 sc1
    v_mfma_f32_16x16x32_bf16 v[68:71], v[188:191], v[132:135], v[68:71]
    v_mfma_f32_16x16x32_bf16 v[40:43], v[184:187], v[136:139], v[40:43]
    ds_read_b128 v[108:111], v20 offset:6144
    v_mfma_f32_16x16x32_bf16 v[72:75], v[188:191], v[136:139], v[72:75]
    ds_read_b128 v[112:115], v20 offset:8192
    s_add_u32 s68, s68, 128
    s_add_u32 m0, s69, 98304
    v_mfma_f32_16x16x32_bf16 v[44:47], v[184:187], v[140:143], v[44:47]
    ds_read_b128 v[116:119], v20 offset:10240
    buffer_load_dwordx4 v28, s[64:67], s68 offen lds
    v_mfma_f32_16x16x32_bf16 v[76:79], v[188:191], v[140:143], v[76:79]
    v_mfma_f32_16x16x32_bf16 v[48:51], v[184:187], v[144:147], v[48:51]
    ds_read_b128 v[120:123], v20 offset:12288
    v_mfma_f32_16x16x32_bf16 v[80:83], v[188:191], v[144:147], v[80:83]
    ds_read_b128 v[124:127], v20 offset:14336
    v_mfma_f32_16x16x32_bf16 v[52:55], v[184:187], v[148:151], v[52:55]
    buffer_load_dwordx4 v[180:183], v9, s[4:7], s80 offen offset:2048 sc1
    v_mfma_f32_16x16x32_bf16 v[84:87], v[188:191], v[148:151], v[84:87]
    v_mfma_f32_16x16x32_bf16 v[56:59], v[184:187], v[152:155], v[56:59]
    v_mfma_f32_16x16x32_bf16 v[88:91], v[188:191], v[152:155], v[88:91]
    s_add_u32 m0, s69, 99328
    v_mfma_f32_16x16x32_bf16 v[60:63], v[184:187], v[156:159], v[60:63]
    buffer_load_dwordx4 v29, s[64:67], s68 offen lds
    v_mfma_f32_16x16x32_bf16 v[92:95], v[188:191], v[156:159], v[92:95]
    s_mov_b32 s82, 6
.p2align 6
kfy_loop_2:
    s_waitcnt vmcnt(9) lgkmcnt(0)
    v_mfma_f32_16x16x32_bf16 v[32:35], v[160:163], v[96:99], v[32:35]
    ds_read_b128 v[128:131], v21 offset:0
    v_mfma_f32_16x16x32_bf16 v[64:67], v[164:167], v[96:99], v[64:67]
    ds_read_b128 v[132:135], v21 offset:2048
    v_mfma_f32_16x16x32_bf16 v[36:39], v[160:163], v[100:103], v[36:39]
    ds_read_b128 v[136:139], v21 offset:4096
    buffer_load_dwordx4 v[184:187], v8, s[4:7], s80 offen offset:3072 sc1
    v_mfma_f32_16x16x32_bf16 v[68:71], v[164:167], v[100:103], v[68:71]
    v_mfma_f32_16x16x32_bf16 v[40:43], v[160:163], v[104:107], v[40:43]
    ds_read_b128 v[140:143], v21 offset:6144
    v_mfma_f32_16x16x32_bf16 v[72:75], v[164:167], v[104:107], v[72:75]
    ds_read_b128 v[144:147], v21 offset:8192
    s_add_u32 m0, s69, 100352
    v_mfma_f32_16x16x32_bf16 v[44:47], v[160:163], v[108:111], v[44:47]
    ds_read_b128 v[148:151], v21 offset:10240
    buffer_load_dwordx4 v30, s[64:67], s68 offen lds
    v_mfma_f32_16x16x32_bf16 v[76:79], v[164:167], v[108:111], v[76:79]
    v_mfma_f32_16x16x32_bf16 v[48:51], v[160:163], v[112:115], v[48:51]
    ds_read_b128 v[152:155], v21 offset:12288
    v_mfma_f32_16x16x32_bf16 v[80:83], v[164:167], v[112:115], v[80:83]
    ds_read_b128 v[156:159], v21 offset:14336
    v_mfma_f32_16x16x32_bf16 v[52:55], v[160:163], v[116:119], v[52:55]
    buffer_load_dwordx4 v[188:191], v9, s[4:7], s80 offen offset:3072 sc1
    v_mfma_f32_16x16x32_bf16 v[84:87], v[164:167], v[116:119], v[84:87]
    v_mfma_f32_16x16x32_bf16 v[56:59], v[160:163], v[120:123], v[56:59]
    v_mfma_f32_16x16x32_bf16 v[88:91], v[164:167], v[120:123], v[88:91]
    s_add_u32 m0, s69, 101376
    v_mfma_f32_16x16x32_bf16 v[60:63], v[160:163], v[124:127], v[60:63]
    buffer_load_dwordx4 v31, s[64:67], s68 offen lds
    v_mfma_f32_16x16x32_bf16 v[92:95], v[164:167], v[124:127], v[92:95]
    s_waitcnt vmcnt(9) lgkmcnt(0)
    s_barrier
    v_mfma_f32_16x16x32_bf16 v[32:35], v[168:171], v[128:131], v[32:35]
    ds_read_b128 v[96:99], v20 offset:32768
    v_mfma_f32_16x16x32_bf16 v[64:67], v[172:175], v[128:131], v[64:67]
    ds_read_b128 v[100:103], v20 offset:34816
    s_add_u32 s80, s80, 4096
    v_mfma_f32_16x16x32_bf16 v[36:39], v[168:171], v[132:135], v[36:39]
    ds_read_b128 v[104:107], v20 offset:36864
    buffer_load_dwordx4 v[160:163], v8, s[4:7], s80 offen offset:0 sc1
    v_mfma_f32_16x16x32_bf16 v[68:71], v[172:175], v[132:135], v[68:71]
    v_mfma_f32_16x16x32_bf16 v[40:43], v[168:171], v[136:139], v[40:43]
    ds_read_b128 v[108:111], v20 offset:38912
    v_mfma_f32_16x16x32_bf16 v[72:75], v[172:175], v[136:139], v[72:75]
    ds_read_b128 v[112:115], v20 offset:40960
    s_add_u32 s68, s68, 128
    s_add_u32 m0, s69, 0
    v_mfma_f32_16x16x32_bf16 v[44:47], v[168:171], v[140:143], v[44:47]
    ds_read_b128 v[116:119], v20 offset:43008
    buffer_load_dwordx4 v28, s[64:67], s68 offen lds
    v_mfma_f32_16x16x32_bf16 v[76:79], v[172:175], v[140:143], v[76:79]
    v_mfma_f32_16x16x32_bf16 v[48:51], v[168:171], v[144:147], v[48:51]
    ds_read_b128 v[120:123], v20 offset:45056
    v_mfma_f32_16x16x32_bf16 v[80:83], v[172:175], v[144:147], v[80:83]
    ds_read_b128 v[124:127], v20 offset:47104
    v_mfma_f32_16x16x32_bf16 v[52:55], v[168:171], v[148:151], v[52:55]
    buffer_load_dwordx4 v[164:167], v9, s[4:7], s80 offen offset:0 sc1
    v_mfma_f32_16x16x32_bf16 v[84:87], v[172:175], v[148:151], v[84:87]
    v_mfma_f32_16x16x32_bf16 v[56:59], v[168:171], v[152:155], v[56:59]
    v_mfma_f32_16x16x32_bf16 v[88:91], v[172:175], v[152:155], v[88:91]
    s_add_u32 m0, s69, 1024
    v_mfma_f32_16x16x32_bf16 v[60:63], v[168:171], v[156:159], v[60:63]
    buffer_load_dwordx4 v29, s[64:67], s68 offen lds
    v_mfma_f32_16x16x32_bf16 v[92:95], v[172:175], v[156:159], v[92:95]
    s_waitcnt vmcnt(9) lgkmcnt(0)
    v_mfma_f32_16x16x32_bf16 v[32:35], v[176:179], v[96:99], v[32:35]
    ds_read_b128 v[128:131], v21 offset:32768
    v_mfma_f32_16x16x32_bf16 v[64:67], v[180:183], v[96:99], v[64:67]
    ds_read_b128 v[132:135], v21 offset:34816
    v_mfma_f32_16x16x32_bf16 v[36:39], v[176:179], v[100:103], v[36:39]
    ds_read_b128 v[136:139], v21 offset:36864
    buffer_load_dwordx4 v[168:171], v8, s[4:7], s80 offen offset:1024 sc1
    v_mfma_f32_16x16x32_bf16 v[68:71], v[180:183], v[100:103], v[68:71]
    v_mfma_f32_16x16x32_bf16 v[40:43], v[176:179], v[104:107], v[40:43]
    ds_read_b128 v[140:143], v21 offset:38912
    v_mfma_f32_16x16x32_bf16 v[72:75], v[180:183], v[104:107], v[72:75]
    ds_read_b128 v[144:147], v21 offset:40960
    s_add_u32 m0, s69, 2048
    v_mfma_f32_16x16x32_bf16 v[44:47], v[176:179], v[108:111], v[44:47]
    ds_read_b128 v[148:151], v21 offset:43008
    buffer_load_dwordx4 v30, s[64:67], s68 offen lds
    v_mfma_f32_16x16x32_bf16 v[76:79], v[180:183], v[108:111], v[76:79]
    v_mfma_f32_16x16x32_bf16 v[48:51], v[176:179], v[112:115], v[48:51]
    ds_read_b128 v[152:155], v21 offset:45056
    v_mfma_f32_16x16x32_bf16 v[80:83], v[180:183], v[112:115], v[80:83]
    ds_read_b128 v[156:159], v21 offset:47104
    v_mfma_f32_16x16x32_bf16 v[52:55], v[176:179], v[116:119], v[52:55]
    buffer_load_dwordx4 v[172:175], v9, s[4:7], s80 offen offset:1024 sc1
    v_mfma_f32_16x16x32_bf16 v[84:87], v[180:183], v[116:119], v[84:87]
    v_mfma_f32_16x16x32_bf16 v[56:59], v[176:179], v[120:123], v[56:59]
    v_mfma_f32_16x16x32_bf16 v[88:91], v[180:183], v[120:123], v[88:91]
    s_add_u32 m0, s69, 3072
    v_mfma_f32_16x16x32_bf16 v[60:63], v[176:179], v[124:127], v[60:63]
    buffer_load_dwordx4 v31, s[64:67], s68 offen lds
    v_mfma_f32_16x16x32_bf16 v[92:95], v[180:183], v[124:127], v[92:95]
    s_waitcnt vmcnt(9) lgkmcnt(0)
    s_barrier
    v_mfma_f32_16x16x32_bf16 v[32:35], v[184:187], v[128:131], v[32:35]
    ds_read_b128 v[96:99], v22 offset:0
    v_mfma_f32_16x16x32_bf16 v[64:67], v[188:191], v[128:131], v[64:67]
    ds_read_b128 v[100:103], v22 offset:2048
    v_mfma_f32_16x16x32_bf16 v[36:39], v[184:187], v[132:135], v[36:39]
    ds_read_b128 v[104:107], v22 offset:4096
    buffer_load_dwordx4 v[176:179], v8, s[4:7], s80 offen offset:2048 sc1
    v_mfma_f32_16x16x32_bf16 v[68:71], v[188:191], v[132:135], v[68:71]
    v_mfma_f32_16x16x32_bf16 v[40:43], v[184:187], v[136:139], v[40:43]
    ds_read_b128 v[108:111], v22 offset:6144
    v_mfma_f32_16x16x32_bf16 v[72:75], v[188:191], v[136:139], v[72:75]
    ds_read_b128 v[112:115], v22 offset:8192
    s_add_u32 s68, s68, 128
    s_add_u32 m0, s69, 32768
    v_mfma_f32_16x16x32_bf16 v[44:47], v[184:187], v[140:143], v[44:47]
    ds_read_b128 v[116:119], v22 offset:10240
    buffer_load_dwordx4 v28, s[64:67], s68 offen lds
    v_mfma_f32_16x16x32_bf16 v[76:79], v[188:191], v[140:143], v[76:79]
    v_mfma_f32_16x16x32_bf16 v[48:51], v[184:187], v[144:147], v[48:51]
    ds_read_b128 v[120:123], v22 offset:12288
    v_mfma_f32_16x16x32_bf16 v[80:83], v[188:191], v[144:147], v[80:83]
    ds_read_b128 v[124:127], v22 offset:14336
    v_mfma_f32_16x16x32_bf16 v[52:55], v[184:187], v[148:151], v[52:55]
    buffer_load_dwordx4 v[180:183], v9, s[4:7], s80 offen offset:2048 sc1
    v_mfma_f32_16x16x32_bf16 v[84:87], v[188:191], v[148:151], v[84:87]
    v_mfma_f32_16x16x32_bf16 v[56:59], v[184:187], v[152:155], v[56:59]
    v_mfma_f32_16x16x32_bf16 v[88:91], v[188:191], v[152:155], v[88:91]
    s_add_u32 m0, s69, 33792
    v_mfma_f32_16x16x32_bf16 v[60:63], v[184:187], v[156:159], v[60:63]
    buffer_load_dwordx4 v29, s[64:67], s68 offen lds
    v_mfma_f32_16x16x32_bf16 v[92:95], v[188:191], v[156:159], v[92:95]
    s_waitcnt vmcnt(9) lgkmcnt(0)
    v_mfma_f32_16x16x32_bf16 v[32:35], v[160:163], v[96:99], v[32:35]
    ds_read_b128 v[128:131], v23 offset:0
    v_mfma_f32_16x16x32_bf16 v[64:67], v[164:167], v[96:99], v[64:67]
    ds_read_b128 v[132:135], v23 offset:2048
    v_mfma_f32_16x16x32_bf16 v[36:39], v[160:163], v[100:103], v[36:39]
    ds_read_b128 v[136:139], v23 offset:4096
    buffer_load_dwordx4 v[184:187], v8, s[4:7], s80 offen offset:3072 sc1
    v_mfma_f32_16x16x32_bf16 v[68:71], v[164:167], v[100:103], v[68:71]
    v_mfma_f32_16x16x32_bf16 v[40:43], v[160:163], v[104:107], v[40:43]
    ds_read_b128 v[140:143], v23 offset:6144
    v_mfma_f32_16x16x32_bf16 v[72:75], v[164:167], v[104:107], v[72:75]
    ds_read_b128 v[144:147], v23 offset:8192
    s_add_u32 m0, s69, 34816
    v_mfma_f32_16x16x32_bf16 v[44:47], v[160:163], v[108:111], v[44:47]
    ds_read_b128 v[148:151], v23 offset:10240
    buffer_load_dwordx4 v30, s[64:67], s68 offen lds
    v_mfma_f32_16x16x32_bf16 v[76:79], v[164:167], v[108:111], v[76:79]
    v_mfma_f32_16x16x32_bf16 v[48:51], v[160:163], v[112:115], v[48:51]
    ds_read_b128 v[152:155], v23 offset:12288
    v_mfma_f32_16x16x32_bf16 v[80:83], v[164:167], v[112:115], v[80:83]
    ds_read_b128 v[156:159], v23 offset:14336
    v_mfma_f32_16x16x32_bf16 v[52:55], v[160:163], v[116:119], v[52:55]
    buffer_load_dwordx4 v[188:191], v9, s[4:7], s80 offen offset:3072 sc1
    v_mfma_f32_16x16x32_bf16 v[84:87], v[164:167], v[116:119], v[84:87]
    v_mfma_f32_16x16x32_bf16 v[56:59], v[160:163], v[120:123], v[56:59]
    v_mfma_f32_16x16x32_bf16 v[88:91], v[164:167], v[120:123], v[88:91]
    s_add_u32 m0, s69, 35840
    v_mfma_f32_16x16x32_bf16 v[60:63], v[160:163], v[124:127], v[60:63]
    buffer_load_dwordx4 v31, s[64:67], s68 offen lds
    v_mfma_f32_16x16x32_bf16 v[92:95], v[164:167], v[124:127], v[92:95]
    s_waitcnt vmcnt(9) lgkmcnt(0)
    s_barrier
    v_mfma_f32_16x16x32_bf16 v[32:35], v[168:171], v[128:131], v[32:35]
    ds_read_b128 v[96:99], v22 offset:32768
    v_mfma_f32_16x16x32_bf16 v[64:67], v[172:175], v[128:131], v[64:67]
    ds_read_b128 v[100:103], v22 offset:34816
    s_add_u32 s80, s80, 4096
    v_mfma_f32_16x16x32_bf16 v[36:39], v[168:171], v[132:135], v[36:39]
    ds_read_b128 v[104:107], v22 offset:36864
    buffer_load_dwordx4 v[160:163], v8, s[4:7], s80 offen offset:0 sc1
    v_mfma_f32_16x16x32_bf16 v[68:71], v[172:175], v[132:135], v[68:71]
    v_mfma_f32_16x16x32_bf16 v[40:43], v[168:171], v[136:139], v[40:43]
    ds_read_b128 v[108:111], v22 offset:38912
    v_mfma_f32_16x16x32_bf16 v[72:75], v[172:175], v[136:139], v[72:75]
    ds_read_b128 v[112:115], v22 offset:40960
    s_add_u32 s68, s68, 128
    s_add_u32 m0, s69, 65536
    v_mfma_f32_16x16x32_bf16 v[44:47], v[168:171], v[140:143], v[44:47]
    ds_read_b128 v[116:119], v22 offset:43008
    buffer_load_dwordx4 v28, s[64:67], s68 offen lds
    v_mfma_f32_16x16x32_bf16 v[76:79], v[172:175], v[140:143], v[76:79]
    v_mfma_f32_16x16x32_bf16 v[48:51], v[168:171], v[144:147], v[48:51]
    ds_read_b128 v[120:123], v22 offset:45056
    v_mfma_f32_16x16x32_bf16 v[80:83], v[172:175], v[144:147], v[80:83]
    ds_read_b128 v[124:127], v22 offset:47104
    v_mfma_f32_16x16x32_bf16 v[52:55], v[168:171], v[148:151], v[52:55]
    buffer_load_dwordx4 v[164:167], v9, s[4:7], s80 offen offset:0 sc1
    v_mfma_f32_16x16x32_bf16 v[84:87], v[172:175], v[148:151], v[84:87]
    v_mfma_f32_16x16x32_bf16 v[56:59], v[168:171], v[152:155], v[56:59]
    v_mfma_f32_16x16x32_bf16 v[88:91], v[172:175], v[152:155], v[88:91]
    s_add_u32 m0, s69, 66560
    v_mfma_f32_16x16x32_bf16 v[60:63], v[168:171], v[156:159], v[60:63]
    buffer_load_dwordx4 v29, s[64:67], s68 offen lds
    v_mfma_f32_16x16x32_bf16 v[92:95], v[172:175], v[156:159], v[92:95]
    s_waitcnt vmcnt(9) lgkmcnt(0)
    v_mfma_f32_16x16x32_bf16 v[32:35], v[176:179], v[96:99], v[32:35]
    ds_read_b128 v[128:131], v23 offset:32768
    v_mfma_f32_16x16x32_bf16 v[64:67], v[180:183], v[96:99], v[64:67]
    ds_read_b128 v[132:135], v23 offset:34816
    v_mfma_f32_16x16x32_bf16 v[36:39], v[176:179], v[100:103], v[36:39]
    ds_read_b128 v[136:139], v23 offset:36864
    buffer_load_dwordx4 v[168:171], v8, s[4:7], s80 offen offset:1024 sc1
    v_mfma_f32_16x16x32_bf16 v[68:71], v[180:183], v[100:103], v[68:71]
    v_mfma_f32_16x16x32_bf16 v[40:43], v[176:179], v[104:107], v[40:43]
    ds_read_b128 v[140:143], v23 offset:38912
    v_mfma_f32_16x16x32_bf16 v[72:75], v[180:183], v[104:107], v[72:75]
    ds_read_b128 v[144:147], v23 offset:40960
    s_add_u32 m0, s69, 67584
    v_mfma_f32_16x16x32_bf16 v[44:47], v[176:179], v[108:111], v[44:47]
    ds_read_b128 v[148:151], v23 offset:43008
    buffer_load_dwordx4 v30, s[64:67], s68 offen lds
    v_mfma_f32_16x16x32_bf16 v[76:79], v[180:183], v[108:111], v[76:79]
    v_mfma_f32_16x16x32_bf16 v[48:51], v[176:179], v[112:115], v[48:51]
    ds_read_b128 v[152:155], v23 offset:45056
    v_mfma_f32_16x16x32_bf16 v[80:83], v[180:183], v[112:115], v[80:83]
    ds_read_b128 v[156:159], v23 offset:47104
    v_mfma_f32_16x16x32_bf16 v[52:55], v[176:179], v[116:119], v[52:55]
    buffer_load_dwordx4 v[172:175], v9, s[4:7], s80 offen offset:1024 sc1
    v_mfma_f32_16x16x32_bf16 v[84:87], v[180:183], v[116:119], v[84:87]
    v_mfma_f32_16x16x32_bf16 v[56:59], v[176:179], v[120:123], v[56:59]
    v_mfma_f32_16x16x32_bf16 v[88:91], v[180:183], v[120:123], v[88:91]
    s_add_u32 m0, s69, 68608
    v_mfma_f32_16x16x32_bf16 v[60:63], v[176:179], v[124:127], v[60:63]
    buffer_load_dwordx4 v31, s[64:67], s68 offen lds
    v_mfma_f32_16x16x32_bf16 v[92:95], v[180:183], v[124:127], v[92:95]
    s_waitcnt vmcnt(9) lgkmcnt(0)
    s_barrier
    v_mfma_f32_16x16x32_bf16 v[32:35], v[184:187], v[128:131], v[32:35]
    ds_read_b128 v[96:99], v20 offset:0
    v_mfma_f32_16x16x32_bf16 v[64:67], v[188:191], v[128:131], v[64:67]
    ds_read_b128 v[100:103], v20 offset:2048
    v_mfma_f32_16x16x32_bf16 v[36:39], v[184:187], v[132:135], v[36:39]
    ds_read_b128 v[104:107], v20 offset:4096
    buffer_load_dwordx4 v[176:179], v8, s[4:7], s80 offen offset:2048 sc1
    v_mfma_f32_16x16x32_bf16 v[68:71], v[188:191], v[132:135], v[68:71]
    v_mfma_f32_16x16x32_bf16 v[40:43], v[184:187], v[136:139], v[40:43]
    ds_read_b128 v[108:111], v20 offset:6144
    v_mfma_f32_16x16x32_bf16 v[72:75], v[188:191], v[136:139], v[72:75]
    ds_read_b128 v[112:115], v20 offset:8192
    s_add_u32 s68, s68, 128
    s_add_u32 m0, s69, 98304
    v_mfma_f32_16x16x32_bf16 v[44:47], v[184:187], v[140:143], v[44:47]
    ds_read_b128 v[116:119], v20 offset:10240
    buffer_load_dwordx4 v28, s[64:67], s68 offen lds
    v_mfma_f32_16x16x32_bf16 v[76:79], v[188:191], v[140:143], v[76:79]
    v_mfma_f32_16x16x32_bf16 v[48:51], v[184:187], v[144:147], v[48:51]
    ds_read_b128 v[120:123], v20 offset:12288
    v_mfma_f32_16x16x32_bf16 v[80:83], v[188:191], v[144:147], v[80:83]
    ds_read_b128 v[124:127], v20 offset:14336
    v_mfma_f32_16x16x32_bf16 v[52:55], v[184:187], v[148:151], v[52:55]
    buffer_load_dwordx4 v[180:183], v9, s[4:7], s80 offen offset:2048 sc1
    v_mfma_f32_16x16x32_bf16 v[84:87], v[188:191], v[148:151], v[84:87]
    v_mfma_f32_16x16x32_bf16 v[56:59], v[184:187], v[152:155], v[56:59]
    v_mfma_f32_16x16x32_bf16 v[88:91], v[188:191], v[152:155], v[88:91]
    s_add_u32 m0, s69, 99328
    v_mfma_f32_16x16x32_bf16 v[60:63], v[184:187], v[156:159], v[60:63]
    buffer_load_dwordx4 v29, s[64:67], s68 offen lds
    v_mfma_f32_16x16x32_bf16 v[92:95], v[188:191], v[156:159], v[92:95]
    s_sub_u32 s82, s82, 1
    s_cmp_lg_u32 s82, 0
    s_cbranch_scc1 kfy_loop_2
    s_waitcnt vmcnt(9) lgkmcnt(0)
    v_mfma_f32_16x16x32_bf16 v[32:35], v[160:163], v[96:99], v[32:35]
    ds_read_b128 v[128:131], v21 offset:0
    v_mfma_f32_16x16x32_bf16 v[64:67], v[164:167], v[96:99], v[64:67]
    ds_read_b128 v[132:135], v21 offset:2048
    v_mfma_f32_16x16x32_bf16 v[36:39], v[160:163], v[100:103], v[36:39]
    ds_read_b128 v[136:139], v21 offset:4096
    buffer_load_dwordx4 v[184:187], v8, s[4:7], s80 offen offset:3072 sc1
    v_mfma_f32_16x16x32_bf16 v[68:71], v[164:167], v[100:103], v[68:71]
    v_mfma_f32_16x16x32_bf16 v[40:43], v[160:163], v[104:107], v[40:43]
    ds_read_b128 v[140:143], v21 offset:6144
    v_mfma_f32_16x16x32_bf16 v[72:75], v[164:167], v[104:107], v[72:75]
    ds_read_b128 v[144:147], v21 offset:8192
    s_add_u32 m0, s69, 100352
    v_mfma_f32_16x16x32_bf16 v[44:47], v[160:163], v[108:111], v[44:47]
    ds_read_b128 v[148:151], v21 offset:10240
    buffer_load_dwordx4 v30, s[64:67], s68 offen lds
    v_mfma_f32_16x16x32_bf16 v[76:79], v[164:167], v[108:111], v[76:79]
    v_mfma_f32_16x16x32_bf16 v[48:51], v[160:163], v[112:115], v[48:51]
    ds_read_b128 v[152:155], v21 offset:12288
    v_mfma_f32_16x16x32_bf16 v[80:83], v[164:167], v[112:115], v[80:83]
    ds_read_b128 v[156:159], v21 offset:14336
    v_mfma_f32_16x16x32_bf16 v[52:55], v[160:163], v[116:119], v[52:55]
    buffer_load_dwordx4 v[188:191], v9, s[4:7], s80 offen offset:3072 sc1
    v_mfma_f32_16x16x32_bf16 v[84:87], v[164:167], v[116:119], v[84:87]
    v_mfma_f32_16x16x32_bf16 v[56:59], v[160:163], v[120:123], v[56:59]
    v_mfma_f32_16x16x32_bf16 v[88:91], v[164:167], v[120:123], v[88:91]
    s_add_u32 m0, s69, 101376
    v_mfma_f32_16x16x32_bf16 v[60:63], v[160:163], v[124:127], v[60:63]
    buffer_load_dwordx4 v31, s[64:67], s68 offen lds
    v_mfma_f32_16x16x32_bf16 v[92:95], v[164:167], v[124:127], v[92:95]
    s_waitcnt vmcnt(9) lgkmcnt(0)
    s_barrier
    v_mfma_f32_16x16x32_bf16 v[32:35], v[168:171], v[128:131], v[32:35]
    ds_read_b128 v[96:99], v20 offset:32768
    v_mfma_f32_16x16x32_bf16 v[64:67], v[172:175], v[128:131], v[64:67]
    ds_read_b128 v[100:103], v20 offset:34816
    v_mfma_f32_16x16x32_bf16 v[36:39], v[168:171], v[132:135], v[36:39]
    ds_read_b128 v[104:107], v20 offset:36864
    v_mfma_f32_16x16x32_bf16 v[68:71], v[172:175], v[132:135], v[68:71]
    s_add_u32 s80, s80, 4096
    v_mfma_f32_16x16x32_bf16 v[40:43], v[168:171], v[136:139], v[40:43]
    ds_read_b128 v[108:111], v20 offset:38912
    buffer_load_dwordx4 v[160:163], v8, s[4:7], s80 offen offset:0 sc1
    v_mfma_f32_16x16x32_bf16 v[72:75], v[172:175], v[136:139], v[72:75]
    ds_read_b128 v[112:115], v20 offset:40960
    v_mfma_f32_16x16x32_bf16 v[44:47], v[168:171], v[140:143], v[44:47]
    ds_read_b128 v[116:119], v20 offset:43008
    v_mfma_f32_16x16x32_bf16 v[76:79], v[172:175], v[140:143], v[76:79]
    v_mfma_f32_16x16x32_bf16 v[48:51], v[168:171], v[144:147], v[48:51]
    ds_read_b128 v[120:123], v20 offset:45056
    v_mfma_f32_16x16x32_bf16 v[80:83], v[172:175], v[144:147], v[80:83]
    ds_read_b128 v[124:127], v20 offset:47104
    v_mfma_f32_16x16x32_bf16 v[52:55], v[168:171], v[148:151], v[52:55]
    v_mfma_f32_16x16x32_bf16 v[84:87], v[172:175], v[148:151], v[84:87]
    v_mfma_f32_16x16x32_bf16 v[56:59], v[168:171], v[152:155], v[56:59]
    buffer_load_dwordx4 v[164:167], v9, s[4:7], s80 offen offset:0 sc1
    v_mfma_f32_16x16x32_bf16 v[88:91], v[172:175], v[152:155], v[88:91]
    v_mfma_f32_16x16x32_bf16 v[60:63], v[168:171], v[156:159], v[60:63]
    v_mfma_f32_16x16x32_bf16 v[92:95], v[172:175], v[156:159], v[92:95]
    s_waitcnt vmcnt(7) lgkmcnt(0)
    v_mfma_f32_16x16x32_bf16 v[32:35], v[176:179], v[96:99], v[32:35]
    ds_read_b128 v[128:131], v21 offset:32768
    v_mfma_f32_16x16x32_bf16 v[64:67], v[180:183], v[96:99], v[64:67]
    ds_read_b128 v[132:135], v21 offset:34816
    v_mfma_f32_16x16x32_bf16 v[36:39], v[176:179], v[100:103], v[36:39]
    ds_read_b128 v[136:139], v21 offset:36864
    v_mfma_f32_16x16x32_bf16 v[68:71], v[180:183], v[100:103], v[68:71]
    v_mfma_f32_16x16x32_bf16 v[40:43], v[176:179], v[104:107], v[40:43]
    ds_read_b128 v[140:143], v21 offset:38912
    buffer_load_dwordx4 v[168:171], v8, s[4:7], s80 offen offset:1024 sc1
    v_mfma_f32_16x16x32_bf16 v[72:75], v[180:183], v[104:107], v[72:75]
    ds_read_b128 v[144:147], v21 offset:40960
    v_mfma_f32_16x16x32_bf16 v[44:47], v[176:179], v[108:111], v[44:47]
    ds_read_b128 v[148:151], v21 offset:43008
    v_mfma_f32_16x16x32_bf16 v[76:79], v[180:183], v[108:111], v[76:79]
    v_mfma_f32_16x16x32_bf16 v[48:51], v[176:179], v[112:115], v[48:51]
    ds_read_b128 v[152:155], v21 offset:45056
    v_mfma_f32_16x16x32_bf16 v[80:83], v[180:183], v[112:115], v[80:83]
    ds_read_b128 v[156:159], v21 offset:47104
    v_mfma_f32_16x16x32_bf16 v[52:55], v[176:179], v[116:119], v[52:55]
    v_mfma_f32_16x16x32_bf16 v[84:87], v[180:183], v[116:119], v[84:87]
    v_mfma_f32_16x16x32_bf16 v[56:59], v[176:179], v[120:123], v[56:59]
    buffer_load_dwordx4 v[172:175], v9, s[4:7], s80 offen offset:1024 sc1
    v_mfma_f32_16x16x32_bf16 v[88:91], v[180:183], v[120:123], v[88:91]
    v_mfma_f32_16x16x32_bf16 v[60:63], v[176:179], v[124:127], v[60:63]
    v_mfma_f32_16x16x32_bf16 v[92:95], v[180:183], v[124:127], v[92:95]
    s_waitcnt vmcnt(5) lgkmcnt(0)
    s_barrier
    v_mfma_f32_16x16x32_bf16 v[32:35], v[184:187], v[128:131], v[32:35]
    ds_read_b128 v[96:99], v22 offset:0
    v_mfma_f32_16x16x32_bf16 v[64:67], v[188:191], v[128:131], v[64:67]
    ds_read_b128 v[100:103], v22 offset:2048
    v_mfma_f32_16x16x32_bf16 v[36:39], v[184:187], v[132:135], v[36:39]
    ds_read_b128 v[104:107], v22 offset:4096
    v_mfma_f32_16x16x32_bf16 v[68:71], v[188:191], v[132:135], v[68:71]
    v_mfma_f32_16x16x32_bf16 v[40:43], v[184:187], v[136:139], v[40:43]
    ds_read_b128 v[108:111], v22 offset:6144
    buffer_load_dwordx4 v[176:179], v8, s[4:7], s80 offen offset:2048 sc1
    v_mfma_f32_16x16x32_bf16 v[72:75], v[188:191], v[136:139], v[72:75]
    ds_read_b128 v[112:115], v22 offset:8192
    v_mfma_f32_16x16x32_bf16 v[44:47], v[184:187], v[140:143], v[44:47]
    ds_read_b128 v[116:119], v22 offset:10240
    v_mfma_f32_16x16x32_bf16 v[76:79], v[188:191], v[140:143], v[76:79]
    v_mfma_f32_16x16x32_bf16 v[48:51], v[184:187], v[144:147], v[48:51]
    ds_read_b128 v[120:123], v22 offset:12288
    v_mfma_f32_16x16x32_bf16 v[80:83], v[188:191], v[144:147], v[80:83]
    ds_read_b128 v[124:127], v22 offset:14336
    v_mfma_f32_16x16x32_bf16 v[52:55], v[184:187], v[148:151], v[52:55]
    v_mfma_f32_16x16x32_bf16 v[84:87], v[188:191], v[148:151], v[84:87]
    v_mfma_f32_16x16x32_bf16 v[56:59], v[184:187], v[152:155], v[56:59]
    buffer_load_dwordx4 v[180:183], v9, s[4:7], s80 offen offset:2048 sc1
    v_mfma_f32_16x16x32_bf16 v[88:91], v[188:191], v[152:155], v[88:91]
    v_mfma_f32_16x16x32_bf16 v[60:63], v[184:187], v[156:159], v[60:63]
    v_mfma_f32_16x16x32_bf16 v[92:95], v[188:191], v[156:159], v[92:95]
    s_waitcnt vmcnt(4) lgkmcnt(0)
    v_mfma_f32_16x16x32_bf16 v[32:35], v[160:163], v[96:99], v[32:35]
    ds_read_b128 v[128:131], v23 offset:0
    v_mfma_f32_16x16x32_bf16 v[64:67], v[164:167], v[96:99], v[64:67]
    ds_read_b128 v[132:135], v23 offset:2048
    v_mfma_f32_16x16x32_bf16 v[36:39], v[160:163], v[100:103], v[36:39]
    ds_read_b128 v[136:139], v23 offset:4096
    v_mfma_f32_16x16x32_bf16 v[68:71], v[164:167], v[100:103], v[68:71]
    v_mfma_f32_16x16x32_bf16 v[40:43], v[160:163], v[104:107], v[40:43]
    ds_read_b128 v[140:143], v23 offset:6144
    buffer_load_dwordx4 v[184:187], v8, s[4:7], s80 offen offset:3072 sc1
    v_mfma_f32_16x16x32_bf16 v[72:75], v[164:167], v[104:107], v[72:75]
    ds_read_b128 v[144:147], v23 offset:8192
    v_mfma_f32_16x16x32_bf16 v[44:47], v[160:163], v[108:111], v[44:47]
    ds_read_b128 v[148:151], v23 offset:10240
    v_mfma_f32_16x16x32_bf16 v[76:79], v[164:167], v[108:111], v[76:79]
    v_mfma_f32_16x16x32_bf16 v[48:51], v[160:163], v[112:115], v[48:51]
    ds_read_b128 v[152:155], v23 offset:12288
    v_mfma_f32_16x16x32_bf16 v[80:83], v[164:167], v[112:115], v[80:83]
    ds_read_b128 v[156:159], v23 offset:14336
    v_mfma_f32_16x16x32_bf16 v[52:55], v[160:163], v[116:119], v[52:55]
    v_mfma_f32_16x16x32_bf16 v[84:87], v[164:167], v[116:119], v[84:87]
    v_mfma_f32_16x16x32_bf16 v[56:59], v[160:163], v[120:123], v[56:59]
    buffer_load_dwordx4 v[188:191], v9, s[4:7], s80 offen offset:3072 sc1
    v_mfma_f32_16x16x32_bf16 v[88:91], v[164:167], v[120:123], v[88:91]
    v_mfma_f32_16x16x32_bf16 v[60:63], v[160:163], v[124:127], v[60:63]
    v_mfma_f32_16x16x32_bf16 v[92:95], v[164:167], v[124:127], v[92:95]
    s_waitcnt vmcnt(4) lgkmcnt(0)
    s_barrier
    v_mfma_f32_16x16x32_bf16 v[32:35], v[168:171], v[128:131], v[32:35]
    ds_read_b128 v[96:99], v22 offset:32768
    v_mfma_f32_16x16x32_bf16 v[64:67], v[172:175], v[128:131], v[64:67]
    ds_read_b128 v[100:103], v22 offset:34816
    v_mfma_f32_16x16x32_bf16 v[36:39], v[168:171], v[132:135], v[36:39]
    ds_read_b128 v[104:107], v22 offset:36864
    v_mfma_f32_16x16x32_bf16 v[68:71], v[172:175], v[132:135], v[68:71]
    v_mfma_f32_16x16x32_bf16 v[40:43], v[168:171], v[136:139], v[40:43]
    ds_read_b128 v[108:111], v22 offset:38912
    v_mfma_f32_16x16x32_bf16 v[72:75], v[172:175], v[136:139], v[72:75]
    ds_read_b128 v[112:115], v22 offset:40960
    v_mfma_f32_16x16x32_bf16 v[44:47], v[168:171], v[140:143], v[44:47]
    ds_read_b128 v[116:119], v22 offset:43008
    v_mfma_f32_16x16x32_bf16 v[76:79], v[172:175], v[140:143], v[76:79]
    v_mfma_f32_16x16x32_bf16 v[48:51], v[168:171], v[144:147], v[48:51]
    ds_read_b128 v[120:123], v22 offset:45056
    v_mfma_f32_16x16x32_bf16 v[80:83], v[172:175], v[144:147], v[80:83]
    ds_read_b128 v[124:127], v22 offset:47104
    v_mfma_f32_16x16x32_bf16 v[52:55], v[168:171], v[148:151], v[52:55]
    v_mfma_f32_16x16x32_bf16 v[84:87], v[172:175], v[148:151], v[84:87]
    v_mfma_f32_16x16x32_bf16 v[56:59], v[168:171], v[152:155], v[56:59]
    v_mfma_f32_16x16x32_bf16 v[88:91], v[172:175], v[152:155], v[88:91]
    v_mfma_f32_16x16x32_bf16 v[60:63], v[168:171], v[156:159], v[60:63]
    v_mfma_f32_16x16x32_bf16 v[92:95], v[172:175], v[156:159], v[92:95]
    s_waitcnt vmcnt(2) lgkmcnt(0)
    v_mfma_f32_16x16x32_bf16 v[32:35], v[176:179], v[96:99], v[32:35]
    ds_read_b128 v[128:131], v23 offset:32768
    v_mfma_f32_16x16x32_bf16 v[64:67], v[180:183], v[96:99], v[64:67]
    ds_read_b128 v[132:135], v23 offset:34816
    v_mfma_f32_16x16x32_bf16 v[36:39], v[176:179], v[100:103], v[36:39]
    ds_read_b128 v[136:139], v23 offset:36864
    v_mfma_f32_16x16x32_bf16 v[68:71], v[180:183], v[100:103], v[68:71]
    v_mfma_f32_16x16x32_bf16 v[40:43], v[176:179], v[104:107], v[40:43]
    ds_read_b128 v[140:143], v23 offset:38912
    v_mfma_f32_16x16x32_bf16 v[72:75], v[180:183], v[104:107], v[72:75]
    ds_read_b128 v[144:147], v23 offset:40960
    v_mfma_f32_16x16x32_bf16 v[44:47], v[176:179], v[108:111], v[44:47]
    ds_read_b128 v[148:151], v23 offset:43008
    v_mfma_f32_16x16x32_bf16 v[76:79], v[180:183], v[108:111], v[76:79]
    v_mfma_f32_16x16x32_bf16 v[48:51], v[176:179], v[112:115], v[48:51]
    ds_read_b128 v[152:155], v23 offset:45056
    v_mfma_f32_16x16x32_bf16 v[80:83], v[180:183], v[112:115], v[80:83]
    ds_read_b128 v[156:159], v23 offset:47104
    v_mfma_f32_16x16x32_bf16 v[52:55], v[176:179], v[116:119], v[52:55]
    v_mfma_f32_16x16x32_bf16 v[84:87], v[180:183], v[116:119], v[84:87]
    v_mfma_f32_16x16x32_bf16 v[56:59], v[176:179], v[120:123], v[56:59]
    v_mfma_f32_16x16x32_bf16 v[88:91], v[180:183], v[120:123], v[88:91]
    v_mfma_f32_16x16x32_bf16 v[60:63], v[176:179], v[124:127], v[60:63]
    v_mfma_f32_16x16x32_bf16 v[92:95], v[180:183], v[124:127], v[92:95]
    s_waitcnt vmcnt(0) lgkmcnt(0)
    v_mfma_f32_16x16x32_bf16 v[32:35], v[184:187], v[128:131], v[32:35]
    v_mfma_f32_16x16x32_bf16 v[64:67], v[188:191], v[128:131], v[64:67]
    v_mfma_f32_16x16x32_bf16 v[36:39], v[184:187], v[132:135], v[36:39]
    v_mfma_f32_16x16x32_bf16 v[68:71], v[188:191], v[132:135], v[68:71]
    v_mfma_f32_16x16x32_bf16 v[40:43], v[184:187], v[136:139], v[40:43]
    v_mfma_f32_16x16x32_bf16 v[72:75], v[188:191], v[136:139], v[72:75]
    v_mfma_f32_16x16x32_bf16 v[44:47], v[184:187], v[140:143], v[44:47]
    v_mfma_f32_16x16x32_bf16 v[76:79], v[188:191], v[140:143], v[76:79]
    v_mfma_f32_16x16x32_bf16 v[48:51], v[184:187], v[144:147], v[48:51]
    v_mfma_f32_16x16x32_bf16 v[80:83], v[188:191], v[144:147], v[80:83]
    v_mfma_f32_16x16x32_bf16 v[52:55], v[184:187], v[148:151], v[52:55]
    v_mfma_f32_16x16x32_bf16 v[84:87], v[188:191], v[148:151], v[84:87]
    v_mfma_f32_16x16x32_bf16 v[56:59], v[184:187], v[152:155], v[56:59]
    v_mfma_f32_16x16x32_bf16 v[88:91], v[188:191], v[152:155], v[88:91]
    v_mfma_f32_16x16x32_bf16 v[60:63], v[184:187], v[156:159], v[60:63]
    v_mfma_f32_16x16x32_bf16 v[92:95], v[188:191], v[156:159], v[92:95]
    s_lshl_b32 s86, s76, 3
    s_lshl_b32 s87, s72, 2
    s_add_u32 s86, s86, s87
    s_lshl_b32 s60, s86, 10
    s_mov_b32 s61, 1024
    s_mov_b32 s62, 2048
    s_mov_b32 s63, 3072
    s_lshl_b32 s86, s72, 17
    s_lshl_b32 s87, s76, 6
    s_add_u32 s56, s86, s87
    s_mov_b32 s57, 32768
    s_mov_b32 s58, 65536
    s_mov_b32 s59, 98304
    s_mov_b32 s52, 29360128
    s_mov_b32 s53, 33554432
    s_mov_b32 s4, s16
    s_mov_b32 s5, s17
    s_mov_b32 s6, 4194304
    s_mov_b32 s7, 0x20000
    s_mov_b32 s64, s36
    s_mov_b32 s65, s37
    s_mov_b32 s66, 4194304
    s_mov_b32 s67, 0x20000
    s_add_u32 s8, s40, s52
    s_addc_u32 s9, s41, 0
    s_mov_b32 s10, 4194304
    s_mov_b32 s11, 0x20000
    s_add_u32 s44, s40, s53
    s_addc_u32 s45, s41, 0
    s_mov_b32 s46, 4194304
    s_mov_b32 s47, 0x20000
    s_lshl_b32 s86, s77, 7
    s_add_u32 s86, s86, 16384
    s_lshl_b32 s87, s75, 6
    s_add_u32 s86, s86, s87
    v_mov_b32 v204, s86
    v_xor_b32 v205, 64, v204
    v_mov_b32 v206, 65536
    s_cmp_lg_u32 s3, 0
    s_cbranch_scc1 fs_3
    buffer_load_dwordx2 v[200:201], v205, s[48:51], 0 offen sc1
fs_3:
    v_lshrrev_b32 v2, 4, v1
    v_and_b32 v3, 1, v2
    v_lshlrev_b32 v3, 5, v3
    v_lshrrev_b32 v2, 1, v2
    v_lshl_add_u32 v3, v2, 4, v3
    v_and_b32 v2, 15, v1
    v_lshl_add_u32 v3, v2, 11, v3
    s_lshl_b32 s86, s71, 18
    s_lshl_b32 s87, s70, 8
    s_add_u32 s86, s86, s87
    s_add_u32 s86, s86, s56
    v_add_u32 v202, s86, v3
    s_lshl_b32 s86, s77, 15
    s_add_u32 s86, s86, s60
    v_lshlrev_b32 v2, 4, v1
    v_add_u32 v203, s86, v2
    buffer_load_dwordx4 v[160:163], v202, s[4:7], 0 offen
    buffer_load_dwordx4 v[164:167], v202, s[4:7], s57 offen
    buffer_load_dwordx4 v[168:171], v202, s[4:7], s58 offen
    buffer_load_dwordx4 v[172:175], v202, s[4:7], s59 offen
    v_cvt_pk_bf16_f32 v96, v32, v33
    v_cvt_pk_bf16_f32 v97, v34, v35
    v_cvt_pk_bf16_f32 v98, v64, v65
    v_cvt_pk_bf16_f32 v99, v66, v67
    v_cvt_pk_bf16_f32 v100, v36, v37
    v_cvt_pk_bf16_f32 v101, v38, v39
    v_cvt_pk_bf16_f32 v102, v68, v69
    v_cvt_pk_bf16_f32 v103, v70, v71
    v_cvt_pk_bf16_f32 v104, v40, v41
    v_cvt_pk_bf16_f32 v105, v42, v43
    v_cvt_pk_bf16_f32 v106, v72, v73
    v_cvt_pk_bf16_f32 v107, v74, v75
    v_cvt_pk_bf16_f32 v108, v44, v45
    v_cvt_pk_bf16_f32 v109, v46, v47
    v_cvt_pk_bf16_f32 v110, v76, v77
    v_cvt_pk_bf16_f32 v111, v78, v79
    v_cvt_pk_bf16_f32 v112, v48, v49
    v_cvt_pk_bf16_f32 v113, v50, v51
    v_cvt_pk_bf16_f32 v114, v80, v81
    v_cvt_pk_bf16_f32 v115, v82, v83
    v_cvt_pk_bf16_f32 v116, v52, v53
    v_cvt_pk_bf16_f32 v117, v54, v55
    v_cvt_pk_bf16_f32 v118, v84, v85
    v_cvt_pk_bf16_f32 v119, v86, v87
    v_cvt_pk_bf16_f32 v120, v56, v57
    v_cvt_pk_bf16_f32 v121, v58, v59
    v_cvt_pk_bf16_f32 v122, v88, v89
    v_cvt_pk_bf16_f32 v123, v90, v91
    v_cvt_pk_bf16_f32 v124, v60, v61
    v_cvt_pk_bf16_f32 v125, v62, v63
    v_cvt_pk_bf16_f32 v126, v92, v93
    v_cvt_pk_bf16_f32 v127, v94, v95
    v_lshlrev_b32 v2, 4, v1
    s_lshl_b32 s86, s3, 12
    v_add_u32 v3, s86, v2
    s_xor_b32 s86, s86, 16384
    v_add_u32 v2, s86, v2
    s_barrier
    ds_write_b128 v3, v[112:115] offset:0
    ds_write_b128 v3, v[116:119] offset:1024
    ds_write_b128 v3, v[120:123] offset:2048
    ds_write_b128 v3, v[124:127] offset:3072
    s_cmp_lg_u32 s3, 0
    s_cbranch_scc1 dw_4
    s_waitcnt vmcnt(4)
    v_cmp_eq_u64 vcc, s[78:79], v[200:201]
    s_nop 1
    v_cndmask_b32 v200, 0, 1, vcc
    ds_write_b32 v206, v200
dw_4:
    s_waitcnt lgkmcnt(0)
    s_barrier
    ds_read_b128 v[112:115], v2 offset:0
    ds_read_b128 v[116:119], v2 offset:1024
    ds_read_b128 v[120:123], v2 offset:2048
    ds_read_b128 v[124:127], v2 offset:3072
    ds_read_b32 v200, v206
    s_waitcnt lgkmcnt(0)
    v_readfirstlane_b32 s55, v200
    s_cmp_eq_u32 s55, 0
    s_cbranch_scc1 dr_5
    buffer_load_dwordx4 v[176:179], v203, s[44:47], 0 offen sc1
    buffer_load_dwordx4 v[180:183], v203, s[44:47], s61 offen sc1
    buffer_load_dwordx4 v[184:187], v203, s[44:47], s62 offen sc1
    buffer_load_dwordx4 v[188:191], v203, s[44:47], s63 offen sc1
dr_5:
    s_lshl_b32 s90, s72, 31
    s_lshr_b32 s85, s90, 16
    s_or_b32 s90, s90, s85
    s_waitcnt lgkmcnt(0)
    v_lshlrev_b32 v48, 16, v96
    v_and_b32 v49, 0xffff0000, v96
    v_lshlrev_b32 v64, 16, v112
    v_and_b32 v65, 0xffff0000, v112
    v_lshlrev_b32 v50, 16, v97
    v_and_b32 v51, 0xffff0000, v97
    v_lshlrev_b32 v66, 16, v113
    v_and_b32 v67, 0xffff0000, v113
    v_lshlrev_b32 v52, 16, v98
    v_and_b32 v53, 0xffff0000, v98
    v_lshlrev_b32 v68, 16, v114
    v_and_b32 v69, 0xffff0000, v114
    v_lshlrev_b32 v54, 16, v99
    v_and_b32 v55, 0xffff0000, v99
    v_lshlrev_b32 v70, 16, v115
    v_and_b32 v71, 0xffff0000, v115
    v_lshlrev_b32 v56, 16, v100
    v_and_b32 v57, 0xffff0000, v100
    v_lshlrev_b32 v72, 16, v116
    v_and_b32 v73, 0xffff0000, v116
    v_lshlrev_b32 v58, 16, v101
    v_and_b32 v59, 0xffff0000, v101
    v_lshlrev_b32 v74, 16, v117
    v_and_b32 v75, 0xffff0000, v117
    v_lshlrev_b32 v60, 16, v102
    v_and_b32 v61, 0xffff0000, v102
    v_lshlrev_b32 v76, 16, v118
    v_and_b32 v77, 0xffff0000, v118
    v_lshlrev_b32 v62, 16, v103
    v_and_b32 v63, 0xffff0000, v103
    v_lshlrev_b32 v78, 16, v119
    v_and_b32 v79, 0xffff0000, v119
    v_sub_f32 v48, v48, v64
    v_sub_f32 v49, v49, v65
    v_sub_f32 v50, v50, v66
    v_sub_f32 v51, v51, v67
    v_sub_f32 v52, v52, v68
    v_sub_f32 v53, v53, v69
    v_sub_f32 v54, v54, v70
    v_sub_f32 v55, v55, v71
    v_sub_f32 v56, v56, v72
    v_sub_f32 v57, v57, v73
    v_sub_f32 v58, v58, v74
    v_sub_f32 v59, v59, v75
    v_sub_f32 v60, v60, v76
    v_sub_f32 v61, v61, v77
    v_sub_f32 v62, v62, v78
    v_sub_f32 v63, v63, v79
    v_cvt_pk_bf16_f32 v32, v48, v49
    v_cvt_pk_bf16_f32 v33, v50, v51
    v_cvt_pk_bf16_f32 v34, v52, v53
    v_cvt_pk_bf16_f32 v35, v54, v55
    v_cvt_pk_bf16_f32 v36, v56, v57
    v_cvt_pk_bf16_f32 v37, v58, v59
    v_cvt_pk_bf16_f32 v38, v60, v61
    v_cvt_pk_bf16_f32 v39, v62, v63
    v_lshlrev_b32 v48, 16, v104
    v_and_b32 v49, 0xffff0000, v104
    v_lshlrev_b32 v64, 16, v120
    v_and_b32 v65, 0xffff0000, v120
    v_lshlrev_b32 v50, 16, v105
    v_and_b32 v51, 0xffff0000, v105
    v_lshlrev_b32 v66, 16, v121
    v_and_b32 v67, 0xffff0000, v121
    v_lshlrev_b32 v52, 16, v106
    v_and_b32 v53, 0xffff0000, v106
    v_lshlrev_b32 v68, 16, v122
    v_and_b32 v69, 0xffff0000, v122
    v_lshlrev_b32 v54, 16, v107
    v_and_b32 v55, 0xffff0000, v107
    v_lshlrev_b32 v70, 16, v123
    v_and_b32 v71, 0xffff0000, v123
    v_lshlrev_b32 v56, 16, v108
    v_and_b32 v57, 0xffff0000, v108
    v_lshlrev_b32 v72, 16, v124
    v_and_b32 v73, 0xffff0000, v124
    v_lshlrev_b32 v58, 16, v109
    v_and_b32 v59, 0xffff0000, v109
    v_lshlrev_b32 v74, 16, v125
    v_and_b32 v75, 0xffff0000, v125
    v_lshlrev_b32 v60, 16, v110
    v_and_b32 v61, 0xffff0000, v110
    v_lshlrev_b32 v76, 16, v126
    v_and_b32 v77, 0xffff0000, v126
    v_lshlrev_b32 v62, 16, v111
    v_and_b32 v63, 0xffff0000, v111
    v_lshlrev_b32 v78, 16, v127
    v_and_b32 v79, 0xffff0000, v127
    v_sub_f32 v48, v48, v64
    v_sub_f32 v49, v49, v65
    v_sub_f32 v50, v50, v66
    v_sub_f32 v51, v51, v67
    v_sub_f32 v52, v52, v68
    v_sub_f32 v53, v53, v69
    v_sub_f32 v54, v54, v70
    v_sub_f32 v55, v55, v71
    v_sub_f32 v56, v56, v72
    v_sub_f32 v57, v57, v73
    v_sub_f32 v58, v58, v74
    v_sub_f32 v59, v59, v75
    v_sub_f32 v60, v60, v76
    v_sub_f32 v61, v61, v77
    v_sub_f32 v62, v62, v78
    v_sub_f32 v63, v63, v79
    v_cvt_pk_bf16_f32 v40, v48, v49
    v_cvt_pk_bf16_f32 v41, v50, v51
    v_cvt_pk_bf16_f32 v42, v52, v53
    v_cvt_pk_bf16_f32 v43, v54, v55
    v_cvt_pk_bf16_f32 v44, v56, v57
    v_cvt_pk_bf16_f32 v45, v58, v59
    v_cvt_pk_bf16_f32 v46, v60, v61
    v_cvt_pk_bf16_f32 v47, v62, v63
    v_xor_b32 v32, s90, v32
    v_xor_b32 v33, s90, v33
    v_xor_b32 v34, s90, v34
    v_xor_b32 v35, s90, v35
    v_xor_b32 v36, s90, v36
    v_xor_b32 v37, s90, v37
    v_xor_b32 v38, s90, v38
    v_xor_b32 v39, s90, v39
    v_xor_b32 v40, s90, v40
    v_xor_b32 v41, s90, v41
    v_xor_b32 v42, s90, v42
    v_xor_b32 v43, s90, v43
    v_xor_b32 v44, s90, v44
    v_xor_b32 v45, s90, v45
    v_xor_b32 v46, s90, v46
    v_xor_b32 v47, s90, v47
    s_nop 1
    v_permlane16_swap_b32 v32, v34
    v_permlane16_swap_b32 v33, v35
    v_permlane16_swap_b32 v36, v38
    v_permlane16_swap_b32 v37, v39
    v_permlane16_swap_b32 v40, v42
    v_permlane16_swap_b32 v41, v43
    v_permlane16_swap_b32 v44, v46
    v_permlane16_swap_b32 v45, v47
    s_branch kf_final
kf_typeO:
    s_mul_i32 s68, s72, 3670016
    s_mov_b32 s64, s32
    s_mov_b32 s65, s33
    s_mov_b32 s66, 7340032
    s_mov_b32 s67, 0x20000
    v_bfe_u32 v2, v1, 4, 1
    v_lshlrev_b32 v2, 1, v2
    v_and_b32 v3, 7, v1
    v_xor_b32 v2, v2, v3
    v_lshlrev_b32 v2, 4, v2
    v_lshrrev_b32 v3, 3, v1
    v_mul_u32_u24 v3, 2048, v3
    v_add_u32 v5, v2, v3
    s_and_b32 s86, s76, 1
    s_lshl_b32 s86, s86, 16
    s_lshr_b32 s87, s76, 1
    s_xor_b32 s87, s87, s72
    s_lshl_b32 s87, s87, 7
    s_add_u32 s86, s86, s87
    s_lshl_b32 s87, s70, 8
    s_add_u32 s86, s86, s87
    v_add_u32 v28, s86, v5
    v_xor_b32 v29, 64, v28
    v_add_u32 v29, 16384, v29
    v_add_u32 v30, 32768, v28
    v_add_u32 v31, 32768, v29
    s_mul_i32 s85, s84, 192
    s_add_u32 s85, s85, 512
    s_mov_b32 s12, s30
    s_mov_b32 s13, s31
    s_mov_b32 s14, 7168
    s_mov_b32 s15, 0x20000
    v_lshlrev_b32 v2, 4, v1
    s_lshl_b32 s86, s85, 1
    s_lshl_b32 s87, s3, 10
    s_add_u32 m0, s87, 131072
    s_nop 0
    buffer_load_dwordx4 v2, s[12:15], s86 offen lds
    s_mov_b32 s44, s28
    s_mov_b32 s45, s29
    s_mov_b32 s46, 7340032
    s_mov_b32 s47, 0x20000
    s_mov_b32 s56, 0
    s_mul_i32 s81, s3, 3072
    s_and_b32 s88, s3, 1
    s_lshl_b32 s88, s88, 2
    v_add_u32 v2, 0, v1
    v_mul_u32_u24 v3, 2731, v2
    v_lshrrev_b32 v3, 16, v3
    v_mul_u32_u24 v4, 24, v3
    v_sub_u32 v2, v2, v4
    v_bfe_u32 v4, v3, 1, 1
    v_lshlrev_b32 v4, 1, v4
    v_or_b32 v4, s88, v4
    v_xor_b32 v2, v2, v4
    v_mul_u32_u24 v3, 7168, v3
    v_lshl_add_u32 v3, v2, 4, v3
    s_mul_i32 s86, s3, 57344
    s_lshl_b32 s87, s85, 1
    s_add_u32 s86, s86, s87
    v_add_u32 v10, s86, v3
    v_add_u32 v2, 64, v1
    v_mul_u32_u24 v3, 2731, v2
    v_lshrrev_b32 v3, 16, v3
    v_mul_u32_u24 v4, 24, v3
    v_sub_u32 v2, v2, v4
    v_bfe_u32 v4, v3, 1, 1
    v_lshlrev_b32 v4, 1, v4
    v_or_b32 v4, s88, v4
    v_xor_b32 v2, v2, v4
    v_mul_u32_u24 v3, 7168, v3
    v_lshl_add_u32 v3, v2, 4, v3
    s_mul_i32 s86, s3, 57344
    s_lshl_b32 s87, s85, 1
    s_add_u32 s86, s86, s87
    v_add_u32 v11, s86, v3
    v_add_u32 v2, 128, v1
    v_mul_u32_u24 v3, 2731, v2
    v_lshrrev_b32 v3, 16, v3
    v_mul_u32_u24 v4, 24, v3
    v_sub_u32 v2, v2, v4
    v_bfe_u32 v4, v3, 1, 1
    v_lshlrev_b32 v4, 1, v4
    v_or_b32 v4, s88, v4
    v_xor_b32 v2, v2, v4
    v_mul_u32_u24 v3, 7168, v3
    v_lshl_add_u32 v3, v2, 4, v3
    s_mul_i32 s86, s3, 57344
    s_lshl_b32 s87, s85, 1
    s_add_u32 s86, s86, s87
    v_add_u32 v12, s86, v3
    v_lshrrev_b32 v2, 4, v1
    v_bfe_u32 v3, v1, 2, 2
    v_lshl_add_u32 v4, v2, 3, v3
    v_mul_u32_u24 v4, 384, v4
    v_and_b32 v2, 1, v2
    v_lshlrev_b32 v2, 1, v2
    v_lshrrev_b32 v3, 1, v3
    v_or_b32 v2, v2, v3
    v_lshlrev_b32 v2, 5, v2
    v_bfe_u32 v3, v1, 1, 1
    v_lshlrev_b32 v3, 4, v3
    v_or_b32 v2, v2, v3
    v_and_b32 v3, 1, v1
    v_lshl_add_u32 v4, v3, 3, v4
    v_xor_b32 v3, 0, v2
    v_add_u32 v20, v3, v4
    v_xor_b32 v3, 32, v2
    v_add_u32 v21, v3, v4
    v_xor_b32 v3, 64, v2
    v_add_u32 v22, v3, v4
    v_xor_b32 v3, 96, v2
    v_add_u32 v23, v3, v4
    v_lshrrev_b32 v2, 4, v1
    v_bfe_u32 v3, v1, 2, 2
    v_lshl_add_u32 v4, v2, 3, v3
    v_mul_u32_u24 v4, 384, v4
    v_and_b32 v2, 1, v2
    v_lshlrev_b32 v2, 1, v2
    v_lshrrev_b32 v3, 1, v3
    v_or_b32 v2, v2, v3
    v_lshlrev_b32 v2, 5, v2
    v_bfe_u32 v3, v1, 1, 1
    v_lshlrev_b32 v3, 4, v3
    v_or_b32 v2, v2, v3
    v_and_b32 v3, 1, v1
    v_lshl_add_u32 v4, v3, 3, v4
    v_add_u32 v4, 65536, v4
    v_xor_b32 v3, 0, v2
    v_add_u32 v24, v3, v4
    v_xor_b32 v3, 32, v2
    v_add_u32 v25, v3, v4
    v_xor_b32 v3, 64, v2
    v_add_u32 v26, v3, v4
    v_xor_b32 v3, 96, v2
    v_add_u32 v27, v3, v4
    s_add_u32 m0, s81, 0
    s_nop 0
    buffer_load_dwordx4 v10, s[44:47], s56 offen nt lds
    s_add_u32 m0, s81, 1024
    s_nop 0
    buffer_load_dwordx4 v11, s[44:47], s56 offen nt lds
    s_add_u32 m0, s81, 2048
    s_nop 0
    buffer_load_dwordx4 v12, s[44:47], s56 offen nt lds
    s_add_u32 s56, s56, 458752
    s_add_u32 m0, s81, 24576
    s_nop 0
    buffer_load_dwordx4 v10, s[44:47], s56 offen nt lds
    s_add_u32 m0, s81, 25600
    s_nop 0
    buffer_load_dwordx4 v11, s[44:47], s56 offen nt lds
    s_add_u32 m0, s81, 26624
    s_nop 0
    buffer_load_dwordx4 v12, s[44:47], s56 offen nt lds
    s_add_u32 s56, s56, 458752
    s_add_u32 m0, s81, 49152
    s_nop 0
    buffer_load_dwordx4 v10, s[44:47], s56 offen nt lds
    s_add_u32 m0, s81, 50176
    s_nop 0
    buffer_load_dwordx4 v11, s[44:47], s56 offen nt lds
    s_add_u32 m0, s81, 51200
    s_nop 0
    buffer_load_dwordx4 v12, s[44:47], s56 offen nt lds
    s_add_u32 s56, s56, 458752
    s_add_u32 m0, s81, 73728
    s_nop 0
    buffer_load_dwordx4 v10, s[44:47], s56 offen nt lds
    s_add_u32 m0, s81, 74752
    s_nop 0
    buffer_load_dwordx4 v11, s[44:47], s56 offen nt lds
    s_add_u32 m0, s81, 75776
    s_nop 0
    buffer_load_dwordx4 v12, s[44:47], s56 offen nt lds
    s_waitcnt vmcnt(14)
    v_lshlrev_b32 v56, 16, v48
    v_and_b32 v57, 0xffff0000, v48
    v_lshlrev_b32 v58, 16, v49
    v_and_b32 v59, 0xffff0000, v49
    v_lshlrev_b32 v60, 16, v50
    v_and_b32 v61, 0xffff0000, v50
    v_lshlrev_b32 v62, 16, v51
    v_and_b32 v63, 0xffff0000, v51
    s_waitcnt vmcnt(13)
    v_lshlrev_b32 v64, 16, v52
    v_and_b32 v65, 0xffff0000, v52
    v_lshlrev_b32 v66, 16, v53
    v_and_b32 v67, 0xffff0000, v53
    v_lshlrev_b32 v68, 16, v54
    v_and_b32 v69, 0xffff0000, v54
    v_lshlrev_b32 v70, 16, v55
    v_and_b32 v71, 0xffff0000, v55
    v_add_f32 v72, v56, v57
    v_add_f32 v73, v58, v59
    v_add_f32 v74, v60, v61
    v_add_f32 v75, v62, v63
    v_add_f32 v76, v64, v65
    v_add_f32 v77, v66, v67
    v_add_f32 v78, v68, v69
    v_add_f32 v79, v70, v71
    v_add_f32 v72, v72, v76
    v_add_f32 v73, v73, v77
    v_add_f32 v74, v74, v78
    v_add_f32 v75, v75, v79
    v_add_f32 v72, v72, v74
    v_add_f32 v73, v73, v75
    v_add_f32 v72, v72, v73
    s_nop 1
    v_add_f32_dpp v73, v72, v72 quad_perm:[1,0,3,2] row_mask:0xf bank_mask:0xf
    v_mov_b32 v72, v73
    s_nop 1
    v_add_f32_dpp v73, v72, v72 quad_perm:[2,3,0,1] row_mask:0xf bank_mask:0xf
    v_mov_b32 v72, v73
    s_nop 1
    v_add_f32_dpp v73, v72, v72 row_half_mirror row_mask:0xf bank_mask:0xf
    v_mov_b32 v72, v73
    s_nop 1
    v_add_f32_dpp v73, v72, v72 row_mirror row_mask:0xf bank_mask:0xf
    v_mov_b32 v72, v73
    s_nop 0
    v_readlane_b32 s86, v72, 0
    v_readlane_b32 s87, v72, 16
    v_readlane_b32 s88, v72, 32
    v_readlane_b32 s89, v72, 48
    s_nop 1
    v_mov_b32 v72, s86
    v_add_f32 v72, s87, v72
    v_add_f32 v72, s88, v72
    v_add_f32 v72, s89, v72
    v_mul_f32 v72, 0x3a800000, v72
    v_sub_f32 v84, v56, v72
    v_sub_f32 v85, v57, v72
    v_sub_f32 v86, v58, v72
    v_sub_f32 v87, v59, v72
    v_sub_f32 v88, v60, v72
    v_sub_f32 v89, v61, v72
    v_sub_f32 v90, v62, v72
    v_sub_f32 v91, v63, v72
    v_sub_f32 v92, v64, v72
    v_sub_f32 v93, v65, v72
    v_sub_f32 v94, v66, v72
    v_sub_f32 v95, v67, v72
    v_sub_f32 v96, v68, v72
    v_sub_f32 v97, v69, v72
    v_sub_f32 v98, v70, v72
    v_sub_f32 v99, v71, v72
    v_mul_f32 v74, v84, v84
    v_fmac_f32 v74, v85, v85
    v_mul_f32 v75, v86, v86
    v_fmac_f32 v75, v87, v87
    v_mul_f32 v76, v88, v88
    v_fmac_f32 v76, v89, v89
    v_mul_f32 v77, v90, v90
    v_fmac_f32 v77, v91, v91
    v_mul_f32 v78, v92, v92
    v_fmac_f32 v78, v93, v93
    v_mul_f32 v79, v94, v94
    v_fmac_f32 v79, v95, v95
    v_mul_f32 v80, v96, v96
    v_fmac_f32 v80, v97, v97
    v_mul_f32 v81, v98, v98
    v_fmac_f32 v81, v99, v99
    v_add_f32 v74, v74, v78
    v_add_f32 v75, v75, v79
    v_add_f32 v76, v76, v80
    v_add_f32 v77, v77, v81
    v_add_f32 v74, v74, v76
    v_add_f32 v75, v75, v77
    v_add_f32 v74, v74, v75
    s_nop 1
    v_add_f32_dpp v75, v74, v74 quad_perm:[1,0,3,2] row_mask:0xf bank_mask:0xf
    v_mov_b32 v74, v75
    s_nop 1
    v_add_f32_dpp v75, v74, v74 quad_perm:[2,3,0,1] row_mask:0xf bank_mask:0xf
    v_mov_b32 v74, v75
    s_nop 1
    v_add_f32_dpp v75, v74, v74 row_half_mirror row_mask:0xf bank_mask:0xf
    v_mov_b32 v74, v75
    s_nop 1
    v_add_f32_dpp v75, v74, v74 row_mirror row_mask:0xf bank_mask:0xf
    v_mov_b32 v74, v75
    s_nop 0
    v_readlane_b32 s86, v74, 0
    v_readlane_b32 s87, v74, 16
    v_readlane_b32 s88, v74, 32
    v_readlane_b32 s89, v74, 48
    s_nop 1
    v_mov_b32 v74, s86
    v_add_f32 v74, s87, v74
    v_add_f32 v74, s88, v74
    v_add_f32 v74, s89, v74
    v_mul_f32 v74, 0x3a800000, v74
    v_cvt_pk_bf16_f32 v75, v72, v74
    v_lshlrev_b32 v72, 16, v75
    v_and_b32 v74, 0xffff0000, v75
    v_add_f32 v74, 0x3727c5ac, v74
    v_cvt_pk_bf16_f32 v74, v74, v74
    v_lshlrev_b32 v74, 16, v74
    v_sqrt_f32 v74, v74
    s_nop 0
    v_cvt_pk_bf16_f32 v74, v74, v74
    v_lshlrev_b32 v74, 16, v74
    v_rcp_f32 v75, v74
    v_sub_f32 v56, v56, v72
    v_sub_f32 v57, v57, v72
    v_sub_f32 v58, v58, v72
    v_sub_f32 v59, v59, v72
    v_sub_f32 v60, v60, v72
    v_sub_f32 v61, v61, v72
    v_sub_f32 v62, v62, v72
    v_sub_f32 v63, v63, v72
    v_sub_f32 v64, v64, v72
    v_sub_f32 v65, v65, v72
    v_sub_f32 v66, v66, v72
    v_sub_f32 v67, v67, v72
    v_sub_f32 v68, v68, v72
    v_sub_f32 v69, v69, v72
    v_sub_f32 v70, v70, v72
    v_sub_f32 v71, v71, v72
    v_cvt_pk_bf16_f32 v48, v56, v57
    v_cvt_pk_bf16_f32 v49, v58, v59
    v_cvt_pk_bf16_f32 v50, v60, v61
    v_cvt_pk_bf16_f32 v51, v62, v63
    v_cvt_pk_bf16_f32 v52, v64, v65
    v_cvt_pk_bf16_f32 v53, v66, v67
    v_cvt_pk_bf16_f32 v54, v68, v69
    v_cvt_pk_bf16_f32 v55, v70, v71
    v_lshlrev_b32 v56, 16, v48
    v_and_b32 v57, 0xffff0000, v48
    v_lshlrev_b32 v58, 16, v49
    v_and_b32 v59, 0xffff0000, v49
    v_lshlrev_b32 v60, 16, v50
    v_and_b32 v61, 0xffff0000, v50
    v_lshlrev_b32 v62, 16, v51
    v_and_b32 v63, 0xffff0000, v51
    v_lshlrev_b32 v64, 16, v52
    v_and_b32 v65, 0xffff0000, v52
    v_lshlrev_b32 v66, 16, v53
    v_and_b32 v67, 0xffff0000, v53
    v_lshlrev_b32 v68, 16, v54
    v_and_b32 v69, 0xffff0000, v54
    v_lshlrev_b32 v70, 16, v55
    v_and_b32 v71, 0xffff0000, v55
    v_mul_f32 v84, v56, v75
    v_mul_f32 v85, v57, v75
    v_mul_f32 v86, v58, v75
    v_mul_f32 v87, v59, v75
    v_mul_f32 v88, v60, v75
    v_mul_f32 v89, v61, v75
    v_mul_f32 v90, v62, v75
    v_mul_f32 v91, v63, v75
    v_mul_f32 v92, v64, v75
    v_mul_f32 v93, v65, v75
    v_mul_f32 v94, v66, v75
    v_mul_f32 v95, v67, v75
    v_mul_f32 v96, v68, v75
    v_mul_f32 v97, v69, v75
    v_mul_f32 v98, v70, v75
    v_mul_f32 v99, v71, v75
    v_fma_f32 v56, -v84, v74, v56
    v_fma_f32 v57, -v85, v74, v57
    v_fma_f32 v58, -v86, v74, v58
    v_fma_f32 v59, -v87, v74, v59
    v_fma_f32 v60, -v88, v74, v60
    v_fma_f32 v61, -v89, v74, v61
    v_fma_f32 v62, -v90, v74, v62
    v_fma_f32 v63, -v91, v74, v63
    v_fma_f32 v64, -v92, v74, v64
    v_fma_f32 v65, -v93, v74, v65
    v_fma_f32 v66, -v94, v74, v66
    v_fma_f32 v67, -v95, v74, v67
    v_fma_f32 v68, -v96, v74, v68
    v_fma_f32 v69, -v97, v74, v69
    v_fma_f32 v70, -v98, v74, v70
    v_fma_f32 v71, -v99, v74, v71
    v_fmac_f32 v84, v56, v75
    v_fmac_f32 v85, v57, v75
    v_fmac_f32 v86, v58, v75
    v_fmac_f32 v87, v59, v75
    v_fmac_f32 v88, v60, v75
    v_fmac_f32 v89, v61, v75
    v_fmac_f32 v90, v62, v75
    v_fmac_f32 v91, v63, v75
    v_fmac_f32 v92, v64, v75
    v_fmac_f32 v93, v65, v75
    v_fmac_f32 v94, v66, v75
    v_fmac_f32 v95, v67, v75
    v_fmac_f32 v96, v68, v75
    v_fmac_f32 v97, v69, v75
    v_fmac_f32 v98, v70, v75
    v_fmac_f32 v99, v71, v75
    v_cvt_pk_bf16_f32 v48, v84, v85
    v_cvt_pk_bf16_f32 v49, v86, v87
    v_cvt_pk_bf16_f32 v50, v88, v89
    v_cvt_pk_bf16_f32 v51, v90, v91
    v_cvt_pk_bf16_f32 v52, v92, v93
    v_cvt_pk_bf16_f32 v53, v94, v95
    v_cvt_pk_bf16_f32 v54, v96, v97
    v_cvt_pk_bf16_f32 v55, v98, v99
    ds_write_b128 v46, v[48:51]
    ds_write_b128 v46, v[52:55] offset:8192
    s_mov_b32 s12, s38
    s_mov_b32 s13, s39
    s_mov_b32 s14, 256
    s_mov_b32 s15, 0x20000
    buffer_load_dwordx2 v[42:43], v44, s[12:15], 0 offen sc1
    s_waitcnt lgkmcnt(0)
    s_barrier
    ds_read_b128 v[48:51], v47
    ds_read_b128 v[52:55], v47 offset:1024
    s_waitcnt lgkmcnt(0)
    buffer_store_dwordx4 v[48:51], v45, s[4:7], s61 offen sc1
    buffer_store_dwordx4 v[52:55], v45, s[4:7], s61 offen offset:2048 sc1
    s_waitcnt vmcnt(0)
    s_barrier
    s_cmp_lg_u32 s3, 0
    s_cbranch_scc1 kfxo_w
    v_readfirstlane_b32 s78, v42
    v_readfirstlane_b32 s79, v43
    s_cmp_lg_u32 s78, 0
    s_cbranch_scc1 kfxo_t2
    s_mov_b32 s12, s38
    s_mov_b32 s13, s39
    s_mov_b32 s14, 256
    s_mov_b32 s15, 0x20000
    v_mov_b32 v2, 0
    s_mov_b32 s93, 400000
kfxo_t:
    buffer_load_dwordx2 v[4:5], v2, s[12:15], 0 offen sc1
    s_waitcnt vmcnt(0)
    v_readfirstlane_b32 s78, v4
    v_readfirstlane_b32 s79, v5
    s_cmp_lg_u32 s78, 0
    s_cbranch_scc1 kfxo_t2
    s_sleep 1
    s_sub_u32 s93, s93, 1
    s_cmp_lg_u32 s93, 0
    s_cbranch_scc1 kfxo_t
kfxo_t2:
    v_mov_b32 v4, s78
    v_mov_b32 v5, s79
    v_mov_b32 v2, s60
    s_mov_b64 exec, 1
    buffer_store_dwordx2 v[4:5], v2, s[48:51], 0 offen sc1
    s_mov_b64 exec, -1
    v_and_b32 v2, 31, v1
    v_lshlrev_b32 v2, 3, v2
    s_lshl_b32 s86, s83, 8
    v_add_u32 v2, s86, v2
    s_mov_b32 s93, 400000
kfxo_p:
    buffer_load_dwordx2 v[4:5], v2, s[48:51], 0 offen sc1
    s_waitcnt vmcnt(0)
    v_cmp_ne_u64 vcc, s[78:79], v[4:5]
    s_cbranch_vccz kfxo_w
    s_sleep 1
    s_sub_u32 s93, s93, 1
    s_cmp_lg_u32 s93, 0
    s_cbranch_scc1 kfxo_p
kfxo_w:
    s_barrier
    buffer_load_dwordx4 a[0:3], v8, s[4:7], s80 offen offset:0 sc1
    buffer_load_dwordx4 a[4:7], v9, s[4:7], s80 offen offset:0 sc1
    buffer_load_dwordx4 a[8:11], v8, s[4:7], s80 offen offset:1024 sc1
    buffer_load_dwordx4 a[12:15], v9, s[4:7], s80 offen offset:1024 sc1
    s_waitcnt vmcnt(13)
    s_barrier
    buffer_load_dwordx4 a[16:19], v8, s[4:7], s80 offen offset:2048 sc1
    s_add_u32 s56, s56, 458752
    s_add_u32 m0, s81, 98304
    s_nop 0
    buffer_load_dwordx4 v10, s[44:47], s56 offen nt lds
    buffer_load_dwordx4 a[20:23], v9, s[4:7], s80 offen offset:2048 sc1
    s_add_u32 m0, s81, 99328
    s_nop 0
    buffer_load_dwordx4 v11, s[44:47], s56 offen nt lds
    ds_read_b64_tr_b16 v[128:129], v20 offset:0
    ds_read_b64_tr_b16 v[130:131], v20 offset:1536
    ds_read_b64_tr_b16 v[132:133], v21 offset:0
    ds_read_b64_tr_b16 v[134:135], v21 offset:1536
    ds_read_b64_tr_b16 v[136:137], v22 offset:0
    ds_read_b64_tr_b16 v[138:139], v22 offset:1536
    ds_read_b64_tr_b16 v[140:141], v23 offset:0
    ds_read_b64_tr_b16 v[142:143], v23 offset:1536
    ds_read_b64_tr_b16 v[144:145], v20 offset:128
    ds_read_b64_tr_b16 v[146:147], v20 offset:1664
    ds_read_b64_tr_b16 v[148:149], v21 offset:128
    ds_read_b64_tr_b16 v[150:151], v21 offset:1664
    ds_read_b64_tr_b16 v[152:153], v22 offset:128
    ds_read_b64_tr_b16 v[154:155], v22 offset:1664
    ds_read_b64_tr_b16 v[156:157], v23 offset:128
    ds_read_b64_tr_b16 v[158:159], v23 offset:1664
    ds_read_b64_tr_b16 v[160:161], v20 offset:256
    ds_read_b64_tr_b16 v[162:163], v20 offset:1792
    ds_read_b64_tr_b16 v[164:165], v21 offset:256
    ds_read_b64_tr_b16 v[166:167], v21 offset:1792
    ds_read_b64_tr_b16 v[168:169], v22 offset:256
    ds_read_b64_tr_b16 v[170:171], v22 offset:1792
    ds_read_b64_tr_b16 v[172:173], v23 offset:256
    ds_read_b64_tr_b16 v[174:175], v23 offset:1792
    s_waitcnt vmcnt(6) lgkmcnt(0)
    v_mfma_f32_16x16x32_bf16 v[32:35], v[128:131], a[0:3], 0
    ds_read_b64_tr_b16 v[176:177], v20 offset:12288
    ds_read_b64_tr_b16 v[178:179], v20 offset:13824
    v_mfma_f32_16x16x32_bf16 v[36:39], v[128:131], a[4:7], 0
    ds_read_b64_tr_b16 v[180:181], v21 offset:12288
    v_mfma_f32_16x16x32_bf16 v[40:43], v[132:135], a[0:3], 0
    ds_read_b64_tr_b16 v[182:183], v21 offset:13824
    ds_read_b64_tr_b16 v[184:185], v22 offset:12288
    v_mfma_f32_16x16x32_bf16 v[44:47], v[132:135], a[4:7], 0
    ds_read_b64_tr_b16 v[186:187], v22 offset:13824
    v_mfma_f32_16x16x32_bf16 v[48:51], v[136:139], a[0:3], 0
    ds_read_b64_tr_b16 v[188:189], v23 offset:12288
    ds_read_b64_tr_b16 v[190:191], v23 offset:13824
    buffer_load_dwordx4 a[24:27], v8, s[4:7], s80 offen offset:3072 sc1
    v_mfma_f32_16x16x32_bf16 v[52:55], v[136:139], a[4:7], 0
    ds_read_b64_tr_b16 v[192:193], v20 offset:12416
    v_mfma_f32_16x16x32_bf16 v[56:59], v[140:143], a[0:3], 0
    ds_read_b64_tr_b16 v[194:195], v20 offset:13952
    ds_read_b64_tr_b16 v[196:197], v21 offset:12416
    v_mfma_f32_16x16x32_bf16 v[60:63], v[140:143], a[4:7], 0
    ds_read_b64_tr_b16 v[198:199], v21 offset:13952
    v_mfma_f32_16x16x32_bf16 v[64:67], v[144:147], a[0:3], 0
    ds_read_b64_tr_b16 v[200:201], v22 offset:12416
    ds_read_b64_tr_b16 v[202:203], v22 offset:13952
    v_mfma_f32_16x16x32_bf16 v[68:71], v[144:147], a[4:7], 0
    ds_read_b64_tr_b16 v[204:205], v23 offset:12416
    v_mfma_f32_16x16x32_bf16 v[72:75], v[148:151], a[0:3], 0
    ds_read_b64_tr_b16 v[206:207], v23 offset:13952
    ds_read_b64_tr_b16 v[208:209], v20 offset:12544
    v_mfma_f32_16x16x32_bf16 v[76:79], v[148:151], a[4:7], 0
    ds_read_b64_tr_b16 v[210:211], v20 offset:14080
    s_add_u32 m0, s81, 100352
    v_mfma_f32_16x16x32_bf16 v[80:83], v[152:155], a[0:3], 0
    ds_read_b64_tr_b16 v[212:213], v21 offset:12544
    ds_read_b64_tr_b16 v[214:215], v21 offset:14080
    buffer_load_dwordx4 v12, s[44:47], s56 offen nt lds
    v_mfma_f32_16x16x32_bf16 v[84:87], v[152:155], a[4:7], 0
    ds_read_b64_tr_b16 v[216:217], v22 offset:12544
    v_mfma_f32_16x16x32_bf16 v[88:91], v[156:159], a[0:3], 0
    ds_read_b64_tr_b16 v[218:219], v22 offset:14080
    ds_read_b64_tr_b16 v[220:221], v23 offset:12544
    v_mfma_f32_16x16x32_bf16 v[92:95], v[156:159], a[4:7], 0
    ds_read_b64_tr_b16 v[222:223], v23 offset:14080
    v_mfma_f32_16x16x32_bf16 v[96:99], v[160:163], a[0:3], 0
    v_mfma_f32_16x16x32_bf16 v[100:103], v[160:163], a[4:7], 0
    v_mfma_f32_16x16x32_bf16 v[104:107], v[164:167], a[0:3], 0
    v_mfma_f32_16x16x32_bf16 v[108:111], v[164:167], a[4:7], 0
    v_mfma_f32_16x16x32_bf16 v[112:115], v[168:171], a[0:3], 0
    buffer_load_dwordx4 a[28:31], v9, s[4:7], s80 offen offset:3072 sc1
    v_mfma_f32_16x16x32_bf16 v[116:119], v[168:171], a[4:7], 0
    v_mfma_f32_16x16x32_bf16 v[120:123], v[172:175], a[0:3], 0
    v_mfma_f32_16x16x32_bf16 v[124:127], v[172:175], a[4:7], 0
    s_waitcnt vmcnt(7) lgkmcnt(0)
    s_barrier
    v_mfma_f32_16x16x32_bf16 v[32:35], v[176:179], a[8:11], v[32:35]
    ds_read_b64_tr_b16 v[128:129], v20 offset:24576
    ds_read_b64_tr_b16 v[130:131], v20 offset:26112
    v_mfma_f32_16x16x32_bf16 v[36:39], v[176:179], a[12:15], v[36:39]
    ds_read_b64_tr_b16 v[132:133], v21 offset:24576
    v_mfma_f32_16x16x32_bf16 v[40:43], v[180:183], a[8:11], v[40:43]
    ds_read_b64_tr_b16 v[134:135], v21 offset:26112
    ds_read_b64_tr_b16 v[136:137], v22 offset:24576
    s_add_u32 s80, s80, 4096
    v_mfma_f32_16x16x32_bf16 v[44:47], v[180:183], a[12:15], v[44:47]
    ds_read_b64_tr_b16 v[138:139], v22 offset:26112
    buffer_load_dwordx4 a[0:3], v8, s[4:7], s80 offen offset:0 sc1
    v_mfma_f32_16x16x32_bf16 v[48:51], v[184:187], a[8:11], v[48:51]
    ds_read_b64_tr_b16 v[140:141], v23 offset:24576
    ds_read_b64_tr_b16 v[142:143], v23 offset:26112
    v_mfma_f32_16x16x32_bf16 v[52:55], v[184:187], a[12:15], v[52:55]
    ds_read_b64_tr_b16 v[144:145], v20 offset:24704
    v_mfma_f32_16x16x32_bf16 v[56:59], v[188:191], a[8:11], v[56:59]
    ds_read_b64_tr_b16 v[146:147], v20 offset:26240
    ds_read_b64_tr_b16 v[148:149], v21 offset:24704
    v_mfma_f32_16x16x32_bf16 v[60:63], v[188:191], a[12:15], v[60:63]
    ds_read_b64_tr_b16 v[150:151], v21 offset:26240
    v_mfma_f32_16x16x32_bf16 v[64:67], v[192:195], a[8:11], v[64:67]
    ds_read_b64_tr_b16 v[152:153], v22 offset:24704
    ds_read_b64_tr_b16 v[154:155], v22 offset:26240
    s_add_u32 s56, s56, 458752
    s_add_u32 m0, s81, 0
    v_mfma_f32_16x16x32_bf16 v[68:71], v[192:195], a[12:15], v[68:71]
    ds_read_b64_tr_b16 v[156:157], v23 offset:24704
    buffer_load_dwordx4 v10, s[44:47], s56 offen nt lds
    v_mfma_f32_16x16x32_bf16 v[72:75], v[196:199], a[8:11], v[72:75]
    ds_read_b64_tr_b16 v[158:159], v23 offset:26240
    ds_read_b64_tr_b16 v[160:161], v20 offset:24832
    v_mfma_f32_16x16x32_bf16 v[76:79], v[196:199], a[12:15], v[76:79]
    ds_read_b64_tr_b16 v[162:163], v20 offset:26368
    v_mfma_f32_16x16x32_bf16 v[80:83], v[200:203], a[8:11], v[80:83]
    ds_read_b64_tr_b16 v[164:165], v21 offset:24832
    ds_read_b64_tr_b16 v[166:167], v21 offset:26368
    v_mfma_f32_16x16x32_bf16 v[84:87], v[200:203], a[12:15], v[84:87]
    ds_read_b64_tr_b16 v[168:169], v22 offset:24832
    v_mfma_f32_16x16x32_bf16 v[88:91], v[204:207], a[8:11], v[88:91]
    ds_read_b64_tr_b16 v[170:171], v22 offset:26368
    ds_read_b64_tr_b16 v[172:173], v23 offset:24832
    v_mfma_f32_16x16x32_bf16 v[92:95], v[204:207], a[12:15], v[92:95]
    ds_read_b64_tr_b16 v[174:175], v23 offset:26368
    buffer_load_dwordx4 a[4:7], v9, s[4:7], s80 offen offset:0 sc1
    v_mfma_f32_16x16x32_bf16 v[96:99], v[208:211], a[8:11], v[96:99]
    v_mfma_f32_16x16x32_bf16 v[100:103], v[208:211], a[12:15], v[100:103]
    v_mfma_f32_16x16x32_bf16 v[104:107], v[212:215], a[8:11], v[104:107]
    v_mfma_f32_16x16x32_bf16 v[108:111], v[212:215], a[12:15], v[108:111]
    v_mfma_f32_16x16x32_bf16 v[112:115], v[216:219], a[8:11], v[112:115]
    s_add_u32 m0, s81, 1024
    v_mfma_f32_16x16x32_bf16 v[116:119], v[216:219], a[12:15], v[116:119]
    buffer_load_dwordx4 v11, s[44:47], s56 offen nt lds
    v_mfma_f32_16x16x32_bf16 v[120:123], v[220:223], a[8:11], v[120:123]
    v_mfma_f32_16x16x32_bf16 v[124:127], v[220:223], a[12:15], v[124:127]
    s_waitcnt vmcnt(8) lgkmcnt(0)
    v_mfma_f32_16x16x32_bf16 v[32:35], v[128:131], a[16:19], v[32:35]
    ds_read_b64_tr_b16 v[176:177], v20 offset:36864
    ds_read_b64_tr_b16 v[178:179], v20 offset:38400
    v_mfma_f32_16x16x32_bf16 v[36:39], v[128:131], a[20:23], v[36:39]
    ds_read_b64_tr_b16 v[180:181], v21 offset:36864
    v_mfma_f32_16x16x32_bf16 v[40:43], v[132:135], a[16:19], v[40:43]
    ds_read_b64_tr_b16 v[182:183], v21 offset:38400
    ds_read_b64_tr_b16 v[184:185], v22 offset:36864
    v_mfma_f32_16x16x32_bf16 v[44:47], v[132:135], a[20:23], v[44:47]
    ds_read_b64_tr_b16 v[186:187], v22 offset:38400
    v_mfma_f32_16x16x32_bf16 v[48:51], v[136:139], a[16:19], v[48:51]
    ds_read_b64_tr_b16 v[188:189], v23 offset:36864
    ds_read_b64_tr_b16 v[190:191], v23 offset:38400
    buffer_load_dwordx4 a[8:11], v8, s[4:7], s80 offen offset:1024 sc1
    v_mfma_f32_16x16x32_bf16 v[52:55], v[136:139], a[20:23], v[52:55]
    ds_read_b64_tr_b16 v[192:193], v20 offset:36992
    v_mfma_f32_16x16x32_bf16 v[56:59], v[140:143], a[16:19], v[56:59]
    ds_read_b64_tr_b16 v[194:195], v20 offset:38528
    ds_read_b64_tr_b16 v[196:197], v21 offset:36992
    v_mfma_f32_16x16x32_bf16 v[60:63], v[140:143], a[20:23], v[60:63]
    ds_read_b64_tr_b16 v[198:199], v21 offset:38528
    v_mfma_f32_16x16x32_bf16 v[64:67], v[144:147], a[16:19], v[64:67]
    ds_read_b64_tr_b16 v[200:201], v22 offset:36992
    ds_read_b64_tr_b16 v[202:203], v22 offset:38528
    v_mfma_f32_16x16x32_bf16 v[68:71], v[144:147], a[20:23], v[68:71]
    ds_read_b64_tr_b16 v[204:205], v23 offset:36992
    v_mfma_f32_16x16x32_bf16 v[72:75], v[148:151], a[16:19], v[72:75]
    ds_read_b64_tr_b16 v[206:207], v23 offset:38528
    ds_read_b64_tr_b16 v[208:209], v20 offset:37120
    v_mfma_f32_16x16x32_bf16 v[76:79], v[148:151], a[20:23], v[76:79]
    ds_read_b64_tr_b16 v[210:211], v20 offset:38656
    s_add_u32 m0, s81, 2048
    v_mfma_f32_16x16x32_bf16 v[80:83], v[152:155], a[16:19], v[80:83]
    ds_read_b64_tr_b16 v[212:213], v21 offset:37120
    ds_read_b64_tr_b16 v[214:215], v21 offset:38656
    buffer_load_dwordx4 v12, s[44:47], s56 offen nt lds
    v_mfma_f32_16x16x32_bf16 v[84:87], v[152:155], a[20:23], v[84:87]
    ds_read_b64_tr_b16 v[216:217], v22 offset:37120
    v_mfma_f32_16x16x32_bf16 v[88:91], v[156:159], a[16:19], v[88:91]
    ds_read_b64_tr_b16 v[218:219], v22 offset:38656
    ds_read_b64_tr_b16 v[220:221], v23 offset:37120
    v_mfma_f32_16x16x32_bf16 v[92:95], v[156:159], a[20:23], v[92:95]
    ds_read_b64_tr_b16 v[222:223], v23 offset:38656
    v_mfma_f32_16x16x32_bf16 v[96:99], v[160:163], a[16:19], v[96:99]
    v_mfma_f32_16x16x32_bf16 v[100:103], v[160:163], a[20:23], v[100:103]
    v_mfma_f32_16x16x32_bf16 v[104:107], v[164:167], a[16:19], v[104:107]
    v_mfma_f32_16x16x32_bf16 v[108:111], v[164:167], a[20:23], v[108:111]
    v_mfma_f32_16x16x32_bf16 v[112:115], v[168:171], a[16:19], v[112:115]
    buffer_load_dwordx4 a[12:15], v9, s[4:7], s80 offen offset:1024 sc1
    v_mfma_f32_16x16x32_bf16 v[116:119], v[168:171], a[20:23], v[116:119]
    v_mfma_f32_16x16x32_bf16 v[120:123], v[172:175], a[16:19], v[120:123]
    v_mfma_f32_16x16x32_bf16 v[124:127], v[172:175], a[20:23], v[124:127]
    s_waitcnt vmcnt(7) lgkmcnt(0)
    s_barrier
    v_mfma_f32_16x16x32_bf16 v[32:35], v[176:179], a[24:27], v[32:35]
    ds_read_b64_tr_b16 v[128:129], v20 offset:49152
    ds_read_b64_tr_b16 v[130:131], v20 offset:50688
    v_mfma_f32_16x16x32_bf16 v[36:39], v[176:179], a[28:31], v[36:39]
    ds_read_b64_tr_b16 v[132:133], v21 offset:49152
    v_mfma_f32_16x16x32_bf16 v[40:43], v[180:183], a[24:27], v[40:43]
    ds_read_b64_tr_b16 v[134:135], v21 offset:50688
    ds_read_b64_tr_b16 v[136:137], v22 offset:49152
    v_mfma_f32_16x16x32_bf16 v[44:47], v[180:183], a[28:31], v[44:47]
    ds_read_b64_tr_b16 v[138:139], v22 offset:50688
    buffer_load_dwordx4 a[16:19], v8, s[4:7], s80 offen offset:2048 sc1
    v_mfma_f32_16x16x32_bf16 v[48:51], v[184:187], a[24:27], v[48:51]
    ds_read_b64_tr_b16 v[140:141], v23 offset:49152
    ds_read_b64_tr_b16 v[142:143], v23 offset:50688
    v_mfma_f32_16x16x32_bf16 v[52:55], v[184:187], a[28:31], v[52:55]
    ds_read_b64_tr_b16 v[144:145], v20 offset:49280
    v_mfma_f32_16x16x32_bf16 v[56:59], v[188:191], a[24:27], v[56:59]
    ds_read_b64_tr_b16 v[146:147], v20 offset:50816
    ds_read_b64_tr_b16 v[148:149], v21 offset:49280
    v_mfma_f32_16x16x32_bf16 v[60:63], v[188:191], a[28:31], v[60:63]
    ds_read_b64_tr_b16 v[150:151], v21 offset:50816
    v_mfma_f32_16x16x32_bf16 v[64:67], v[192:195], a[24:27], v[64:67]
    ds_read_b64_tr_b16 v[152:153], v22 offset:49280
    ds_read_b64_tr_b16 v[154:155], v22 offset:50816
    s_add_u32 s56, s56, 458752
    s_add_u32 m0, s81, 24576
    v_mfma_f32_16x16x32_bf16 v[68:71], v[192:195], a[28:31], v[68:71]
    ds_read_b64_tr_b16 v[156:157], v23 offset:49280
    buffer_load_dwordx4 v10, s[44:47], s56 offen nt lds
    v_mfma_f32_16x16x32_bf16 v[72:75], v[196:199], a[24:27], v[72:75]
    ds_read_b64_tr_b16 v[158:159], v23 offset:50816
    ds_read_b64_tr_b16 v[160:161], v20 offset:49408
    v_mfma_f32_16x16x32_bf16 v[76:79], v[196:199], a[28:31], v[76:79]
    ds_read_b64_tr_b16 v[162:163], v20 offset:50944
    v_mfma_f32_16x16x32_bf16 v[80:83], v[200:203], a[24:27], v[80:83]
    ds_read_b64_tr_b16 v[164:165], v21 offset:49408
    ds_read_b64_tr_b16 v[166:167], v21 offset:50944
    v_mfma_f32_16x16x32_bf16 v[84:87], v[200:203], a[28:31], v[84:87]
    ds_read_b64_tr_b16 v[168:169], v22 offset:49408
    v_mfma_f32_16x16x32_bf16 v[88:91], v[204:207], a[24:27], v[88:91]
    ds_read_b64_tr_b16 v[170:171], v22 offset:50944
    ds_read_b64_tr_b16 v[172:173], v23 offset:49408
    v_mfma_f32_16x16x32_bf16 v[92:95], v[204:207], a[28:31], v[92:95]
    ds_read_b64_tr_b16 v[174:175], v23 offset:50944
    buffer_load_dwordx4 a[20:23], v9, s[4:7], s80 offen offset:2048 sc1
    v_mfma_f32_16x16x32_bf16 v[96:99], v[208:211], a[24:27], v[96:99]
    v_mfma_f32_16x16x32_bf16 v[100:103], v[208:211], a[28:31], v[100:103]
    v_mfma_f32_16x16x32_bf16 v[104:107], v[212:215], a[24:27], v[104:107]
    v_mfma_f32_16x16x32_bf16 v[108:111], v[212:215], a[28:31], v[108:111]
    v_mfma_f32_16x16x32_bf16 v[112:115], v[216:219], a[24:27], v[112:115]
    s_add_u32 m0, s81, 25600
    v_mfma_f32_16x16x32_bf16 v[116:119], v[216:219], a[28:31], v[116:119]
    buffer_load_dwordx4 v11, s[44:47], s56 offen nt lds
    v_mfma_f32_16x16x32_bf16 v[120:123], v[220:223], a[24:27], v[120:123]
    v_mfma_f32_16x16x32_bf16 v[124:127], v[220:223], a[28:31], v[124:127]
    s_waitcnt vmcnt(8) lgkmcnt(0)
    v_mfma_f32_16x16x32_bf16 v[32:35], v[128:131], a[0:3], v[32:35]
    ds_read_b64_tr_b16 v[176:177], v20 offset:61440
    ds_read_b64_tr_b16 v[178:179], v20 offset:62976
    v_mfma_f32_16x16x32_bf16 v[36:39], v[128:131], a[4:7], v[36:39]
    ds_read_b64_tr_b16 v[180:181], v21 offset:61440
    v_mfma_f32_16x16x32_bf16 v[40:43], v[132:135], a[0:3], v[40:43]
    ds_read_b64_tr_b16 v[182:183], v21 offset:62976
    ds_read_b64_tr_b16 v[184:185], v22 offset:61440
    v_mfma_f32_16x16x32_bf16 v[44:47], v[132:135], a[4:7], v[44:47]
    ds_read_b64_tr_b16 v[186:187], v22 offset:62976
    v_mfma_f32_16x16x32_bf16 v[48:51], v[136:139], a[0:3], v[48:51]
    ds_read_b64_tr_b16 v[188:189], v23 offset:61440
    ds_read_b64_tr_b16 v[190:191], v23 offset:62976
    buffer_load_dwordx4 a[24:27], v8, s[4:7], s80 offen offset:3072 sc1
    v_mfma_f32_16x16x32_bf16 v[52:55], v[136:139], a[4:7], v[52:55]
    ds_read_b64_tr_b16 v[192:193], v20 offset:61568
    v_mfma_f32_16x16x32_bf16 v[56:59], v[140:143], a[0:3], v[56:59]
    ds_read_b64_tr_b16 v[194:195], v20 offset:63104
    ds_read_b64_tr_b16 v[196:197], v21 offset:61568
    v_mfma_f32_16x16x32_bf16 v[60:63], v[140:143], a[4:7], v[60:63]
    ds_read_b64_tr_b16 v[198:199], v21 offset:63104
    v_mfma_f32_16x16x32_bf16 v[64:67], v[144:147], a[0:3], v[64:67]
    ds_read_b64_tr_b16 v[200:201], v22 offset:61568
    ds_read_b64_tr_b16 v[202:203], v22 offset:63104
    v_mfma_f32_16x16x32_bf16 v[68:71], v[144:147], a[4:7], v[68:71]
    ds_read_b64_tr_b16 v[204:205], v23 offset:61568
    v_mfma_f32_16x16x32_bf16 v[72:75], v[148:151], a[0:3], v[72:75]
    ds_read_b64_tr_b16 v[206:207], v23 offset:63104
    ds_read_b64_tr_b16 v[208:209], v20 offset:61696
    v_mfma_f32_16x16x32_bf16 v[76:79], v[148:151], a[4:7], v[76:79]
    ds_read_b64_tr_b16 v[210:211], v20 offset:63232
    s_add_u32 m0, s81, 26624
    v_mfma_f32_16x16x32_bf16 v[80:83], v[152:155], a[0:3], v[80:83]
    ds_read_b64_tr_b16 v[212:213], v21 offset:61696
    ds_read_b64_tr_b16 v[214:215], v21 offset:63232
    buffer_load_dwordx4 v12, s[44:47], s56 offen nt lds
    v_mfma_f32_16x16x32_bf16 v[84:87], v[152:155], a[4:7], v[84:87]
    ds_read_b64_tr_b16 v[216:217], v22 offset:61696
    v_mfma_f32_16x16x32_bf16 v[88:91], v[156:159], a[0:3], v[88:91]
    ds_read_b64_tr_b16 v[218:219], v22 offset:63232
    ds_read_b64_tr_b16 v[220:221], v23 offset:61696
    v_mfma_f32_16x16x32_bf16 v[92:95], v[156:159], a[4:7], v[92:95]
    ds_read_b64_tr_b16 v[222:223], v23 offset:63232
    v_mfma_f32_16x16x32_bf16 v[96:99], v[160:163], a[0:3], v[96:99]
    v_mfma_f32_16x16x32_bf16 v[100:103], v[160:163], a[4:7], v[100:103]
    v_mfma_f32_16x16x32_bf16 v[104:107], v[164:167], a[0:3], v[104:107]
    v_mfma_f32_16x16x32_bf16 v[108:111], v[164:167], a[4:7], v[108:111]
    v_mfma_f32_16x16x32_bf16 v[112:115], v[168:171], a[0:3], v[112:115]
    buffer_load_dwordx4 a[28:31], v9, s[4:7], s80 offen offset:3072 sc1
    v_mfma_f32_16x16x32_bf16 v[116:119], v[168:171], a[4:7], v[116:119]
    v_mfma_f32_16x16x32_bf16 v[120:123], v[172:175], a[0:3], v[120:123]
    v_mfma_f32_16x16x32_bf16 v[124:127], v[172:175], a[4:7], v[124:127]
    s_waitcnt vmcnt(7) lgkmcnt(0)
    s_barrier
    v_mfma_f32_16x16x32_bf16 v[32:35], v[176:179], a[8:11], v[32:35]
    ds_read_b64_tr_b16 v[128:129], v24 offset:8192
    ds_read_b64_tr_b16 v[130:131], v24 offset:9728
    v_mfma_f32_16x16x32_bf16 v[36:39], v[176:179], a[12:15], v[36:39]
    ds_read_b64_tr_b16 v[132:133], v25 offset:8192
    v_mfma_f32_16x16x32_bf16 v[40:43], v[180:183], a[8:11], v[40:43]
    ds_read_b64_tr_b16 v[134:135], v25 offset:9728
    ds_read_b64_tr_b16 v[136:137], v26 offset:8192
    s_add_u32 s80, s80, 4096
    v_mfma_f32_16x16x32_bf16 v[44:47], v[180:183], a[12:15], v[44:47]
    ds_read_b64_tr_b16 v[138:139], v26 offset:9728
    buffer_load_dwordx4 a[0:3], v8, s[4:7], s80 offen offset:0 sc1
    v_mfma_f32_16x16x32_bf16 v[48:51], v[184:187], a[8:11], v[48:51]
    ds_read_b64_tr_b16 v[140:141], v27 offset:8192
    ds_read_b64_tr_b16 v[142:143], v27 offset:9728
    v_mfma_f32_16x16x32_bf16 v[52:55], v[184:187], a[12:15], v[52:55]
    ds_read_b64_tr_b16 v[144:145], v24 offset:8320
    v_mfma_f32_16x16x32_bf16 v[56:59], v[188:191], a[8:11], v[56:59]
    ds_read_b64_tr_b16 v[146:147], v24 offset:9856
    ds_read_b64_tr_b16 v[148:149], v25 offset:8320
    v_mfma_f32_16x16x32_bf16 v[60:63], v[188:191], a[12:15], v[60:63]
    ds_read_b64_tr_b16 v[150:151], v25 offset:9856
    v_mfma_f32_16x16x32_bf16 v[64:67], v[192:195], a[8:11], v[64:67]
    ds_read_b64_tr_b16 v[152:153], v26 offset:8320
    ds_read_b64_tr_b16 v[154:155], v26 offset:9856
    s_add_u32 s56, s56, 458752
    s_add_u32 m0, s81, 49152
    v_mfma_f32_16x16x32_bf16 v[68:71], v[192:195], a[12:15], v[68:71]
    ds_read_b64_tr_b16 v[156:157], v27 offset:8320
    buffer_load_dwordx4 v10, s[44:47], s56 offen nt lds
    v_mfma_f32_16x16x32_bf16 v[72:75], v[196:199], a[8:11], v[72:75]
    ds_read_b64_tr_b16 v[158:159], v27 offset:9856
    ds_read_b64_tr_b16 v[160:161], v24 offset:8448
    v_mfma_f32_16x16x32_bf16 v[76:79], v[196:199], a[12:15], v[76:79]
    ds_read_b64_tr_b16 v[162:163], v24 offset:9984
    v_mfma_f32_16x16x32_bf16 v[80:83], v[200:203], a[8:11], v[80:83]
    ds_read_b64_tr_b16 v[164:165], v25 offset:8448
    ds_read_b64_tr_b16 v[166:167], v25 offset:9984
    v_mfma_f32_16x16x32_bf16 v[84:87], v[200:203], a[12:15], v[84:87]
    ds_read_b64_tr_b16 v[168:169], v26 offset:8448
    v_mfma_f32_16x16x32_bf16 v[88:91], v[204:207], a[8:11], v[88:91]
    ds_read_b64_tr_b16 v[170:171], v26 offset:9984
    ds_read_b64_tr_b16 v[172:173], v27 offset:8448
    v_mfma_f32_16x16x32_bf16 v[92:95], v[204:207], a[12:15], v[92:95]
    ds_read_b64_tr_b16 v[174:175], v27 offset:9984
    buffer_load_dwordx4 a[4:7], v9, s[4:7], s80 offen offset:0 sc1
    v_mfma_f32_16x16x32_bf16 v[96:99], v[208:211], a[8:11], v[96:99]
    v_mfma_f32_16x16x32_bf16 v[100:103], v[208:211], a[12:15], v[100:103]
    v_mfma_f32_16x16x32_bf16 v[104:107], v[212:215], a[8:11], v[104:107]
    v_mfma_f32_16x16x32_bf16 v[108:111], v[212:215], a[12:15], v[108:111]
    v_mfma_f32_16x16x32_bf16 v[112:115], v[216:219], a[8:11], v[112:115]
    s_add_u32 m0, s81, 50176
    v_mfma_f32_16x16x32_bf16 v[116:119], v[216:219], a[12:15], v[116:119]
    buffer_load_dwordx4 v11, s[44:47], s56 offen nt lds
    v_mfma_f32_16x16x32_bf16 v[120:123], v[220:223], a[8:11], v[120:123]
    v_mfma_f32_16x16x32_bf16 v[124:127], v[220:223], a[12:15], v[124:127]
    s_waitcnt vmcnt(8) lgkmcnt(0)
    v_mfma_f32_16x16x32_bf16 v[32:35], v[128:131], a[16:19], v[32:35]
    ds_read_b64_tr_b16 v[176:177], v24 offset:20480
    ds_read_b64_tr_b16 v[178:179], v24 offset:22016
    v_mfma_f32_16x16x32_bf16 v[36:39], v[128:131], a[20:23], v[36:39]
    ds_read_b64_tr_b16 v[180:181], v25 offset:20480
    v_mfma_f32_16x16x32_bf16 v[40:43], v[132:135], a[16:19], v[40:43]
    ds_read_b64_tr_b16 v[182:183], v25 offset:22016
    ds_read_b64_tr_b16 v[184:185], v26 offset:20480
    v_mfma_f32_16x16x32_bf16 v[44:47], v[132:135], a[20:23], v[44:47]
    ds_read_b64_tr_b16 v[186:187], v26 offset:22016
    v_mfma_f32_16x16x32_bf16 v[48:51], v[136:139], a[16:19], v[48:51]
    ds_read_b64_tr_b16 v[188:189], v27 offset:20480
    ds_read_b64_tr_b16 v[190:191], v27 offset:22016
    buffer_load_dwordx4 a[8:11], v8, s[4:7], s80 offen offset:1024 sc1
    v_mfma_f32_16x16x32_bf16 v[52:55], v[136:139], a[20:23], v[52:55]
    ds_read_b64_tr_b16 v[192:193], v24 offset:20608
    v_mfma_f32_16x16x32_bf16 v[56:59], v[140:143], a[16:19], v[56:59]
    ds_read_b64_tr_b16 v[194:195], v24 offset:22144
    ds_read_b64_tr_b16 v[196:197], v25 offset:20608
    v_mfma_f32_16x16x32_bf16 v[60:63], v[140:143], a[20:23], v[60:63]
    ds_read_b64_tr_b16 v[198:199], v25 offset:22144
    v_mfma_f32_16x16x32_bf16 v[64:67], v[144:147], a[16:19], v[64:67]
    ds_read_b64_tr_b16 v[200:201], v26 offset:20608
    ds_read_b64_tr_b16 v[202:203], v26 offset:22144
    v_mfma_f32_16x16x32_bf16 v[68:71], v[144:147], a[20:23], v[68:71]
    ds_read_b64_tr_b16 v[204:205], v27 offset:20608
    v_mfma_f32_16x16x32_bf16 v[72:75], v[148:151], a[16:19], v[72:75]
    ds_read_b64_tr_b16 v[206:207], v27 offset:22144
    ds_read_b64_tr_b16 v[208:209], v24 offset:20736
    v_mfma_f32_16x16x32_bf16 v[76:79], v[148:151], a[20:23], v[76:79]
    ds_read_b64_tr_b16 v[210:211], v24 offset:22272
    s_add_u32 m0, s81, 51200
    v_mfma_f32_16x16x32_bf16 v[80:83], v[152:155], a[16:19], v[80:83]
    ds_read_b64_tr_b16 v[212:213], v25 offset:20736
    ds_read_b64_tr_b16 v[214:215], v25 offset:22272
    buffer_load_dwordx4 v12, s[44:47], s56 offen nt lds
    v_mfma_f32_16x16x32_bf16 v[84:87], v[152:155], a[20:23], v[84:87]
    ds_read_b64_tr_b16 v[216:217], v26 offset:20736
    v_mfma_f32_16x16x32_bf16 v[88:91], v[156:159], a[16:19], v[88:91]
    ds_read_b64_tr_b16 v[218:219], v26 offset:22272
    ds_read_b64_tr_b16 v[220:221], v27 offset:20736
    v_mfma_f32_16x16x32_bf16 v[92:95], v[156:159], a[20:23], v[92:95]
    ds_read_b64_tr_b16 v[222:223], v27 offset:22272
    v_mfma_f32_16x16x32_bf16 v[96:99], v[160:163], a[16:19], v[96:99]
    v_mfma_f32_16x16x32_bf16 v[100:103], v[160:163], a[20:23], v[100:103]
    v_mfma_f32_16x16x32_bf16 v[104:107], v[164:167], a[16:19], v[104:107]
    v_mfma_f32_16x16x32_bf16 v[108:111], v[164:167], a[20:23], v[108:111]
    v_mfma_f32_16x16x32_bf16 v[112:115], v[168:171], a[16:19], v[112:115]
    buffer_load_dwordx4 a[12:15], v9, s[4:7], s80 offen offset:1024 sc1
    v_mfma_f32_16x16x32_bf16 v[116:119], v[168:171], a[20:23], v[116:119]
    v_mfma_f32_16x16x32_bf16 v[120:123], v[172:175], a[16:19], v[120:123]
    v_mfma_f32_16x16x32_bf16 v[124:127], v[172:175], a[20:23], v[124:127]
    s_waitcnt vmcnt(7) lgkmcnt(0)
    s_barrier
    v_mfma_f32_16x16x32_bf16 v[32:35], v[176:179], a[24:27], v[32:35]
    ds_read_b64_tr_b16 v[128:129], v24 offset:32768
    ds_read_b64_tr_b16 v[130:131], v24 offset:34304
    v_mfma_f32_16x16x32_bf16 v[36:39], v[176:179], a[28:31], v[36:39]
    ds_read_b64_tr_b16 v[132:133], v25 offset:32768
    v_mfma_f32_16x16x32_bf16 v[40:43], v[180:183], a[24:27], v[40:43]
    ds_read_b64_tr_b16 v[134:135], v25 offset:34304
    ds_read_b64_tr_b16 v[136:137], v26 offset:32768
    v_mfma_f32_16x16x32_bf16 v[44:47], v[180:183], a[28:31], v[44:47]
    ds_read_b64_tr_b16 v[138:139], v26 offset:34304
    buffer_load_dwordx4 a[16:19], v8, s[4:7], s80 offen offset:2048 sc1
    v_mfma_f32_16x16x32_bf16 v[48:51], v[184:187], a[24:27], v[48:51]
    ds_read_b64_tr_b16 v[140:141], v27 offset:32768
    ds_read_b64_tr_b16 v[142:143], v27 offset:34304
    v_mfma_f32_16x16x32_bf16 v[52:55], v[184:187], a[28:31], v[52:55]
    ds_read_b64_tr_b16 v[144:145], v24 offset:32896
    v_mfma_f32_16x16x32_bf16 v[56:59], v[188:191], a[24:27], v[56:59]
    ds_read_b64_tr_b16 v[146:147], v24 offset:34432
    ds_read_b64_tr_b16 v[148:149], v25 offset:32896
    v_mfma_f32_16x16x32_bf16 v[60:63], v[188:191], a[28:31], v[60:63]
    ds_read_b64_tr_b16 v[150:151], v25 offset:34432
    v_mfma_f32_16x16x32_bf16 v[64:67], v[192:195], a[24:27], v[64:67]
    ds_read_b64_tr_b16 v[152:153], v26 offset:32896
    ds_read_b64_tr_b16 v[154:155], v26 offset:34432
    s_add_u32 s56, s56, 458752
    s_add_u32 m0, s81, 73728
    v_mfma_f32_16x16x32_bf16 v[68:71], v[192:195], a[28:31], v[68:71]
    ds_read_b64_tr_b16 v[156:157], v27 offset:32896
    buffer_load_dwordx4 v10, s[44:47], s56 offen nt lds
    v_mfma_f32_16x16x32_bf16 v[72:75], v[196:199], a[24:27], v[72:75]
    ds_read_b64_tr_b16 v[158:159], v27 offset:34432
    ds_read_b64_tr_b16 v[160:161], v24 offset:33024
    v_mfma_f32_16x16x32_bf16 v[76:79], v[196:199], a[28:31], v[76:79]
    ds_read_b64_tr_b16 v[162:163], v24 offset:34560
    v_mfma_f32_16x16x32_bf16 v[80:83], v[200:203], a[24:27], v[80:83]
    ds_read_b64_tr_b16 v[164:165], v25 offset:33024
    ds_read_b64_tr_b16 v[166:167], v25 offset:34560
    v_mfma_f32_16x16x32_bf16 v[84:87], v[200:203], a[28:31], v[84:87]
    ds_read_b64_tr_b16 v[168:169], v26 offset:33024
    v_mfma_f32_16x16x32_bf16 v[88:91], v[204:207], a[24:27], v[88:91]
    ds_read_b64_tr_b16 v[170:171], v26 offset:34560
    ds_read_b64_tr_b16 v[172:173], v27 offset:33024
    v_mfma_f32_16x16x32_bf16 v[92:95], v[204:207], a[28:31], v[92:95]
    ds_read_b64_tr_b16 v[174:175], v27 offset:34560
    buffer_load_dwordx4 a[20:23], v9, s[4:7], s80 offen offset:2048 sc1
    v_mfma_f32_16x16x32_bf16 v[96:99], v[208:211], a[24:27], v[96:99]
    v_mfma_f32_16x16x32_bf16 v[100:103], v[208:211], a[28:31], v[100:103]
    v_mfma_f32_16x16x32_bf16 v[104:107], v[212:215], a[24:27], v[104:107]
    v_mfma_f32_16x16x32_bf16 v[108:111], v[212:215], a[28:31], v[108:111]
    v_mfma_f32_16x16x32_bf16 v[112:115], v[216:219], a[24:27], v[112:115]
    s_add_u32 m0, s81, 74752
    v_mfma_f32_16x16x32_bf16 v[116:119], v[216:219], a[28:31], v[116:119]
    buffer_load_dwordx4 v11, s[44:47], s56 offen nt lds
    v_mfma_f32_16x16x32_bf16 v[120:123], v[220:223], a[24:27], v[120:123]
    v_mfma_f32_16x16x32_bf16 v[124:127], v[220:223], a[28:31], v[124:127]
    s_waitcnt vmcnt(8) lgkmcnt(0)
    v_mfma_f32_16x16x32_bf16 v[32:35], v[128:131], a[0:3], v[32:35]
    ds_read_b64_tr_b16 v[176:177], v24 offset:45056
    ds_read_b64_tr_b16 v[178:179], v24 offset:46592
    v_mfma_f32_16x16x32_bf16 v[36:39], v[128:131], a[4:7], v[36:39]
    ds_read_b64_tr_b16 v[180:181], v25 offset:45056
    v_mfma_f32_16x16x32_bf16 v[40:43], v[132:135], a[0:3], v[40:43]
    ds_read_b64_tr_b16 v[182:183], v25 offset:46592
    ds_read_b64_tr_b16 v[184:185], v26 offset:45056
    v_mfma_f32_16x16x32_bf16 v[44:47], v[132:135], a[4:7], v[44:47]
    ds_read_b64_tr_b16 v[186:187], v26 offset:46592
    v_mfma_f32_16x16x32_bf16 v[48:51], v[136:139], a[0:3], v[48:51]
    ds_read_b64_tr_b16 v[188:189], v27 offset:45056
    ds_read_b64_tr_b16 v[190:191], v27 offset:46592
    buffer_load_dwordx4 a[24:27], v8, s[4:7], s80 offen offset:3072 sc1
    v_mfma_f32_16x16x32_bf16 v[52:55], v[136:139], a[4:7], v[52:55]
    ds_read_b64_tr_b16 v[192:193], v24 offset:45184
    v_mfma_f32_16x16x32_bf16 v[56:59], v[140:143], a[0:3], v[56:59]
    ds_read_b64_tr_b16 v[194:195], v24 offset:46720
    ds_read_b64_tr_b16 v[196:197], v25 offset:45184
    v_mfma_f32_16x16x32_bf16 v[60:63], v[140:143], a[4:7], v[60:63]
    ds_read_b64_tr_b16 v[198:199], v25 offset:46720
    v_mfma_f32_16x16x32_bf16 v[64:67], v[144:147], a[0:3], v[64:67]
    ds_read_b64_tr_b16 v[200:201], v26 offset:45184
    ds_read_b64_tr_b16 v[202:203], v26 offset:46720
    v_mfma_f32_16x16x32_bf16 v[68:71], v[144:147], a[4:7], v[68:71]
    ds_read_b64_tr_b16 v[204:205], v27 offset:45184
    v_mfma_f32_16x16x32_bf16 v[72:75], v[148:151], a[0:3], v[72:75]
    ds_read_b64_tr_b16 v[206:207], v27 offset:46720
    ds_read_b64_tr_b16 v[208:209], v24 offset:45312
    v_mfma_f32_16x16x32_bf16 v[76:79], v[148:151], a[4:7], v[76:79]
    ds_read_b64_tr_b16 v[210:211], v24 offset:46848
    s_add_u32 m0, s81, 75776
    v_mfma_f32_16x16x32_bf16 v[80:83], v[152:155], a[0:3], v[80:83]
    ds_read_b64_tr_b16 v[212:213], v25 offset:45312
    ds_read_b64_tr_b16 v[214:215], v25 offset:46848
    buffer_load_dwordx4 v12, s[44:47], s56 offen nt lds
    v_mfma_f32_16x16x32_bf16 v[84:87], v[152:155], a[4:7], v[84:87]
    ds_read_b64_tr_b16 v[216:217], v26 offset:45312
    v_mfma_f32_16x16x32_bf16 v[88:91], v[156:159], a[0:3], v[88:91]
    ds_read_b64_tr_b16 v[218:219], v26 offset:46848
    ds_read_b64_tr_b16 v[220:221], v27 offset:45312
    v_mfma_f32_16x16x32_bf16 v[92:95], v[156:159], a[4:7], v[92:95]
    ds_read_b64_tr_b16 v[222:223], v27 offset:46848
    v_mfma_f32_16x16x32_bf16 v[96:99], v[160:163], a[0:3], v[96:99]
    v_mfma_f32_16x16x32_bf16 v[100:103], v[160:163], a[4:7], v[100:103]
    v_mfma_f32_16x16x32_bf16 v[104:107], v[164:167], a[0:3], v[104:107]
    v_mfma_f32_16x16x32_bf16 v[108:111], v[164:167], a[4:7], v[108:111]
    v_mfma_f32_16x16x32_bf16 v[112:115], v[168:171], a[0:3], v[112:115]
    buffer_load_dwordx4 a[28:31], v9, s[4:7], s80 offen offset:3072 sc1
    v_mfma_f32_16x16x32_bf16 v[116:119], v[168:171], a[4:7], v[116:119]
    v_mfma_f32_16x16x32_bf16 v[120:123], v[172:175], a[0:3], v[120:123]
    v_mfma_f32_16x16x32_bf16 v[124:127], v[172:175], a[4:7], v[124:127]
    s_waitcnt vmcnt(7) lgkmcnt(0)
    s_barrier
    v_mfma_f32_16x16x32_bf16 v[32:35], v[176:179], a[8:11], v[32:35]
    ds_read_b64_tr_b16 v[128:129], v20 offset:0
    ds_read_b64_tr_b16 v[130:131], v20 offset:1536
    v_mfma_f32_16x16x32_bf16 v[36:39], v[176:179], a[12:15], v[36:39]
    ds_read_b64_tr_b16 v[132:133], v21 offset:0
    v_mfma_f32_16x16x32_bf16 v[40:43], v[180:183], a[8:11], v[40:43]
    ds_read_b64_tr_b16 v[134:135], v21 offset:1536
    ds_read_b64_tr_b16 v[136:137], v22 offset:0
    s_add_u32 s80, s80, 4096
    v_mfma_f32_16x16x32_bf16 v[44:47], v[180:183], a[12:15], v[44:47]
    ds_read_b64_tr_b16 v[138:139], v22 offset:1536
    buffer_load_dwordx4 a[0:3], v8, s[4:7], s80 offen offset:0 sc1
    v_mfma_f32_16x16x32_bf16 v[48:51], v[184:187], a[8:11], v[48:51]
    ds_read_b64_tr_b16 v[140:141], v23 offset:0
    ds_read_b64_tr_b16 v[142:143], v23 offset:1536
    v_mfma_f32_16x16x32_bf16 v[52:55], v[184:187], a[12:15], v[52:55]
    ds_read_b64_tr_b16 v[144:145], v20 offset:128
    v_mfma_f32_16x16x32_bf16 v[56:59], v[188:191], a[8:11], v[56:59]
    ds_read_b64_tr_b16 v[146:147], v20 offset:1664
    ds_read_b64_tr_b16 v[148:149], v21 offset:128
    v_mfma_f32_16x16x32_bf16 v[60:63], v[188:191], a[12:15], v[60:63]
    ds_read_b64_tr_b16 v[150:151], v21 offset:1664
    v_mfma_f32_16x16x32_bf16 v[64:67], v[192:195], a[8:11], v[64:67]
    ds_read_b64_tr_b16 v[152:153], v22 offset:128
    ds_read_b64_tr_b16 v[154:155], v22 offset:1664
    s_add_u32 s56, s56, 458752
    s_add_u32 m0, s81, 98304
    v_mfma_f32_16x16x32_bf16 v[68:71], v[192:195], a[12:15], v[68:71]
    ds_read_b64_tr_b16 v[156:157], v23 offset:128
    buffer_load_dwordx4 v10, s[44:47], s56 offen nt lds
    v_mfma_f32_16x16x32_bf16 v[72:75], v[196:199], a[8:11], v[72:75]
    ds_read_b64_tr_b16 v[158:159], v23 offset:1664
    ds_read_b64_tr_b16 v[160:161], v20 offset:256
    v_mfma_f32_16x16x32_bf16 v[76:79], v[196:199], a[12:15], v[76:79]
    ds_read_b64_tr_b16 v[162:163], v20 offset:1792
    v_mfma_f32_16x16x32_bf16 v[80:83], v[200:203], a[8:11], v[80:83]
    ds_read_b64_tr_b16 v[164:165], v21 offset:256
    ds_read_b64_tr_b16 v[166:167], v21 offset:1792
    v_mfma_f32_16x16x32_bf16 v[84:87], v[200:203], a[12:15], v[84:87]
    ds_read_b64_tr_b16 v[168:169], v22 offset:256
    v_mfma_f32_16x16x32_bf16 v[88:91], v[204:207], a[8:11], v[88:91]
    ds_read_b64_tr_b16 v[170:171], v22 offset:1792
    ds_read_b64_tr_b16 v[172:173], v23 offset:256
    v_mfma_f32_16x16x32_bf16 v[92:95], v[204:207], a[12:15], v[92:95]
    ds_read_b64_tr_b16 v[174:175], v23 offset:1792
    buffer_load_dwordx4 a[4:7], v9, s[4:7], s80 offen offset:0 sc1
    v_mfma_f32_16x16x32_bf16 v[96:99], v[208:211], a[8:11], v[96:99]
    v_mfma_f32_16x16x32_bf16 v[100:103], v[208:211], a[12:15], v[100:103]
    v_mfma_f32_16x16x32_bf16 v[104:107], v[212:215], a[8:11], v[104:107]
    v_mfma_f32_16x16x32_bf16 v[108:111], v[212:215], a[12:15], v[108:111]
    v_mfma_f32_16x16x32_bf16 v[112:115], v[216:219], a[8:11], v[112:115]
    s_add_u32 m0, s81, 99328
    v_mfma_f32_16x16x32_bf16 v[116:119], v[216:219], a[12:15], v[116:119]
    buffer_load_dwordx4 v11, s[44:47], s56 offen nt lds
    v_mfma_f32_16x16x32_bf16 v[120:123], v[220:223], a[8:11], v[120:123]
    v_mfma_f32_16x16x32_bf16 v[124:127], v[220:223], a[12:15], v[124:127]
    s_waitcnt vmcnt(8) lgkmcnt(0)
    v_mfma_f32_16x16x32_bf16 v[32:35], v[128:131], a[16:19], v[32:35]
    ds_read_b64_tr_b16 v[176:177], v20 offset:12288
    ds_read_b64_tr_b16 v[178:179], v20 offset:13824
    v_mfma_f32_16x16x32_bf16 v[36:39], v[128:131], a[20:23], v[36:39]
    ds_read_b64_tr_b16 v[180:181], v21 offset:12288
    v_mfma_f32_16x16x32_bf16 v[40:43], v[132:135], a[16:19], v[40:43]
    ds_read_b64_tr_b16 v[182:183], v21 offset:13824
    ds_read_b64_tr_b16 v[184:185], v22 offset:12288
    v_mfma_f32_16x16x32_bf16 v[44:47], v[132:135], a[20:23], v[44:47]
    ds_read_b64_tr_b16 v[186:187], v22 offset:13824
    v_mfma_f32_16x16x32_bf16 v[48:51], v[136:139], a[16:19], v[48:51]
    ds_read_b64_tr_b16 v[188:189], v23 offset:12288
    ds_read_b64_tr_b16 v[190:191], v23 offset:13824
    buffer_load_dwordx4 a[8:11], v8, s[4:7], s80 offen offset:1024 sc1
    v_mfma_f32_16x16x32_bf16 v[52:55], v[136:139], a[20:23], v[52:55]
    ds_read_b64_tr_b16 v[192:193], v20 offset:12416
    v_mfma_f32_16x16x32_bf16 v[56:59], v[140:143], a[16:19], v[56:59]
    ds_read_b64_tr_b16 v[194:195], v20 offset:13952
    ds_read_b64_tr_b16 v[196:197], v21 offset:12416
    v_mfma_f32_16x16x32_bf16 v[60:63], v[140:143], a[20:23], v[60:63]
    ds_read_b64_tr_b16 v[198:199], v21 offset:13952
    v_mfma_f32_16x16x32_bf16 v[64:67], v[144:147], a[16:19], v[64:67]
    ds_read_b64_tr_b16 v[200:201], v22 offset:12416
    ds_read_b64_tr_b16 v[202:203], v22 offset:13952
    v_mfma_f32_16x16x32_bf16 v[68:71], v[144:147], a[20:23], v[68:71]
    ds_read_b64_tr_b16 v[204:205], v23 offset:12416
    v_mfma_f32_16x16x32_bf16 v[72:75], v[148:151], a[16:19], v[72:75]
    ds_read_b64_tr_b16 v[206:207], v23 offset:13952
    ds_read_b64_tr_b16 v[208:209], v20 offset:12544
    v_mfma_f32_16x16x32_bf16 v[76:79], v[148:151], a[20:23], v[76:79]
    ds_read_b64_tr_b16 v[210:211], v20 offset:14080
    s_add_u32 m0, s81, 100352
    v_mfma_f32_16x16x32_bf16 v[80:83], v[152:155], a[16:19], v[80:83]
    ds_read_b64_tr_b16 v[212:213], v21 offset:12544
    ds_read_b64_tr_b16 v[214:215], v21 offset:14080
    buffer_load_dwordx4 v12, s[44:47], s56 offen nt lds
    v_mfma_f32_16x16x32_bf16 v[84:87], v[152:155], a[20:23], v[84:87]
    ds_read_b64_tr_b16 v[216:217], v22 offset:12544
    v_mfma_f32_16x16x32_bf16 v[88:91], v[156:159], a[16:19], v[88:91]
    ds_read_b64_tr_b16 v[218:219], v22 offset:14080
    ds_read_b64_tr_b16 v[220:221], v23 offset:12544
    v_mfma_f32_16x16x32_bf16 v[92:95], v[156:159], a[20:23], v[92:95]
    ds_read_b64_tr_b16 v[222:223], v23 offset:14080
    v_mfma_f32_16x16x32_bf16 v[96:99], v[160:163], a[16:19], v[96:99]
    v_mfma_f32_16x16x32_bf16 v[100:103], v[160:163], a[20:23], v[100:103]
    v_mfma_f32_16x16x32_bf16 v[104:107], v[164:167], a[16:19], v[104:107]
    v_mfma_f32_16x16x32_bf16 v[108:111], v[164:167], a[20:23], v[108:111]
    v_mfma_f32_16x16x32_bf16 v[112:115], v[168:171], a[16:19], v[112:115]
    buffer_load_dwordx4 a[12:15], v9, s[4:7], s80 offen offset:1024 sc1
    v_mfma_f32_16x16x32_bf16 v[116:119], v[168:171], a[20:23], v[116:119]
    v_mfma_f32_16x16x32_bf16 v[120:123], v[172:175], a[16:19], v[120:123]
    v_mfma_f32_16x16x32_bf16 v[124:127], v[172:175], a[20:23], v[124:127]
    s_waitcnt vmcnt(7) lgkmcnt(0)
    s_barrier
    v_mfma_f32_16x16x32_bf16 v[32:35], v[176:179], a[24:27], v[32:35]
    ds_read_b64_tr_b16 v[128:129], v20 offset:24576
    ds_read_b64_tr_b16 v[130:131], v20 offset:26112
    v_mfma_f32_16x16x32_bf16 v[36:39], v[176:179], a[28:31], v[36:39]
    ds_read_b64_tr_b16 v[132:133], v21 offset:24576
    v_mfma_f32_16x16x32_bf16 v[40:43], v[180:183], a[24:27], v[40:43]
    ds_read_b64_tr_b16 v[134:135], v21 offset:26112
    ds_read_b64_tr_b16 v[136:137], v22 offset:24576
    v_mfma_f32_16x16x32_bf16 v[44:47], v[180:183], a[28:31], v[44:47]
    ds_read_b64_tr_b16 v[138:139], v22 offset:26112
    buffer_load_dwordx4 a[16:19], v8, s[4:7], s80 offen offset:2048 sc1
    v_mfma_f32_16x16x32_bf16 v[48:51], v[184:187], a[24:27], v[48:51]
    ds_read_b64_tr_b16 v[140:141], v23 offset:24576
    ds_read_b64_tr_b16 v[142:143], v23 offset:26112
    v_mfma_f32_16x16x32_bf16 v[52:55], v[184:187], a[28:31], v[52:55]
    ds_read_b64_tr_b16 v[144:145], v20 offset:24704
    v_mfma_f32_16x16x32_bf16 v[56:59], v[188:191], a[24:27], v[56:59]
    ds_read_b64_tr_b16 v[146:147], v20 offset:26240
    ds_read_b64_tr_b16 v[148:149], v21 offset:24704
    v_mfma_f32_16x16x32_bf16 v[60:63], v[188:191], a[28:31], v[60:63]
    ds_read_b64_tr_b16 v[150:151], v21 offset:26240
    v_mfma_f32_16x16x32_bf16 v[64:67], v[192:195], a[24:27], v[64:67]
    ds_read_b64_tr_b16 v[152:153], v22 offset:24704
    ds_read_b64_tr_b16 v[154:155], v22 offset:26240
    s_add_u32 s56, s56, 458752
    s_add_u32 m0, s81, 0
    v_mfma_f32_16x16x32_bf16 v[68:71], v[192:195], a[28:31], v[68:71]
    ds_read_b64_tr_b16 v[156:157], v23 offset:24704
    buffer_load_dwordx4 v10, s[44:47], s56 offen nt lds
    v_mfma_f32_16x16x32_bf16 v[72:75], v[196:199], a[24:27], v[72:75]
    ds_read_b64_tr_b16 v[158:159], v23 offset:26240
    ds_read_b64_tr_b16 v[160:161], v20 offset:24832
    v_mfma_f32_16x16x32_bf16 v[76:79], v[196:199], a[28:31], v[76:79]
    ds_read_b64_tr_b16 v[162:163], v20 offset:26368
    v_mfma_f32_16x16x32_bf16 v[80:83], v[200:203], a[24:27], v[80:83]
    ds_read_b64_tr_b16 v[164:165], v21 offset:24832
    ds_read_b64_tr_b16 v[166:167], v21 offset:26368
    v_mfma_f32_16x16x32_bf16 v[84:87], v[200:203], a[28:31], v[84:87]
    ds_read_b64_tr_b16 v[168:169], v22 offset:24832
    v_mfma_f32_16x16x32_bf16 v[88:91], v[204:207], a[24:27], v[88:91]
    ds_read_b64_tr_b16 v[170:171], v22 offset:26368
    ds_read_b64_tr_b16 v[172:173], v23 offset:24832
    v_mfma_f32_16x16x32_bf16 v[92:95], v[204:207], a[28:31], v[92:95]
    ds_read_b64_tr_b16 v[174:175], v23 offset:26368
    buffer_load_dwordx4 a[20:23], v9, s[4:7], s80 offen offset:2048 sc1
    v_mfma_f32_16x16x32_bf16 v[96:99], v[208:211], a[24:27], v[96:99]
    v_mfma_f32_16x16x32_bf16 v[100:103], v[208:211], a[28:31], v[100:103]
    v_mfma_f32_16x16x32_bf16 v[104:107], v[212:215], a[24:27], v[104:107]
    v_mfma_f32_16x16x32_bf16 v[108:111], v[212:215], a[28:31], v[108:111]
    v_mfma_f32_16x16x32_bf16 v[112:115], v[216:219], a[24:27], v[112:115]
    s_add_u32 m0, s81, 1024
    v_mfma_f32_16x16x32_bf16 v[116:119], v[216:219], a[28:31], v[116:119]
    buffer_load_dwordx4 v11, s[44:47], s56 offen nt lds
    v_mfma_f32_16x16x32_bf16 v[120:123], v[220:223], a[24:27], v[120:123]
    v_mfma_f32_16x16x32_bf16 v[124:127], v[220:223], a[28:31], v[124:127]
    s_waitcnt vmcnt(8) lgkmcnt(0)
    v_mfma_f32_16x16x32_bf16 v[32:35], v[128:131], a[0:3], v[32:35]
    ds_read_b64_tr_b16 v[176:177], v20 offset:36864
    ds_read_b64_tr_b16 v[178:179], v20 offset:38400
    v_mfma_f32_16x16x32_bf16 v[36:39], v[128:131], a[4:7], v[36:39]
    ds_read_b64_tr_b16 v[180:181], v21 offset:36864
    v_mfma_f32_16x16x32_bf16 v[40:43], v[132:135], a[0:3], v[40:43]
    ds_read_b64_tr_b16 v[182:183], v21 offset:38400
    ds_read_b64_tr_b16 v[184:185], v22 offset:36864
    v_mfma_f32_16x16x32_bf16 v[44:47], v[132:135], a[4:7], v[44:47]
    ds_read_b64_tr_b16 v[186:187], v22 offset:38400
    v_mfma_f32_16x16x32_bf16 v[48:51], v[136:139], a[0:3], v[48:51]
    ds_read_b64_tr_b16 v[188:189], v23 offset:36864
    ds_read_b64_tr_b16 v[190:191], v23 offset:38400
    buffer_load_dwordx4 a[24:27], v8, s[4:7], s80 offen offset:3072 sc1
    v_mfma_f32_16x16x32_bf16 v[52:55], v[136:139], a[4:7], v[52:55]
    ds_read_b64_tr_b16 v[192:193], v20 offset:36992
    v_mfma_f32_16x16x32_bf16 v[56:59], v[140:143], a[0:3], v[56:59]
    ds_read_b64_tr_b16 v[194:195], v20 offset:38528
    ds_read_b64_tr_b16 v[196:197], v21 offset:36992
    v_mfma_f32_16x16x32_bf16 v[60:63], v[140:143], a[4:7], v[60:63]
    ds_read_b64_tr_b16 v[198:199], v21 offset:38528
    v_mfma_f32_16x16x32_bf16 v[64:67], v[144:147], a[0:3], v[64:67]
    ds_read_b64_tr_b16 v[200:201], v22 offset:36992
    ds_read_b64_tr_b16 v[202:203], v22 offset:38528
    v_mfma_f32_16x16x32_bf16 v[68:71], v[144:147], a[4:7], v[68:71]
    ds_read_b64_tr_b16 v[204:205], v23 offset:36992
    v_mfma_f32_16x16x32_bf16 v[72:75], v[148:151], a[0:3], v[72:75]
    ds_read_b64_tr_b16 v[206:207], v23 offset:38528
    ds_read_b64_tr_b16 v[208:209], v20 offset:37120
    v_mfma_f32_16x16x32_bf16 v[76:79], v[148:151], a[4:7], v[76:79]
    ds_read_b64_tr_b16 v[210:211], v20 offset:38656
    s_add_u32 m0, s81, 2048
    v_mfma_f32_16x16x32_bf16 v[80:83], v[152:155], a[0:3], v[80:83]
    ds_read_b64_tr_b16 v[212:213], v21 offset:37120
    ds_read_b64_tr_b16 v[214:215], v21 offset:38656
    buffer_load_dwordx4 v12, s[44:47], s56 offen nt lds
    v_mfma_f32_16x16x32_bf16 v[84:87], v[152:155], a[4:7], v[84:87]
    ds_read_b64_tr_b16 v[216:217], v22 offset:37120
    v_mfma_f32_16x16x32_bf16 v[88:91], v[156:159], a[0:3], v[88:91]
    ds_read_b64_tr_b16 v[218:219], v22 offset:38656
    ds_read_b64_tr_b16 v[220:221], v23 offset:37120
    v_mfma_f32_16x16x32_bf16 v[92:95], v[156:159], a[4:7], v[92:95]
    ds_read_b64_tr_b16 v[222:223], v23 offset:38656
    v_mfma_f32_16x16x32_bf16 v[96:99], v[160:163], a[0:3], v[96:99]
    v_mfma_f32_16x16x32_bf16 v[100:103], v[160:163], a[4:7], v[100:103]
    v_mfma_f32_16x16x32_bf16 v[104:107], v[164:167], a[0:3], v[104:107]
    v_mfma_f32_16x16x32_bf16 v[108:111], v[164:167], a[4:7], v[108:111]
    v_mfma_f32_16x16x32_bf16 v[112:115], v[168:171], a[0:3], v[112:115]
    buffer_load_dwordx4 a[28:31], v9, s[4:7], s80 offen offset:3072 sc1
    v_mfma_f32_16x16x32_bf16 v[116:119], v[168:171], a[4:7], v[116:119]
    v_mfma_f32_16x16x32_bf16 v[120:123], v[172:175], a[0:3], v[120:123]
    v_mfma_f32_16x16x32_bf16 v[124:127], v[172:175], a[4:7], v[124:127]
    s_waitcnt vmcnt(7) lgkmcnt(0)
    s_barrier
    v_mfma_f32_16x16x32_bf16 v[32:35], v[176:179], a[8:11], v[32:35]
    ds_read_b64_tr_b16 v[128:129], v20 offset:49152
    ds_read_b64_tr_b16 v[130:131], v20 offset:50688
    v_mfma_f32_16x16x32_bf16 v[36:39], v[176:179], a[12:15], v[36:39]
    ds_read_b64_tr_b16 v[132:133], v21 offset:49152
    v_mfma_f32_16x16x32_bf16 v[40:43], v[180:183], a[8:11], v[40:43]
    ds_read_b64_tr_b16 v[134:135], v21 offset:50688
    ds_read_b64_tr_b16 v[136:137], v22 offset:49152
    s_add_u32 s80, s80, 4096
    v_mfma_f32_16x16x32_bf16 v[44:47], v[180:183], a[12:15], v[44:47]
    ds_read_b64_tr_b16 v[138:139], v22 offset:50688
    buffer_load_dwordx4 a[0:3], v8, s[4:7], s80 offen offset:0 sc1
    v_mfma_f32_16x16x32_bf16 v[48:51], v[184:187], a[8:11], v[48:51]
    ds_read_b64_tr_b16 v[140:141], v23 offset:49152
    ds_read_b64_tr_b16 v[142:143], v23 offset:50688
    v_mfma_f32_16x16x32_bf16 v[52:55], v[184:187], a[12:15], v[52:55]
    ds_read_b64_tr_b16 v[144:145], v20 offset:49280
    v_mfma_f32_16x16x32_bf16 v[56:59], v[188:191], a[8:11], v[56:59]
    ds_read_b64_tr_b16 v[146:147], v20 offset:50816
    ds_read_b64_tr_b16 v[148:149], v21 offset:49280
    v_mfma_f32_16x16x32_bf16 v[60:63], v[188:191], a[12:15], v[60:63]
    ds_read_b64_tr_b16 v[150:151], v21 offset:50816
    v_mfma_f32_16x16x32_bf16 v[64:67], v[192:195], a[8:11], v[64:67]
    ds_read_b64_tr_b16 v[152:153], v22 offset:49280
    ds_read_b64_tr_b16 v[154:155], v22 offset:50816
    s_add_u32 s56, s56, 458752
    s_add_u32 m0, s81, 24576
    v_mfma_f32_16x16x32_bf16 v[68:71], v[192:195], a[12:15], v[68:71]
    ds_read_b64_tr_b16 v[156:157], v23 offset:49280
    buffer_load_dwordx4 v10, s[44:47], s56 offen nt lds
    v_mfma_f32_16x16x32_bf16 v[72:75], v[196:199], a[8:11], v[72:75]
    ds_read_b64_tr_b16 v[158:159], v23 offset:50816
    ds_read_b64_tr_b16 v[160:161], v20 offset:49408
    v_mfma_f32_16x16x32_bf16 v[76:79], v[196:199], a[12:15], v[76:79]
    ds_read_b64_tr_b16 v[162:163], v20 offset:50944
    v_mfma_f32_16x16x32_bf16 v[80:83], v[200:203], a[8:11], v[80:83]
    ds_read_b64_tr_b16 v[164:165], v21 offset:49408
    ds_read_b64_tr_b16 v[166:167], v21 offset:50944
    v_mfma_f32_16x16x32_bf16 v[84:87], v[200:203], a[12:15], v[84:87]
    ds_read_b64_tr_b16 v[168:169], v22 offset:49408
    v_mfma_f32_16x16x32_bf16 v[88:91], v[204:207], a[8:11], v[88:91]
    ds_read_b64_tr_b16 v[170:171], v22 offset:50944
    ds_read_b64_tr_b16 v[172:173], v23 offset:49408
    v_mfma_f32_16x16x32_bf16 v[92:95], v[204:207], a[12:15], v[92:95]
    ds_read_b64_tr_b16 v[174:175], v23 offset:50944
    buffer_load_dwordx4 a[4:7], v9, s[4:7], s80 offen offset:0 sc1
    v_mfma_f32_16x16x32_bf16 v[96:99], v[208:211], a[8:11], v[96:99]
    v_mfma_f32_16x16x32_bf16 v[100:103], v[208:211], a[12:15], v[100:103]
    v_mfma_f32_16x16x32_bf16 v[104:107], v[212:215], a[8:11], v[104:107]
    v_mfma_f32_16x16x32_bf16 v[108:111], v[212:215], a[12:15], v[108:111]
    v_mfma_f32_16x16x32_bf16 v[112:115], v[216:219], a[8:11], v[112:115]
    s_add_u32 m0, s81, 25600
    v_mfma_f32_16x16x32_bf16 v[116:119], v[216:219], a[12:15], v[116:119]
    buffer_load_dwordx4 v11, s[44:47], s56 offen nt lds
    v_mfma_f32_16x16x32_bf16 v[120:123], v[220:223], a[8:11], v[120:123]
    v_mfma_f32_16x16x32_bf16 v[124:127], v[220:223], a[12:15], v[124:127]
    s_waitcnt vmcnt(8) lgkmcnt(0)
    v_mfma_f32_16x16x32_bf16 v[32:35], v[128:131], a[16:19], v[32:35]
    ds_read_b64_tr_b16 v[176:177], v20 offset:61440
    ds_read_b64_tr_b16 v[178:179], v20 offset:62976
    v_mfma_f32_16x16x32_bf16 v[36:39], v[128:131], a[20:23], v[36:39]
    ds_read_b64_tr_b16 v[180:181], v21 offset:61440
    v_mfma_f32_16x16x32_bf16 v[40:43], v[132:135], a[16:19], v[40:43]
    ds_read_b64_tr_b16 v[182:183], v21 offset:62976
    ds_read_b64_tr_b16 v[184:185], v22 offset:61440
    v_mfma_f32_16x16x32_bf16 v[44:47], v[132:135], a[20:23], v[44:47]
    ds_read_b64_tr_b16 v[186:187], v22 offset:62976
    buffer_load_dwordx4 a[8:11], v8, s[4:7], s80 offen offset:1024 sc1
    v_mfma_f32_16x16x32_bf16 v[48:51], v[136:139], a[16:19], v[48:51]
    ds_read_b64_tr_b16 v[188:189], v23 offset:61440
    ds_read_b64_tr_b16 v[190:191], v23 offset:62976
    v_mfma_f32_16x16x32_bf16 v[52:55], v[136:139], a[20:23], v[52:55]
    ds_read_b64_tr_b16 v[192:193], v20 offset:61568
    v_mfma_f32_16x16x32_bf16 v[56:59], v[140:143], a[16:19], v[56:59]
    ds_read_b64_tr_b16 v[194:195], v20 offset:63104
    ds_read_b64_tr_b16 v[196:197], v21 offset:61568
    v_mfma_f32_16x16x32_bf16 v[60:63], v[140:143], a[20:23], v[60:63]
    ds_read_b64_tr_b16 v[198:199], v21 offset:63104
    v_mfma_f32_16x16x32_bf16 v[64:67], v[144:147], a[16:19], v[64:67]
    ds_read_b64_tr_b16 v[200:201], v22 offset:61568
    ds_read_b64_tr_b16 v[202:203], v22 offset:63104
    s_add_u32 m0, s81, 26624
    v_mfma_f32_16x16x32_bf16 v[68:71], v[144:147], a[20:23], v[68:71]
    ds_read_b64_tr_b16 v[204:205], v23 offset:61568
    buffer_load_dwordx4 v12, s[44:47], s56 offen nt lds
    v_mfma_f32_16x16x32_bf16 v[72:75], v[148:151], a[16:19], v[72:75]
    ds_read_b64_tr_b16 v[206:207], v23 offset:63104
    ds_read_b64_tr_b16 v[208:209], v20 offset:61696
    v_mfma_f32_16x16x32_bf16 v[76:79], v[148:151], a[20:23], v[76:79]
    ds_read_b64_tr_b16 v[210:211], v20 offset:63232
    v_mfma_f32_16x16x32_bf16 v[80:83], v[152:155], a[16:19], v[80:83]
    ds_read_b64_tr_b16 v[212:213], v21 offset:61696
    ds_read_b64_tr_b16 v[214:215], v21 offset:63232
    v_mfma_f32_16x16x32_bf16 v[84:87], v[152:155], a[20:23], v[84:87]
    ds_read_b64_tr_b16 v[216:217], v22 offset:61696
    v_mfma_f32_16x16x32_bf16 v[88:91], v[156:159], a[16:19], v[88:91]
    ds_read_b64_tr_b16 v[218:219], v22 offset:63232
    ds_read_b64_tr_b16 v[220:221], v23 offset:61696
    v_mfma_f32_16x16x32_bf16 v[92:95], v[156:159], a[20:23], v[92:95]
    ds_read_b64_tr_b16 v[222:223], v23 offset:63232
    buffer_load_dwordx4 a[12:15], v9, s[4:7], s80 offen offset:1024 sc1
    v_mfma_f32_16x16x32_bf16 v[96:99], v[160:163], a[16:19], v[96:99]
    v_mfma_f32_16x16x32_bf16 v[100:103], v[160:163], a[20:23], v[100:103]
    v_mfma_f32_16x16x32_bf16 v[104:107], v[164:167], a[16:19], v[104:107]
    v_mfma_f32_16x16x32_bf16 v[108:111], v[164:167], a[20:23], v[108:111]
    v_mfma_f32_16x16x32_bf16 v[112:115], v[168:171], a[16:19], v[112:115]
    s_mov_b32 s8, s18
    s_mov_b32 s9, s19
    s_mov_b32 s10, 8388608
    s_mov_b32 s11, 0x20000
    v_mfma_f32_16x16x32_bf16 v[116:119], v[168:171], a[20:23], v[116:119]
    buffer_load_dword v7, v13, s[8:11], 0 offen
    v_mfma_f32_16x16x32_bf16 v[120:123], v[172:175], a[16:19], v[120:123]
    v_mfma_f32_16x16x32_bf16 v[124:127], v[172:175], a[20:23], v[124:127]
    s_waitcnt vmcnt(8) lgkmcnt(0)
    s_barrier
    v_mfma_f32_16x16x32_bf16 v[32:35], v[176:179], a[24:27], v[32:35]
    ds_read_b64_tr_b16 v[128:129], v24 offset:8192
    ds_read_b64_tr_b16 v[130:131], v24 offset:9728
    v_mfma_f32_16x16x32_bf16 v[36:39], v[176:179], a[28:31], v[36:39]
    ds_read_b64_tr_b16 v[132:133], v25 offset:8192
    v_mfma_f32_16x16x32_bf16 v[40:43], v[180:183], a[24:27], v[40:43]
    ds_read_b64_tr_b16 v[134:135], v25 offset:9728
    ds_read_b64_tr_b16 v[136:137], v26 offset:8192
    v_mfma_f32_16x16x32_bf16 v[44:47], v[180:183], a[28:31], v[44:47]
    ds_read_b64_tr_b16 v[138:139], v26 offset:9728
    buffer_load_dwordx4 a[16:19], v8, s[4:7], s80 offen offset:2048 sc1
    v_mfma_f32_16x16x32_bf16 v[48:51], v[184:187], a[24:27], v[48:51]
    ds_read_b64_tr_b16 v[140:141], v27 offset:8192
    ds_read_b64_tr_b16 v[142:143], v27 offset:9728
    v_mfma_f32_16x16x32_bf16 v[52:55], v[184:187], a[28:31], v[52:55]
    ds_read_b64_tr_b16 v[144:145], v24 offset:8320
    v_mfma_f32_16x16x32_bf16 v[56:59], v[188:191], a[24:27], v[56:59]
    ds_read_b64_tr_b16 v[146:147], v24 offset:9856
    ds_read_b64_tr_b16 v[148:149], v25 offset:8320
    v_mfma_f32_16x16x32_bf16 v[60:63], v[188:191], a[28:31], v[60:63]
    ds_read_b64_tr_b16 v[150:151], v25 offset:9856
    v_mfma_f32_16x16x32_bf16 v[64:67], v[192:195], a[24:27], v[64:67]
    ds_read_b64_tr_b16 v[152:153], v26 offset:8320
    ds_read_b64_tr_b16 v[154:155], v26 offset:9856
    s_add_u32 s56, s56, 458752
    s_add_u32 m0, s81, 49152
    v_mfma_f32_16x16x32_bf16 v[68:71], v[192:195], a[28:31], v[68:71]
    ds_read_b64_tr_b16 v[156:157], v27 offset:8320
    buffer_load_dwordx4 v10, s[44:47], s56 offen nt lds
    v_mfma_f32_16x16x32_bf16 v[72:75], v[196:199], a[24:27], v[72:75]
    ds_read_b64_tr_b16 v[158:159], v27 offset:9856
    ds_read_b64_tr_b16 v[160:161], v24 offset:8448
    v_mfma_f32_16x16x32_bf16 v[76:79], v[196:199], a[28:31], v[76:79]
    ds_read_b64_tr_b16 v[162:163], v24 offset:9984
    v_mfma_f32_16x16x32_bf16 v[80:83], v[200:203], a[24:27], v[80:83]
    ds_read_b64_tr_b16 v[164:165], v25 offset:8448
    ds_read_b64_tr_b16 v[166:167], v25 offset:9984
    v_mfma_f32_16x16x32_bf16 v[84:87], v[200:203], a[28:31], v[84:87]
    ds_read_b64_tr_b16 v[168:169], v26 offset:8448
    v_mfma_f32_16x16x32_bf16 v[88:91], v[204:207], a[24:27], v[88:91]
    ds_read_b64_tr_b16 v[170:171], v26 offset:9984
    ds_read_b64_tr_b16 v[172:173], v27 offset:8448
    v_mfma_f32_16x16x32_bf16 v[92:95], v[204:207], a[28:31], v[92:95]
    ds_read_b64_tr_b16 v[174:175], v27 offset:9984
    buffer_load_dwordx4 a[20:23], v9, s[4:7], s80 offen offset:2048 sc1
    v_mfma_f32_16x16x32_bf16 v[96:99], v[208:211], a[24:27], v[96:99]
    v_mfma_f32_16x16x32_bf16 v[100:103], v[208:211], a[28:31], v[100:103]
    v_mfma_f32_16x16x32_bf16 v[104:107], v[212:215], a[24:27], v[104:107]
    v_mfma_f32_16x16x32_bf16 v[108:111], v[212:215], a[28:31], v[108:111]
    v_mfma_f32_16x16x32_bf16 v[112:115], v[216:219], a[24:27], v[112:115]
    s_add_u32 m0, s81, 50176
    v_mfma_f32_16x16x32_bf16 v[116:119], v[216:219], a[28:31], v[116:119]
    buffer_load_dwordx4 v11, s[44:47], s56 offen nt lds
    v_mfma_f32_16x16x32_bf16 v[120:123], v[220:223], a[24:27], v[120:123]
    v_mfma_f32_16x16x32_bf16 v[124:127], v[220:223], a[28:31], v[124:127]
    s_waitcnt vmcnt(9) lgkmcnt(0)
    v_mfma_f32_16x16x32_bf16 v[32:35], v[128:131], a[0:3], v[32:35]
    ds_read_b64_tr_b16 v[176:177], v24 offset:20480
    ds_read_b64_tr_b16 v[178:179], v24 offset:22016
    v_mfma_f32_16x16x32_bf16 v[36:39], v[128:131], a[4:7], v[36:39]
    ds_read_b64_tr_b16 v[180:181], v25 offset:20480
    v_mfma_f32_16x16x32_bf16 v[40:43], v[132:135], a[0:3], v[40:43]
    ds_read_b64_tr_b16 v[182:183], v25 offset:22016
    ds_read_b64_tr_b16 v[184:185], v26 offset:20480
    v_mfma_f32_16x16x32_bf16 v[44:47], v[132:135], a[4:7], v[44:47]
    ds_read_b64_tr_b16 v[186:187], v26 offset:22016
    v_mfma_f32_16x16x32_bf16 v[48:51], v[136:139], a[0:3], v[48:51]
    ds_read_b64_tr_b16 v[188:189], v27 offset:20480
    ds_read_b64_tr_b16 v[190:191], v27 offset:22016
    buffer_load_dwordx4 a[24:27], v8, s[4:7], s80 offen offset:3072 sc1
    v_mfma_f32_16x16x32_bf16 v[52:55], v[136:139], a[4:7], v[52:55]
    ds_read_b64_tr_b16 v[192:193], v24 offset:20608
    v_mfma_f32_16x16x32_bf16 v[56:59], v[140:143], a[0:3], v[56:59]
    ds_read_b64_tr_b16 v[194:195], v24 offset:22144
    ds_read_b64_tr_b16 v[196:197], v25 offset:20608
    v_mfma_f32_16x16x32_bf16 v[60:63], v[140:143], a[4:7], v[60:63]
    ds_read_b64_tr_b16 v[198:199], v25 offset:22144
    v_mfma_f32_16x16x32_bf16 v[64:67], v[144:147], a[0:3], v[64:67]
    ds_read_b64_tr_b16 v[200:201], v26 offset:20608
    ds_read_b64_tr_b16 v[202:203], v26 offset:22144
    v_mfma_f32_16x16x32_bf16 v[68:71], v[144:147], a[4:7], v[68:71]
    ds_read_b64_tr_b16 v[204:205], v27 offset:20608
    v_mfma_f32_16x16x32_bf16 v[72:75], v[148:151], a[0:3], v[72:75]
    ds_read_b64_tr_b16 v[206:207], v27 offset:22144
    ds_read_b64_tr_b16 v[208:209], v24 offset:20736
    v_mfma_f32_16x16x32_bf16 v[76:79], v[148:151], a[4:7], v[76:79]
    ds_read_b64_tr_b16 v[210:211], v24 offset:22272
    s_add_u32 m0, s81, 51200
    v_mfma_f32_16x16x32_bf16 v[80:83], v[152:155], a[0:3], v[80:83]
    ds_read_b64_tr_b16 v[212:213], v25 offset:20736
    ds_read_b64_tr_b16 v[214:215], v25 offset:22272
    buffer_load_dwordx4 v12, s[44:47], s56 offen nt lds
    v_mfma_f32_16x16x32_bf16 v[84:87], v[152:155], a[4:7], v[84:87]
    ds_read_b64_tr_b16 v[216:217], v26 offset:20736
    v_mfma_f32_16x16x32_bf16 v[88:91], v[156:159], a[0:3], v[88:91]
    ds_read_b64_tr_b16 v[218:219], v26 offset:22272
    ds_read_b64_tr_b16 v[220:221], v27 offset:20736
    v_mfma_f32_16x16x32_bf16 v[92:95], v[156:159], a[4:7], v[92:95]
    ds_read_b64_tr_b16 v[222:223], v27 offset:22272
    v_mfma_f32_16x16x32_bf16 v[96:99], v[160:163], a[0:3], v[96:99]
    v_mfma_f32_16x16x32_bf16 v[100:103], v[160:163], a[4:7], v[100:103]
    v_mfma_f32_16x16x32_bf16 v[104:107], v[164:167], a[0:3], v[104:107]
    v_mfma_f32_16x16x32_bf16 v[108:111], v[164:167], a[4:7], v[108:111]
    v_mfma_f32_16x16x32_bf16 v[112:115], v[168:171], a[0:3], v[112:115]
    buffer_load_dwordx4 a[28:31], v9, s[4:7], s80 offen offset:3072 sc1
    v_mfma_f32_16x16x32_bf16 v[116:119], v[168:171], a[4:7], v[116:119]
    v_mfma_f32_16x16x32_bf16 v[120:123], v[172:175], a[0:3], v[120:123]
    v_mfma_f32_16x16x32_bf16 v[124:127], v[172:175], a[4:7], v[124:127]
    s_waitcnt vmcnt(8) lgkmcnt(0)
    s_barrier
    v_mfma_f32_16x16x32_bf16 v[32:35], v[176:179], a[8:11], v[32:35]
    ds_read_b64_tr_b16 v[128:129], v24 offset:32768
    ds_read_b64_tr_b16 v[130:131], v24 offset:34304
    v_mfma_f32_16x16x32_bf16 v[36:39], v[176:179], a[12:15], v[36:39]
    ds_read_b64_tr_b16 v[132:133], v25 offset:32768
    v_mfma_f32_16x16x32_bf16 v[40:43], v[180:183], a[8:11], v[40:43]
    ds_read_b64_tr_b16 v[134:135], v25 offset:34304
    ds_read_b64_tr_b16 v[136:137], v26 offset:32768
    s_add_u32 s80, s80, 4096
    v_mfma_f32_16x16x32_bf16 v[44:47], v[180:183], a[12:15], v[44:47]
    ds_read_b64_tr_b16 v[138:139], v26 offset:34304
    buffer_load_dwordx4 a[0:3], v8, s[4:7], s80 offen offset:0 sc1
    v_mfma_f32_16x16x32_bf16 v[48:51], v[184:187], a[8:11], v[48:51]
    ds_read_b64_tr_b16 v[140:141], v27 offset:32768
    ds_read_b64_tr_b16 v[142:143], v27 offset:34304
    v_mfma_f32_16x16x32_bf16 v[52:55], v[184:187], a[12:15], v[52:55]
    ds_read_b64_tr_b16 v[144:145], v24 offset:32896
    v_mfma_f32_16x16x32_bf16 v[56:59], v[188:191], a[8:11], v[56:59]
    ds_read_b64_tr_b16 v[146:147], v24 offset:34432
    ds_read_b64_tr_b16 v[148:149], v25 offset:32896
    v_mfma_f32_16x16x32_bf16 v[60:63], v[188:191], a[12:15], v[60:63]
    ds_read_b64_tr_b16 v[150:151], v25 offset:34432
    v_mfma_f32_16x16x32_bf16 v[64:67], v[192:195], a[8:11], v[64:67]
    ds_read_b64_tr_b16 v[152:153], v26 offset:32896
    ds_read_b64_tr_b16 v[154:155], v26 offset:34432
    s_add_u32 s56, s56, 458752
    s_add_u32 m0, s81, 73728
    v_mfma_f32_16x16x32_bf16 v[68:71], v[192:195], a[12:15], v[68:71]
    ds_read_b64_tr_b16 v[156:157], v27 offset:32896
    buffer_load_dwordx4 v10, s[44:47], s56 offen nt lds
    v_mfma_f32_16x16x32_bf16 v[72:75], v[196:199], a[8:11], v[72:75]
    ds_read_b64_tr_b16 v[158:159], v27 offset:34432
    ds_read_b64_tr_b16 v[160:161], v24 offset:33024
    v_mfma_f32_16x16x32_bf16 v[76:79], v[196:199], a[12:15], v[76:79]
    ds_read_b64_tr_b16 v[162:163], v24 offset:34560
    v_mfma_f32_16x16x32_bf16 v[80:83], v[200:203], a[8:11], v[80:83]
    ds_read_b64_tr_b16 v[164:165], v25 offset:33024
    ds_read_b64_tr_b16 v[166:167], v25 offset:34560
    v_mfma_f32_16x16x32_bf16 v[84:87], v[200:203], a[12:15], v[84:87]
    ds_read_b64_tr_b16 v[168:169], v26 offset:33024
    v_mfma_f32_16x16x32_bf16 v[88:91], v[204:207], a[8:11], v[88:91]
    ds_read_b64_tr_b16 v[170:171], v26 offset:34560
    ds_read_b64_tr_b16 v[172:173], v27 offset:33024
    v_mfma_f32_16x16x32_bf16 v[92:95], v[204:207], a[12:15], v[92:95]
    ds_read_b64_tr_b16 v[174:175], v27 offset:34560
    buffer_load_dwordx4 a[4:7], v9, s[4:7], s80 offen offset:0 sc1
    v_mfma_f32_16x16x32_bf16 v[96:99], v[208:211], a[8:11], v[96:99]
    v_mfma_f32_16x16x32_bf16 v[100:103], v[208:211], a[12:15], v[100:103]
    v_mfma_f32_16x16x32_bf16 v[104:107], v[212:215], a[8:11], v[104:107]
    v_mfma_f32_16x16x32_bf16 v[108:111], v[212:215], a[12:15], v[108:111]
    v_mfma_f32_16x16x32_bf16 v[112:115], v[216:219], a[8:11], v[112:115]
    s_add_u32 m0, s81, 74752
    v_mfma_f32_16x16x32_bf16 v[116:119], v[216:219], a[12:15], v[116:119]
    buffer_load_dwordx4 v11, s[44:47], s56 offen nt lds
    v_mfma_f32_16x16x32_bf16 v[120:123], v[220:223], a[8:11], v[120:123]
    v_mfma_f32_16x16x32_bf16 v[124:127], v[220:223], a[12:15], v[124:127]
    s_waitcnt vmcnt(8) lgkmcnt(0)
    v_mfma_f32_16x16x32_bf16 v[32:35], v[128:131], a[16:19], v[32:35]
    ds_read_b64_tr_b16 v[176:177], v24 offset:45056
    ds_read_b64_tr_b16 v[178:179], v24 offset:46592
    v_mfma_f32_16x16x32_bf16 v[36:39], v[128:131], a[20:23], v[36:39]
    ds_read_b64_tr_b16 v[180:181], v25 offset:45056
    v_mfma_f32_16x16x32_bf16 v[40:43], v[132:135], a[16:19], v[40:43]
    ds_read_b64_tr_b16 v[182:183], v25 offset:46592
    ds_read_b64_tr_b16 v[184:185], v26 offset:45056
    v_mfma_f32_16x16x32_bf16 v[44:47], v[132:135], a[20:23], v[44:47]
    ds_read_b64_tr_b16 v[186:187], v26 offset:46592
    v_mfma_f32_16x16x32_bf16 v[48:51], v[136:139], a[16:19], v[48:51]
    ds_read_b64_tr_b16 v[188:189], v27 offset:45056
    ds_read_b64_tr_b16 v[190:191], v27 offset:46592
    buffer_load_dwordx4 a[8:11], v8, s[4:7], s80 offen offset:1024 sc1
    v_mfma_f32_16x16x32_bf16 v[52:55], v[136:139], a[20:23], v[52:55]
    ds_read_b64_tr_b16 v[192:193], v24 offset:45184
    v_mfma_f32_16x16x32_bf16 v[56:59], v[140:143], a[16:19], v[56:59]
    ds_read_b64_tr_b16 v[194:195], v24 offset:46720
    ds_read_b64_tr_b16 v[196:197], v25 offset:45184
    v_mfma_f32_16x16x32_bf16 v[60:63], v[140:143], a[20:23], v[60:63]
    ds_read_b64_tr_b16 v[198:199], v25 offset:46720
    v_mfma_f32_16x16x32_bf16 v[64:67], v[144:147], a[16:19], v[64:67]
    ds_read_b64_tr_b16 v[200:201], v26 offset:45184
    ds_read_b64_tr_b16 v[202:203], v26 offset:46720
    v_mfma_f32_16x16x32_bf16 v[68:71], v[144:147], a[20:23], v[68:71]
    ds_read_b64_tr_b16 v[204:205], v27 offset:45184
    v_mfma_f32_16x16x32_bf16 v[72:75], v[148:151], a[16:19], v[72:75]
    ds_read_b64_tr_b16 v[206:207], v27 offset:46720
    ds_read_b64_tr_b16 v[208:209], v24 offset:45312
    v_mfma_f32_16x16x32_bf16 v[76:79], v[148:151], a[20:23], v[76:79]
    ds_read_b64_tr_b16 v[210:211], v24 offset:46848
    s_add_u32 m0, s81, 75776
    v_mfma_f32_16x16x32_bf16 v[80:83], v[152:155], a[16:19], v[80:83]
    ds_read_b64_tr_b16 v[212:213], v25 offset:45312
    ds_read_b64_tr_b16 v[214:215], v25 offset:46848
    buffer_load_dwordx4 v12, s[44:47], s56 offen nt lds
    v_mfma_f32_16x16x32_bf16 v[84:87], v[152:155], a[20:23], v[84:87]
    ds_read_b64_tr_b16 v[216:217], v26 offset:45312
    v_mfma_f32_16x16x32_bf16 v[88:91], v[156:159], a[16:19], v[88:91]
    ds_read_b64_tr_b16 v[218:219], v26 offset:46848
    ds_read_b64_tr_b16 v[220:221], v27 offset:45312
    v_mfma_f32_16x16x32_bf16 v[92:95], v[156:159], a[20:23], v[92:95]
    ds_read_b64_tr_b16 v[222:223], v27 offset:46848
    v_mfma_f32_16x16x32_bf16 v[96:99], v[160:163], a[16:19], v[96:99]
    v_mfma_f32_16x16x32_bf16 v[100:103], v[160:163], a[20:23], v[100:103]
    v_mfma_f32_16x16x32_bf16 v[104:107], v[164:167], a[16:19], v[104:107]
    v_mfma_f32_16x16x32_bf16 v[108:111], v[164:167], a[20:23], v[108:111]
    v_mfma_f32_16x16x32_bf16 v[112:115], v[168:171], a[16:19], v[112:115]
    buffer_load_dwordx4 a[12:15], v9, s[4:7], s80 offen offset:1024 sc1
    v_mfma_f32_16x16x32_bf16 v[116:119], v[168:171], a[20:23], v[116:119]
    v_mfma_f32_16x16x32_bf16 v[120:123], v[172:175], a[16:19], v[120:123]
    v_mfma_f32_16x16x32_bf16 v[124:127], v[172:175], a[20:23], v[124:127]
    s_waitcnt vmcnt(7) lgkmcnt(0)
    s_barrier
    v_mfma_f32_16x16x32_bf16 v[32:35], v[176:179], a[24:27], v[32:35]
    ds_read_b64_tr_b16 v[128:129], v20 offset:0
    ds_read_b64_tr_b16 v[130:131], v20 offset:1536
    v_mfma_f32_16x16x32_bf16 v[36:39], v[176:179], a[28:31], v[36:39]
    ds_read_b64_tr_b16 v[132:133], v21 offset:0
    v_mfma_f32_16x16x32_bf16 v[40:43], v[180:183], a[24:27], v[40:43]
    ds_read_b64_tr_b16 v[134:135], v21 offset:1536
    ds_read_b64_tr_b16 v[136:137], v22 offset:0
    v_mfma_f32_16x16x32_bf16 v[44:47], v[180:183], a[28:31], v[44:47]
    ds_read_b64_tr_b16 v[138:139], v22 offset:1536
    buffer_load_dwordx4 a[16:19], v8, s[4:7], s80 offen offset:2048 sc1
    v_mfma_f32_16x16x32_bf16 v[48:51], v[184:187], a[24:27], v[48:51]
    ds_read_b64_tr_b16 v[140:141], v23 offset:0
    ds_read_b64_tr_b16 v[142:143], v23 offset:1536
    v_mfma_f32_16x16x32_bf16 v[52:55], v[184:187], a[28:31], v[52:55]
    ds_read_b64_tr_b16 v[144:145], v20 offset:128
    v_mfma_f32_16x16x32_bf16 v[56:59], v[188:191], a[24:27], v[56:59]
    ds_read_b64_tr_b16 v[146:147], v20 offset:1664
    ds_read_b64_tr_b16 v[148:149], v21 offset:128
    v_mfma_f32_16x16x32_bf16 v[60:63], v[188:191], a[28:31], v[60:63]
    ds_read_b64_tr_b16 v[150:151], v21 offset:1664
    v_mfma_f32_16x16x32_bf16 v[64:67], v[192:195], a[24:27], v[64:67]
    ds_read_b64_tr_b16 v[152:153], v22 offset:128
    ds_read_b64_tr_b16 v[154:155], v22 offset:1664
    s_add_u32 s56, s56, 458752
    s_add_u32 m0, s81, 98304
    v_mfma_f32_16x16x32_bf16 v[68:71], v[192:195], a[28:31], v[68:71]
    ds_read_b64_tr_b16 v[156:157], v23 offset:128
    buffer_load_dwordx4 v10, s[44:47], s56 offen nt lds
    v_mfma_f32_16x16x32_bf16 v[72:75], v[196:199], a[24:27], v[72:75]
    ds_read_b64_tr_b16 v[158:159], v23 offset:1664
    ds_read_b64_tr_b16 v[160:161], v20 offset:256
    v_mfma_f32_16x16x32_bf16 v[76:79], v[196:199], a[28:31], v[76:79]
    ds_read_b64_tr_b16 v[162:163], v20 offset:1792
    v_mfma_f32_16x16x32_bf16 v[80:83], v[200:203], a[24:27], v[80:83]
    ds_read_b64_tr_b16 v[164:165], v21 offset:256
    ds_read_b64_tr_b16 v[166:167], v21 offset:1792
    v_mfma_f32_16x16x32_bf16 v[84:87], v[200:203], a[28:31], v[84:87]
    ds_read_b64_tr_b16 v[168:169], v22 offset:256
    v_mfma_f32_16x16x32_bf16 v[88:91], v[204:207], a[24:27], v[88:91]
    ds_read_b64_tr_b16 v[170:171], v22 offset:1792
    ds_read_b64_tr_b16 v[172:173], v23 offset:256
    v_mfma_f32_16x16x32_bf16 v[92:95], v[204:207], a[28:31], v[92:95]
    ds_read_b64_tr_b16 v[174:175], v23 offset:1792
    buffer_load_dwordx4 a[20:23], v9, s[4:7], s80 offen offset:2048 sc1
    v_mfma_f32_16x16x32_bf16 v[96:99], v[208:211], a[24:27], v[96:99]
    v_mfma_f32_16x16x32_bf16 v[100:103], v[208:211], a[28:31], v[100:103]
    v_mfma_f32_16x16x32_bf16 v[104:107], v[212:215], a[24:27], v[104:107]
    v_mfma_f32_16x16x32_bf16 v[108:111], v[212:215], a[28:31], v[108:111]
    v_mfma_f32_16x16x32_bf16 v[112:115], v[216:219], a[24:27], v[112:115]
    s_add_u32 m0, s81, 99328
    v_mfma_f32_16x16x32_bf16 v[116:119], v[216:219], a[28:31], v[116:119]
    buffer_load_dwordx4 v11, s[44:47], s56 offen nt lds
    v_mfma_f32_16x16x32_bf16 v[120:123], v[220:223], a[24:27], v[120:123]
    v_mfma_f32_16x16x32_bf16 v[124:127], v[220:223], a[28:31], v[124:127]
    s_waitcnt vmcnt(8) lgkmcnt(0)
    v_mfma_f32_16x16x32_bf16 v[32:35], v[128:131], a[0:3], v[32:35]
    ds_read_b64_tr_b16 v[176:177], v20 offset:12288
    ds_read_b64_tr_b16 v[178:179], v20 offset:13824
    v_mfma_f32_16x16x32_bf16 v[36:39], v[128:131], a[4:7], v[36:39]
    ds_read_b64_tr_b16 v[180:181], v21 offset:12288
    v_mfma_f32_16x16x32_bf16 v[40:43], v[132:135], a[0:3], v[40:43]
    ds_read_b64_tr_b16 v[182:183], v21 offset:13824
    ds_read_b64_tr_b16 v[184:185], v22 offset:12288
    v_mfma_f32_16x16x32_bf16 v[44:47], v[132:135], a[4:7], v[44:47]
    ds_read_b64_tr_b16 v[186:187], v22 offset:13824
    buffer_load_dwordx4 a[24:27], v8, s[4:7], s80 offen offset:3072 sc1
    v_mfma_f32_16x16x32_bf16 v[48:51], v[136:139], a[0:3], v[48:51]
    ds_read_b64_tr_b16 v[188:189], v23 offset:12288
    ds_read_b64_tr_b16 v[190:191], v23 offset:13824
    v_mfma_f32_16x16x32_bf16 v[52:55], v[136:139], a[4:7], v[52:55]
    ds_read_b64_tr_b16 v[192:193], v20 offset:12416
    v_mfma_f32_16x16x32_bf16 v[56:59], v[140:143], a[0:3], v[56:59]
    ds_read_b64_tr_b16 v[194:195], v20 offset:13952
    ds_read_b64_tr_b16 v[196:197], v21 offset:12416
    v_mfma_f32_16x16x32_bf16 v[60:63], v[140:143], a[4:7], v[60:63]
    ds_read_b64_tr_b16 v[198:199], v21 offset:13952
    v_mfma_f32_16x16x32_bf16 v[64:67], v[144:147], a[0:3], v[64:67]
    ds_read_b64_tr_b16 v[200:201], v22 offset:12416
    ds_read_b64_tr_b16 v[202:203], v22 offset:13952
    s_add_u32 m0, s81, 100352
    v_mfma_f32_16x16x32_bf16 v[68:71], v[144:147], a[4:7], v[68:71]
    ds_read_b64_tr_b16 v[204:205], v23 offset:12416
    buffer_load_dwordx4 v12, s[44:47], s56 offen nt lds
    v_mfma_f32_16x16x32_bf16 v[72:75], v[148:151], a[0:3], v[72:75]
    ds_read_b64_tr_b16 v[206:207], v23 offset:13952
    ds_read_b64_tr_b16 v[208:209], v20 offset:12544
    v_mfma_f32_16x16x32_bf16 v[76:79], v[148:151], a[4:7], v[76:79]
    ds_read_b64_tr_b16 v[210:211], v20 offset:14080
    v_mfma_f32_16x16x32_bf16 v[80:83], v[152:155], a[0:3], v[80:83]
    ds_read_b64_tr_b16 v[212:213], v21 offset:12544
    ds_read_b64_tr_b16 v[214:215], v21 offset:14080
    v_mfma_f32_16x16x32_bf16 v[84:87], v[152:155], a[4:7], v[84:87]
    ds_read_b64_tr_b16 v[216:217], v22 offset:12544
    v_mfma_f32_16x16x32_bf16 v[88:91], v[156:159], a[0:3], v[88:91]
    ds_read_b64_tr_b16 v[218:219], v22 offset:14080
    ds_read_b64_tr_b16 v[220:221], v23 offset:12544
    v_mfma_f32_16x16x32_bf16 v[92:95], v[156:159], a[4:7], v[92:95]
    ds_read_b64_tr_b16 v[222:223], v23 offset:14080
    buffer_load_dwordx4 a[28:31], v9, s[4:7], s80 offen offset:3072 sc1
    v_mfma_f32_16x16x32_bf16 v[96:99], v[160:163], a[0:3], v[96:99]
    v_mfma_f32_16x16x32_bf16 v[100:103], v[160:163], a[4:7], v[100:103]
    v_mfma_f32_16x16x32_bf16 v[104:107], v[164:167], a[0:3], v[104:107]
    v_mfma_f32_16x16x32_bf16 v[108:111], v[164:167], a[4:7], v[108:111]
    v_mfma_f32_16x16x32_bf16 v[112:115], v[168:171], a[0:3], v[112:115]
    s_mov_b32 s8, s20
    s_mov_b32 s9, s21
    s_mov_b32 s10, 8388608
    s_mov_b32 s11, 0x20000
    v_mfma_f32_16x16x32_bf16 v[116:119], v[168:171], a[4:7], v[116:119]
    buffer_load_dword v7, v13, s[8:11], 0 offen
    v_mfma_f32_16x16x32_bf16 v[120:123], v[172:175], a[0:3], v[120:123]
    v_mfma_f32_16x16x32_bf16 v[124:127], v[172:175], a[4:7], v[124:127]
    s_waitcnt vmcnt(8) lgkmcnt(0)
    s_barrier
    v_mfma_f32_16x16x32_bf16 v[32:35], v[176:179], a[8:11], v[32:35]
    ds_read_b64_tr_b16 v[128:129], v20 offset:24576
    ds_read_b64_tr_b16 v[130:131], v20 offset:26112
    v_mfma_f32_16x16x32_bf16 v[36:39], v[176:179], a[12:15], v[36:39]
    ds_read_b64_tr_b16 v[132:133], v21 offset:24576
    v_mfma_f32_16x16x32_bf16 v[40:43], v[180:183], a[8:11], v[40:43]
    ds_read_b64_tr_b16 v[134:135], v21 offset:26112
    ds_read_b64_tr_b16 v[136:137], v22 offset:24576
    s_add_u32 s80, s80, 4096
    v_mfma_f32_16x16x32_bf16 v[44:47], v[180:183], a[12:15], v[44:47]
    ds_read_b64_tr_b16 v[138:139], v22 offset:26112
    buffer_load_dwordx4 a[0:3], v8, s[4:7], s80 offen offset:0 sc1
    v_mfma_f32_16x16x32_bf16 v[48:51], v[184:187], a[8:11], v[48:51]
    ds_read_b64_tr_b16 v[140:141], v23 offset:24576
    ds_read_b64_tr_b16 v[142:143], v23 offset:26112
    v_mfma_f32_16x16x32_bf16 v[52:55], v[184:187], a[12:15], v[52:55]
    ds_read_b64_tr_b16 v[144:145], v20 offset:24704
    v_mfma_f32_16x16x32_bf16 v[56:59], v[188:191], a[8:11], v[56:59]
    ds_read_b64_tr_b16 v[146:147], v20 offset:26240
    ds_read_b64_tr_b16 v[148:149], v21 offset:24704
    v_mfma_f32_16x16x32_bf16 v[60:63], v[188:191], a[12:15], v[60:63]
    ds_read_b64_tr_b16 v[150:151], v21 offset:26240
    v_mfma_f32_16x16x32_bf16 v[64:67], v[192:195], a[8:11], v[64:67]
    ds_read_b64_tr_b16 v[152:153], v22 offset:24704
    ds_read_b64_tr_b16 v[154:155], v22 offset:26240
    s_add_u32 s56, s56, 458752
    s_add_u32 m0, s81, 0
    v_mfma_f32_16x16x32_bf16 v[68:71], v[192:195], a[12:15], v[68:71]
    ds_read_b64_tr_b16 v[156:157], v23 offset:24704
    buffer_load_dwordx4 v10, s[44:47], s56 offen nt lds
    v_mfma_f32_16x16x32_bf16 v[72:75], v[196:199], a[8:11], v[72:75]
    ds_read_b64_tr_b16 v[158:159], v23 offset:26240
    ds_read_b64_tr_b16 v[160:161], v20 offset:24832
    v_mfma_f32_16x16x32_bf16 v[76:79], v[196:199], a[12:15], v[76:79]
    ds_read_b64_tr_b16 v[162:163], v20 offset:26368
    v_mfma_f32_16x16x32_bf16 v[80:83], v[200:203], a[8:11], v[80:83]
    ds_read_b64_tr_b16 v[164:165], v21 offset:24832
    ds_read_b64_tr_b16 v[166:167], v21 offset:26368
    v_mfma_f32_16x16x32_bf16 v[84:87], v[200:203], a[12:15], v[84:87]
    ds_read_b64_tr_b16 v[168:169], v22 offset:24832
    v_mfma_f32_16x16x32_bf16 v[88:91], v[204:207], a[8:11], v[88:91]
    ds_read_b64_tr_b16 v[170:171], v22 offset:26368
    ds_read_b64_tr_b16 v[172:173], v23 offset:24832
    v_mfma_f32_16x16x32_bf16 v[92:95], v[204:207], a[12:15], v[92:95]
    ds_read_b64_tr_b16 v[174:175], v23 offset:26368
    buffer_load_dwordx4 a[4:7], v9, s[4:7], s80 offen offset:0 sc1
    v_mfma_f32_16x16x32_bf16 v[96:99], v[208:211], a[8:11], v[96:99]
    v_mfma_f32_16x16x32_bf16 v[100:103], v[208:211], a[12:15], v[100:103]
    v_mfma_f32_16x16x32_bf16 v[104:107], v[212:215], a[8:11], v[104:107]
    v_mfma_f32_16x16x32_bf16 v[108:111], v[212:215], a[12:15], v[108:111]
    v_mfma_f32_16x16x32_bf16 v[112:115], v[216:219], a[8:11], v[112:115]
    s_add_u32 m0, s81, 1024
    v_mfma_f32_16x16x32_bf16 v[116:119], v[216:219], a[12:15], v[116:119]
    buffer_load_dwordx4 v11, s[44:47], s56 offen nt lds
    v_mfma_f32_16x16x32_bf16 v[120:123], v[220:223], a[8:11], v[120:123]
    v_mfma_f32_16x16x32_bf16 v[124:127], v[220:223], a[12:15], v[124:127]
    s_waitcnt vmcnt(9) lgkmcnt(0)
    v_mfma_f32_16x16x32_bf16 v[32:35], v[128:131], a[16:19], v[32:35]
    ds_read_b64_tr_b16 v[176:177], v20 offset:36864
    ds_read_b64_tr_b16 v[178:179], v20 offset:38400
    v_mfma_f32_16x16x32_bf16 v[36:39], v[128:131], a[20:23], v[36:39]
    ds_read_b64_tr_b16 v[180:181], v21 offset:36864
    v_mfma_f32_16x16x32_bf16 v[40:43], v[132:135], a[16:19], v[40:43]
    ds_read_b64_tr_b16 v[182:183], v21 offset:38400
    ds_read_b64_tr_b16 v[184:185], v22 offset:36864
    v_mfma_f32_16x16x32_bf16 v[44:47], v[132:135], a[20:23], v[44:47]
    ds_read_b64_tr_b16 v[186:187], v22 offset:38400
    v_mfma_f32_16x16x32_bf16 v[48:51], v[136:139], a[16:19], v[48:51]
    ds_read_b64_tr_b16 v[188:189], v23 offset:36864
    ds_read_b64_tr_b16 v[190:191], v23 offset:38400
    buffer_load_dwordx4 a[8:11], v8, s[4:7], s80 offen offset:1024 sc1
    v_mfma_f32_16x16x32_bf16 v[52:55], v[136:139], a[20:23], v[52:55]
    ds_read_b64_tr_b16 v[192:193], v20 offset:36992
    v_mfma_f32_16x16x32_bf16 v[56:59], v[140:143], a[16:19], v[56:59]
    ds_read_b64_tr_b16 v[194:195], v20 offset:38528
    ds_read_b64_tr_b16 v[196:197], v21 offset:36992
    v_mfma_f32_16x16x32_bf16 v[60:63], v[140:143], a[20:23], v[60:63]
    ds_read_b64_tr_b16 v[198:199], v21 offset:38528
    v_mfma_f32_16x16x32_bf16 v[64:67], v[144:147], a[16:19], v[64:67]
    ds_read_b64_tr_b16 v[200:201], v22 offset:36992
    ds_read_b64_tr_b16 v[202:203], v22 offset:38528
    v_mfma_f32_16x16x32_bf16 v[68:71], v[144:147], a[20:23], v[68:71]
    ds_read_b64_tr_b16 v[204:205], v23 offset:36992
    v_mfma_f32_16x16x32_bf16 v[72:75], v[148:151], a[16:19], v[72:75]
    ds_read_b64_tr_b16 v[206:207], v23 offset:38528
    ds_read_b64_tr_b16 v[208:209], v20 offset:37120
    v_mfma_f32_16x16x32_bf16 v[76:79], v[148:151], a[20:23], v[76:79]
    ds_read_b64_tr_b16 v[210:211], v20 offset:38656
    s_add_u32 m0, s81, 2048
    v_mfma_f32_16x16x32_bf16 v[80:83], v[152:155], a[16:19], v[80:83]
    ds_read_b64_tr_b16 v[212:213], v21 offset:37120
    ds_read_b64_tr_b16 v[214:215], v21 offset:38656
    buffer_load_dwordx4 v12, s[44:47], s56 offen nt lds
    v_mfma_f32_16x16x32_bf16 v[84:87], v[152:155], a[20:23], v[84:87]
    ds_read_b64_tr_b16 v[216:217], v22 offset:37120
    v_mfma_f32_16x16x32_bf16 v[88:91], v[156:159], a[16:19], v[88:91]
    ds_read_b64_tr_b16 v[218:219], v22 offset:38656
    ds_read_b64_tr_b16 v[220:221], v23 offset:37120
    v_mfma_f32_16x16x32_bf16 v[92:95], v[156:159], a[20:23], v[92:95]
    ds_read_b64_tr_b16 v[222:223], v23 offset:38656
    v_mfma_f32_16x16x32_bf16 v[96:99], v[160:163], a[16:19], v[96:99]
    v_mfma_f32_16x16x32_bf16 v[100:103], v[160:163], a[20:23], v[100:103]
    v_mfma_f32_16x16x32_bf16 v[104:107], v[164:167], a[16:19], v[104:107]
    v_mfma_f32_16x16x32_bf16 v[108:111], v[164:167], a[20:23], v[108:111]
    v_mfma_f32_16x16x32_bf16 v[112:115], v[168:171], a[16:19], v[112:115]
    buffer_load_dwordx4 a[12:15], v9, s[4:7], s80 offen offset:1024 sc1
    v_mfma_f32_16x16x32_bf16 v[116:119], v[168:171], a[20:23], v[116:119]
    v_mfma_f32_16x16x32_bf16 v[120:123], v[172:175], a[16:19], v[120:123]
    v_mfma_f32_16x16x32_bf16 v[124:127], v[172:175], a[20:23], v[124:127]
    s_waitcnt vmcnt(8) lgkmcnt(0)
    s_barrier
    v_mfma_f32_16x16x32_bf16 v[32:35], v[176:179], a[24:27], v[32:35]
    ds_read_b64_tr_b16 v[128:129], v20 offset:49152
    ds_read_b64_tr_b16 v[130:131], v20 offset:50688
    v_mfma_f32_16x16x32_bf16 v[36:39], v[176:179], a[28:31], v[36:39]
    ds_read_b64_tr_b16 v[132:133], v21 offset:49152
    v_mfma_f32_16x16x32_bf16 v[40:43], v[180:183], a[24:27], v[40:43]
    ds_read_b64_tr_b16 v[134:135], v21 offset:50688
    ds_read_b64_tr_b16 v[136:137], v22 offset:49152
    v_mfma_f32_16x16x32_bf16 v[44:47], v[180:183], a[28:31], v[44:47]
    ds_read_b64_tr_b16 v[138:139], v22 offset:50688
    v_mfma_f32_16x16x32_bf16 v[48:51], v[184:187], a[24:27], v[48:51]
    ds_read_b64_tr_b16 v[140:141], v23 offset:49152
    ds_read_b64_tr_b16 v[142:143], v23 offset:50688
    v_mfma_f32_16x16x32_bf16 v[52:55], v[184:187], a[28:31], v[52:55]
    ds_read_b64_tr_b16 v[144:145], v20 offset:49280
    v_mfma_f32_16x16x32_bf16 v[56:59], v[188:191], a[24:27], v[56:59]
    ds_read_b64_tr_b16 v[146:147], v20 offset:50816
    ds_read_b64_tr_b16 v[148:149], v21 offset:49280
    buffer_load_dwordx4 a[16:19], v8, s[4:7], s80 offen offset:2048 sc1
    v_mfma_f32_16x16x32_bf16 v[60:63], v[188:191], a[28:31], v[60:63]
    ds_read_b64_tr_b16 v[150:151], v21 offset:50816
    v_mfma_f32_16x16x32_bf16 v[64:67], v[192:195], a[24:27], v[64:67]
    ds_read_b64_tr_b16 v[152:153], v22 offset:49280
    ds_read_b64_tr_b16 v[154:155], v22 offset:50816
    v_mfma_f32_16x16x32_bf16 v[68:71], v[192:195], a[28:31], v[68:71]
    ds_read_b64_tr_b16 v[156:157], v23 offset:49280
    v_mfma_f32_16x16x32_bf16 v[72:75], v[196:199], a[24:27], v[72:75]
    ds_read_b64_tr_b16 v[158:159], v23 offset:50816
    ds_read_b64_tr_b16 v[160:161], v20 offset:49408
    v_mfma_f32_16x16x32_bf16 v[76:79], v[196:199], a[28:31], v[76:79]
    ds_read_b64_tr_b16 v[162:163], v20 offset:50944
    v_mfma_f32_16x16x32_bf16 v[80:83], v[200:203], a[24:27], v[80:83]
    ds_read_b64_tr_b16 v[164:165], v21 offset:49408
    ds_read_b64_tr_b16 v[166:167], v21 offset:50944
    v_mfma_f32_16x16x32_bf16 v[84:87], v[200:203], a[28:31], v[84:87]
    ds_read_b64_tr_b16 v[168:169], v22 offset:49408
    v_mfma_f32_16x16x32_bf16 v[88:91], v[204:207], a[24:27], v[88:91]
    ds_read_b64_tr_b16 v[170:171], v22 offset:50944
    ds_read_b64_tr_b16 v[172:173], v23 offset:49408
    v_mfma_f32_16x16x32_bf16 v[92:95], v[204:207], a[28:31], v[92:95]
    ds_read_b64_tr_b16 v[174:175], v23 offset:50944
    v_mfma_f32_16x16x32_bf16 v[96:99], v[208:211], a[24:27], v[96:99]
    v_mfma_f32_16x16x32_bf16 v[100:103], v[208:211], a[28:31], v[100:103]
    v_mfma_f32_16x16x32_bf16 v[104:107], v[212:215], a[24:27], v[104:107]
    buffer_load_dwordx4 a[20:23], v9, s[4:7], s80 offen offset:2048 sc1
    v_mfma_f32_16x16x32_bf16 v[108:111], v[212:215], a[28:31], v[108:111]
    v_mfma_f32_16x16x32_bf16 v[112:115], v[216:219], a[24:27], v[112:115]
    v_mfma_f32_16x16x32_bf16 v[116:119], v[216:219], a[28:31], v[116:119]
    v_mfma_f32_16x16x32_bf16 v[120:123], v[220:223], a[24:27], v[120:123]
    v_mfma_f32_16x16x32_bf16 v[124:127], v[220:223], a[28:31], v[124:127]
    s_waitcnt vmcnt(6) lgkmcnt(0)
    v_mfma_f32_16x16x32_bf16 v[32:35], v[128:131], a[0:3], v[32:35]
    ds_read_b64_tr_b16 v[176:177], v20 offset:61440
    ds_read_b64_tr_b16 v[178:179], v20 offset:62976
    v_mfma_f32_16x16x32_bf16 v[36:39], v[128:131], a[4:7], v[36:39]
    ds_read_b64_tr_b16 v[180:181], v21 offset:61440
    v_mfma_f32_16x16x32_bf16 v[40:43], v[132:135], a[0:3], v[40:43]
    ds_read_b64_tr_b16 v[182:183], v21 offset:62976
    ds_read_b64_tr_b16 v[184:185], v22 offset:61440
    v_mfma_f32_16x16x32_bf16 v[44:47], v[132:135], a[4:7], v[44:47]
    ds_read_b64_tr_b16 v[186:187], v22 offset:62976
    v_mfma_f32_16x16x32_bf16 v[48:51], v[136:139], a[0:3], v[48:51]
    ds_read_b64_tr_b16 v[188:189], v23 offset:61440
    ds_read_b64_tr_b16 v[190:191], v23 offset:62976
    v_mfma_f32_16x16x32_bf16 v[52:55], v[136:139], a[4:7], v[52:55]
    ds_read_b64_tr_b16 v[192:193], v20 offset:61568
    v_mfma_f32_16x16x32_bf16 v[56:59], v[140:143], a[0:3], v[56:59]
    ds_read_b64_tr_b16 v[194:195], v20 offset:63104
    ds_read_b64_tr_b16 v[196:197], v21 offset:61568
    buffer_load_dwordx4 a[24:27], v8, s[4:7], s80 offen offset:3072 sc1
    v_mfma_f32_16x16x32_bf16 v[60:63], v[140:143], a[4:7], v[60:63]
    ds_read_b64_tr_b16 v[198:199], v21 offset:63104
    v_mfma_f32_16x16x32_bf16 v[64:67], v[144:147], a[0:3], v[64:67]
    ds_read_b64_tr_b16 v[200:201], v22 offset:61568
    ds_read_b64_tr_b16 v[202:203], v22 offset:63104
    v_mfma_f32_16x16x32_bf16 v[68:71], v[144:147], a[4:7], v[68:71]
    ds_read_b64_tr_b16 v[204:205], v23 offset:61568
    v_mfma_f32_16x16x32_bf16 v[72:75], v[148:151], a[0:3], v[72:75]
    ds_read_b64_tr_b16 v[206:207], v23 offset:63104
    ds_read_b64_tr_b16 v[208:209], v20 offset:61696
    v_mfma_f32_16x16x32_bf16 v[76:79], v[148:151], a[4:7], v[76:79]
    ds_read_b64_tr_b16 v[210:211], v20 offset:63232
    v_mfma_f32_16x16x32_bf16 v[80:83], v[152:155], a[0:3], v[80:83]
    ds_read_b64_tr_b16 v[212:213], v21 offset:61696
    ds_read_b64_tr_b16 v[214:215], v21 offset:63232
    v_mfma_f32_16x16x32_bf16 v[84:87], v[152:155], a[4:7], v[84:87]
    ds_read_b64_tr_b16 v[216:217], v22 offset:61696
    v_mfma_f32_16x16x32_bf16 v[88:91], v[156:159], a[0:3], v[88:91]
    ds_read_b64_tr_b16 v[218:219], v22 offset:63232
    ds_read_b64_tr_b16 v[220:221], v23 offset:61696
    v_mfma_f32_16x16x32_bf16 v[92:95], v[156:159], a[4:7], v[92:95]
    ds_read_b64_tr_b16 v[222:223], v23 offset:63232
    v_mfma_f32_16x16x32_bf16 v[96:99], v[160:163], a[0:3], v[96:99]
    v_mfma_f32_16x16x32_bf16 v[100:103], v[160:163], a[4:7], v[100:103]
    v_mfma_f32_16x16x32_bf16 v[104:107], v[164:167], a[0:3], v[104:107]
    buffer_load_dwordx4 a[28:31], v9, s[4:7], s80 offen offset:3072 sc1
    v_mfma_f32_16x16x32_bf16 v[108:111], v[164:167], a[4:7], v[108:111]
    v_mfma_f32_16x16x32_bf16 v[112:115], v[168:171], a[0:3], v[112:115]
    v_mfma_f32_16x16x32_bf16 v[116:119], v[168:171], a[4:7], v[116:119]
    v_mfma_f32_16x16x32_bf16 v[120:123], v[172:175], a[0:3], v[120:123]
    v_mfma_f32_16x16x32_bf16 v[124:127], v[172:175], a[4:7], v[124:127]
    s_waitcnt vmcnt(4) lgkmcnt(0)
    s_barrier
    v_mfma_f32_16x16x32_bf16 v[32:35], v[176:179], a[8:11], v[32:35]
    ds_read_b64_tr_b16 v[128:129], v24 offset:8192
    ds_read_b64_tr_b16 v[130:131], v24 offset:9728
    v_mfma_f32_16x16x32_bf16 v[36:39], v[176:179], a[12:15], v[36:39]
    ds_read_b64_tr_b16 v[132:133], v25 offset:8192
    v_mfma_f32_16x16x32_bf16 v[40:43], v[180:183], a[8:11], v[40:43]
    ds_read_b64_tr_b16 v[134:135], v25 offset:9728
    ds_read_b64_tr_b16 v[136:137], v26 offset:8192
    v_mfma_f32_16x16x32_bf16 v[44:47], v[180:183], a[12:15], v[44:47]
    ds_read_b64_tr_b16 v[138:139], v26 offset:9728
    v_mfma_f32_16x16x32_bf16 v[48:51], v[184:187], a[8:11], v[48:51]
    ds_read_b64_tr_b16 v[140:141], v27 offset:8192
    ds_read_b64_tr_b16 v[142:143], v27 offset:9728
    v_mfma_f32_16x16x32_bf16 v[52:55], v[184:187], a[12:15], v[52:55]
    ds_read_b64_tr_b16 v[144:145], v24 offset:8320
    s_add_u32 s80, s80, 4096
    v_mfma_f32_16x16x32_bf16 v[56:59], v[188:191], a[8:11], v[56:59]
    ds_read_b64_tr_b16 v[146:147], v24 offset:9856
    ds_read_b64_tr_b16 v[148:149], v25 offset:8320
    buffer_load_dwordx4 a[0:3], v8, s[4:7], s80 offen offset:0 sc1
    v_mfma_f32_16x16x32_bf16 v[60:63], v[188:191], a[12:15], v[60:63]
    ds_read_b64_tr_b16 v[150:151], v25 offset:9856
    v_mfma_f32_16x16x32_bf16 v[64:67], v[192:195], a[8:11], v[64:67]
    ds_read_b64_tr_b16 v[152:153], v26 offset:8320
    ds_read_b64_tr_b16 v[154:155], v26 offset:9856
    v_mfma_f32_16x16x32_bf16 v[68:71], v[192:195], a[12:15], v[68:71]
    ds_read_b64_tr_b16 v[156:157], v27 offset:8320
    v_mfma_f32_16x16x32_bf16 v[72:75], v[196:199], a[8:11], v[72:75]
    ds_read_b64_tr_b16 v[158:159], v27 offset:9856
    ds_read_b64_tr_b16 v[160:161], v24 offset:8448
    v_mfma_f32_16x16x32_bf16 v[76:79], v[196:199], a[12:15], v[76:79]
    ds_read_b64_tr_b16 v[162:163], v24 offset:9984
    v_mfma_f32_16x16x32_bf16 v[80:83], v[200:203], a[8:11], v[80:83]
    ds_read_b64_tr_b16 v[164:165], v25 offset:8448
    ds_read_b64_tr_b16 v[166:167], v25 offset:9984
    v_mfma_f32_16x16x32_bf16 v[84:87], v[200:203], a[12:15], v[84:87]
    ds_read_b64_tr_b16 v[168:169], v26 offset:8448
    v_mfma_f32_16x16x32_bf16 v[88:91], v[204:207], a[8:11], v[88:91]
    ds_read_b64_tr_b16 v[170:171], v26 offset:9984
    ds_read_b64_tr_b16 v[172:173], v27 offset:8448
    v_mfma_f32_16x16x32_bf16 v[92:95], v[204:207], a[12:15], v[92:95]
    ds_read_b64_tr_b16 v[174:175], v27 offset:9984
    v_mfma_f32_16x16x32_bf16 v[96:99], v[208:211], a[8:11], v[96:99]
    v_mfma_f32_16x16x32_bf16 v[100:103], v[208:211], a[12:15], v[100:103]
    v_mfma_f32_16x16x32_bf16 v[104:107], v[212:215], a[8:11], v[104:107]
    buffer_load_dwordx4 a[4:7], v9, s[4:7], s80 offen offset:0 sc1
    v_mfma_f32_16x16x32_bf16 v[108:111], v[212:215], a[12:15], v[108:111]
    v_mfma_f32_16x16x32_bf16 v[112:115], v[216:219], a[8:11], v[112:115]
    v_mfma_f32_16x16x32_bf16 v[116:119], v[216:219], a[12:15], v[116:119]
    v_mfma_f32_16x16x32_bf16 v[120:123], v[220:223], a[8:11], v[120:123]
    v_mfma_f32_16x16x32_bf16 v[124:127], v[220:223], a[12:15], v[124:127]
    s_waitcnt vmcnt(4) lgkmcnt(0)
    v_mfma_f32_16x16x32_bf16 v[32:35], v[128:131], a[16:19], v[32:35]
    ds_read_b64_tr_b16 v[176:177], v24 offset:20480
    ds_read_b64_tr_b16 v[178:179], v24 offset:22016
    v_mfma_f32_16x16x32_bf16 v[36:39], v[128:131], a[20:23], v[36:39]
    ds_read_b64_tr_b16 v[180:181], v25 offset:20480
    v_mfma_f32_16x16x32_bf16 v[40:43], v[132:135], a[16:19], v[40:43]
    ds_read_b64_tr_b16 v[182:183], v25 offset:22016
    ds_read_b64_tr_b16 v[184:185], v26 offset:20480
    v_mfma_f32_16x16x32_bf16 v[44:47], v[132:135], a[20:23], v[44:47]
    ds_read_b64_tr_b16 v[186:187], v26 offset:22016
    v_mfma_f32_16x16x32_bf16 v[48:51], v[136:139], a[16:19], v[48:51]
    ds_read_b64_tr_b16 v[188:189], v27 offset:20480
    ds_read_b64_tr_b16 v[190:191], v27 offset:22016
    buffer_load_dwordx4 a[8:11], v8, s[4:7], s80 offen offset:1024 sc1
    v_mfma_f32_16x16x32_bf16 v[52:55], v[136:139], a[20:23], v[52:55]
    ds_read_b64_tr_b16 v[192:193], v24 offset:20608
    v_mfma_f32_16x16x32_bf16 v[56:59], v[140:143], a[16:19], v[56:59]
    ds_read_b64_tr_b16 v[194:195], v24 offset:22144
    ds_read_b64_tr_b16 v[196:197], v25 offset:20608
    v_mfma_f32_16x16x32_bf16 v[60:63], v[140:143], a[20:23], v[60:63]
    ds_read_b64_tr_b16 v[198:199], v25 offset:22144
    v_mfma_f32_16x16x32_bf16 v[64:67], v[144:147], a[16:19], v[64:67]
    ds_read_b64_tr_b16 v[200:201], v26 offset:20608
    ds_read_b64_tr_b16 v[202:203], v26 offset:22144
    v_mfma_f32_16x16x32_bf16 v[68:71], v[144:147], a[20:23], v[68:71]
    ds_read_b64_tr_b16 v[204:205], v27 offset:20608
    v_mfma_f32_16x16x32_bf16 v[72:75], v[148:151], a[16:19], v[72:75]
    ds_read_b64_tr_b16 v[206:207], v27 offset:22144
    ds_read_b64_tr_b16 v[208:209], v24 offset:20736
    v_mfma_f32_16x16x32_bf16 v[76:79], v[148:151], a[20:23], v[76:79]
    ds_read_b64_tr_b16 v[210:211], v24 offset:22272
    v_mfma_f32_16x16x32_bf16 v[80:83], v[152:155], a[16:19], v[80:83]
    ds_read_b64_tr_b16 v[212:213], v25 offset:20736
    ds_read_b64_tr_b16 v[214:215], v25 offset:22272
    buffer_load_dwordx4 a[12:15], v9, s[4:7], s80 offen offset:1024 sc1
    v_mfma_f32_16x16x32_bf16 v[84:87], v[152:155], a[20:23], v[84:87]
    ds_read_b64_tr_b16 v[216:217], v26 offset:20736
    v_mfma_f32_16x16x32_bf16 v[88:91], v[156:159], a[16:19], v[88:91]
    ds_read_b64_tr_b16 v[218:219], v26 offset:22272
    ds_read_b64_tr_b16 v[220:221], v27 offset:20736
    v_mfma_f32_16x16x32_bf16 v[92:95], v[156:159], a[20:23], v[92:95]
    ds_read_b64_tr_b16 v[222:223], v27 offset:22272
    v_mfma_f32_16x16x32_bf16 v[96:99], v[160:163], a[16:19], v[96:99]
    v_mfma_f32_16x16x32_bf16 v[100:103], v[160:163], a[20:23], v[100:103]
    v_mfma_f32_16x16x32_bf16 v[104:107], v[164:167], a[16:19], v[104:107]
    v_mfma_f32_16x16x32_bf16 v[108:111], v[164:167], a[20:23], v[108:111]
    s_mov_b32 s8, s32
    s_mov_b32 s9, s33
    s_mov_b32 s10, 7340032
    s_mov_b32 s11, 0x20000
    v_mfma_f32_16x16x32_bf16 v[112:115], v[168:171], a[16:19], v[112:115]
    buffer_load_dword v7, v14, s[8:11], 0 offen
    v_mfma_f32_16x16x32_bf16 v[116:119], v[168:171], a[20:23], v[116:119]
    v_mfma_f32_16x16x32_bf16 v[120:123], v[172:175], a[16:19], v[120:123]
    v_mfma_f32_16x16x32_bf16 v[124:127], v[172:175], a[20:23], v[124:127]
    s_waitcnt vmcnt(5) lgkmcnt(0)
    s_barrier
    v_mfma_f32_16x16x32_bf16 v[32:35], v[176:179], a[24:27], v[32:35]
    ds_read_b64_tr_b16 v[128:129], v24 offset:32768
    ds_read_b64_tr_b16 v[130:131], v24 offset:34304
    v_mfma_f32_16x16x32_bf16 v[36:39], v[176:179], a[28:31], v[36:39]
    ds_read_b64_tr_b16 v[132:133], v25 offset:32768
    v_mfma_f32_16x16x32_bf16 v[40:43], v[180:183], a[24:27], v[40:43]
    ds_read_b64_tr_b16 v[134:135], v25 offset:34304
    ds_read_b64_tr_b16 v[136:137], v26 offset:32768
    v_mfma_f32_16x16x32_bf16 v[44:47], v[180:183], a[28:31], v[44:47]
    ds_read_b64_tr_b16 v[138:139], v26 offset:34304
    v_mfma_f32_16x16x32_bf16 v[48:51], v[184:187], a[24:27], v[48:51]
    ds_read_b64_tr_b16 v[140:141], v27 offset:32768
    ds_read_b64_tr_b16 v[142:143], v27 offset:34304
    v_mfma_f32_16x16x32_bf16 v[52:55], v[184:187], a[28:31], v[52:55]
    ds_read_b64_tr_b16 v[144:145], v24 offset:32896
    v_mfma_f32_16x16x32_bf16 v[56:59], v[188:191], a[24:27], v[56:59]
    ds_read_b64_tr_b16 v[146:147], v24 offset:34432
    ds_read_b64_tr_b16 v[148:149], v25 offset:32896
    buffer_load_dwordx4 a[16:19], v8, s[4:7], s80 offen offset:2048 sc1
    v_mfma_f32_16x16x32_bf16 v[60:63], v[188:191], a[28:31], v[60:63]
    ds_read_b64_tr_b16 v[150:151], v25 offset:34432
    v_mfma_f32_16x16x32_bf16 v[64:67], v[192:195], a[24:27], v[64:67]
    ds_read_b64_tr_b16 v[152:153], v26 offset:32896
    ds_read_b64_tr_b16 v[154:155], v26 offset:34432
    v_mfma_f32_16x16x32_bf16 v[68:71], v[192:195], a[28:31], v[68:71]
    ds_read_b64_tr_b16 v[156:157], v27 offset:32896
    v_mfma_f32_16x16x32_bf16 v[72:75], v[196:199], a[24:27], v[72:75]
    ds_read_b64_tr_b16 v[158:159], v27 offset:34432
    ds_read_b64_tr_b16 v[160:161], v24 offset:33024
    v_mfma_f32_16x16x32_bf16 v[76:79], v[196:199], a[28:31], v[76:79]
    ds_read_b64_tr_b16 v[162:163], v24 offset:34560
    v_mfma_f32_16x16x32_bf16 v[80:83], v[200:203], a[24:27], v[80:83]
    ds_read_b64_tr_b16 v[164:165], v25 offset:33024
    ds_read_b64_tr_b16 v[166:167], v25 offset:34560
    v_mfma_f32_16x16x32_bf16 v[84:87], v[200:203], a[28:31], v[84:87]
    ds_read_b64_tr_b16 v[168:169], v26 offset:33024
    v_mfma_f32_16x16x32_bf16 v[88:91], v[204:207], a[24:27], v[88:91]
    ds_read_b64_tr_b16 v[170:171], v26 offset:34560
    ds_read_b64_tr_b16 v[172:173], v27 offset:33024
    v_mfma_f32_16x16x32_bf16 v[92:95], v[204:207], a[28:31], v[92:95]
    ds_read_b64_tr_b16 v[174:175], v27 offset:34560
    v_mfma_f32_16x16x32_bf16 v[96:99], v[208:211], a[24:27], v[96:99]
    v_mfma_f32_16x16x32_bf16 v[100:103], v[208:211], a[28:31], v[100:103]
    v_mfma_f32_16x16x32_bf16 v[104:107], v[212:215], a[24:27], v[104:107]
    buffer_load_dwordx4 a[20:23], v9, s[4:7], s80 offen offset:2048 sc1
    v_mfma_f32_16x16x32_bf16 v[108:111], v[212:215], a[28:31], v[108:111]
    v_mfma_f32_16x16x32_bf16 v[112:115], v[216:219], a[24:27], v[112:115]
    v_mfma_f32_16x16x32_bf16 v[116:119], v[216:219], a[28:31], v[116:119]
    v_mfma_f32_16x16x32_bf16 v[120:123], v[220:223], a[24:27], v[120:123]
    v_mfma_f32_16x16x32_bf16 v[124:127], v[220:223], a[28:31], v[124:127]
    s_waitcnt vmcnt(5) lgkmcnt(0)
    v_mfma_f32_16x16x32_bf16 v[32:35], v[128:131], a[0:3], v[32:35]
    ds_read_b64_tr_b16 v[176:177], v24 offset:45056
    ds_read_b64_tr_b16 v[178:179], v24 offset:46592
    v_mfma_f32_16x16x32_bf16 v[36:39], v[128:131], a[4:7], v[36:39]
    ds_read_b64_tr_b16 v[180:181], v25 offset:45056
    v_mfma_f32_16x16x32_bf16 v[40:43], v[132:135], a[0:3], v[40:43]
    ds_read_b64_tr_b16 v[182:183], v25 offset:46592
    ds_read_b64_tr_b16 v[184:185], v26 offset:45056
    v_mfma_f32_16x16x32_bf16 v[44:47], v[132:135], a[4:7], v[44:47]
    ds_read_b64_tr_b16 v[186:187], v26 offset:46592
    v_mfma_f32_16x16x32_bf16 v[48:51], v[136:139], a[0:3], v[48:51]
    ds_read_b64_tr_b16 v[188:189], v27 offset:45056
    ds_read_b64_tr_b16 v[190:191], v27 offset:46592
    v_mfma_f32_16x16x32_bf16 v[52:55], v[136:139], a[4:7], v[52:55]
    ds_read_b64_tr_b16 v[192:193], v24 offset:45184
    v_mfma_f32_16x16x32_bf16 v[56:59], v[140:143], a[0:3], v[56:59]
    ds_read_b64_tr_b16 v[194:195], v24 offset:46720
    ds_read_b64_tr_b16 v[196:197], v25 offset:45184
    buffer_load_dwordx4 a[24:27], v8, s[4:7], s80 offen offset:3072 sc1
    v_mfma_f32_16x16x32_bf16 v[60:63], v[140:143], a[4:7], v[60:63]
    ds_read_b64_tr_b16 v[198:199], v25 offset:46720
    v_mfma_f32_16x16x32_bf16 v[64:67], v[144:147], a[0:3], v[64:67]
    ds_read_b64_tr_b16 v[200:201], v26 offset:45184
    ds_read_b64_tr_b16 v[202:203], v26 offset:46720
    v_mfma_f32_16x16x32_bf16 v[68:71], v[144:147], a[4:7], v[68:71]
    ds_read_b64_tr_b16 v[204:205], v27 offset:45184
    v_mfma_f32_16x16x32_bf16 v[72:75], v[148:151], a[0:3], v[72:75]
    ds_read_b64_tr_b16 v[206:207], v27 offset:46720
    ds_read_b64_tr_b16 v[208:209], v24 offset:45312
    v_mfma_f32_16x16x32_bf16 v[76:79], v[148:151], a[4:7], v[76:79]
    ds_read_b64_tr_b16 v[210:211], v24 offset:46848
    v_mfma_f32_16x16x32_bf16 v[80:83], v[152:155], a[0:3], v[80:83]
    ds_read_b64_tr_b16 v[212:213], v25 offset:45312
    ds_read_b64_tr_b16 v[214:215], v25 offset:46848
    v_mfma_f32_16x16x32_bf16 v[84:87], v[152:155], a[4:7], v[84:87]
    ds_read_b64_tr_b16 v[216:217], v26 offset:45312
    v_mfma_f32_16x16x32_bf16 v[88:91], v[156:159], a[0:3], v[88:91]
    ds_read_b64_tr_b16 v[218:219], v26 offset:46848
    ds_read_b64_tr_b16 v[220:221], v27 offset:45312
    v_mfma_f32_16x16x32_bf16 v[92:95], v[156:159], a[4:7], v[92:95]
    ds_read_b64_tr_b16 v[222:223], v27 offset:46848
    v_mfma_f32_16x16x32_bf16 v[96:99], v[160:163], a[0:3], v[96:99]
    v_mfma_f32_16x16x32_bf16 v[100:103], v[160:163], a[4:7], v[100:103]
    v_mfma_f32_16x16x32_bf16 v[104:107], v[164:167], a[0:3], v[104:107]
    buffer_load_dwordx4 a[28:31], v9, s[4:7], s80 offen offset:3072 sc1
    v_mfma_f32_16x16x32_bf16 v[108:111], v[164:167], a[4:7], v[108:111]
    v_mfma_f32_16x16x32_bf16 v[112:115], v[168:171], a[0:3], v[112:115]
    v_mfma_f32_16x16x32_bf16 v[116:119], v[168:171], a[4:7], v[116:119]
    v_mfma_f32_16x16x32_bf16 v[120:123], v[172:175], a[0:3], v[120:123]
    v_mfma_f32_16x16x32_bf16 v[124:127], v[172:175], a[4:7], v[124:127]
    s_waitcnt vmcnt(5) lgkmcnt(0)
    s_barrier
    v_mfma_f32_16x16x32_bf16 v[32:35], v[176:179], a[8:11], v[32:35]
    ds_read_b64_tr_b16 v[128:129], v20 offset:0
    ds_read_b64_tr_b16 v[130:131], v20 offset:1536
    v_mfma_f32_16x16x32_bf16 v[36:39], v[176:179], a[12:15], v[36:39]
    ds_read_b64_tr_b16 v[132:133], v21 offset:0
    v_mfma_f32_16x16x32_bf16 v[40:43], v[180:183], a[8:11], v[40:43]
    ds_read_b64_tr_b16 v[134:135], v21 offset:1536
    ds_read_b64_tr_b16 v[136:137], v22 offset:0
    v_mfma_f32_16x16x32_bf16 v[44:47], v[180:183], a[12:15], v[44:47]
    ds_read_b64_tr_b16 v[138:139], v22 offset:1536
    v_mfma_f32_16x16x32_bf16 v[48:51], v[184:187], a[8:11], v[48:51]
    ds_read_b64_tr_b16 v[140:141], v23 offset:0
    ds_read_b64_tr_b16 v[142:143], v23 offset:1536
    v_mfma_f32_16x16x32_bf16 v[52:55], v[184:187], a[12:15], v[52:55]
    ds_read_b64_tr_b16 v[144:145], v20 offset:128
    v_mfma_f32_16x16x32_bf16 v[56:59], v[188:191], a[8:11], v[56:59]
    ds_read_b64_tr_b16 v[146:147], v20 offset:1664
    ds_read_b64_tr_b16 v[148:149], v21 offset:128
    v_mfma_f32_16x16x32_bf16 v[60:63], v[188:191], a[12:15], v[60:63]
    ds_read_b64_tr_b16 v[150:151], v21 offset:1664
    v_mfma_f32_16x16x32_bf16 v[64:67], v[192:195], a[8:11], v[64:67]
    ds_read_b64_tr_b16 v[152:153], v22 offset:128
    ds_read_b64_tr_b16 v[154:155], v22 offset:1664
    v_mfma_f32_16x16x32_bf16 v[68:71], v[192:195], a[12:15], v[68:71]
    ds_read_b64_tr_b16 v[156:157], v23 offset:128
    v_mfma_f32_16x16x32_bf16 v[72:75], v[196:199], a[8:11], v[72:75]
    ds_read_b64_tr_b16 v[158:159], v23 offset:1664
    ds_read_b64_tr_b16 v[160:161], v20 offset:256
    v_mfma_f32_16x16x32_bf16 v[76:79], v[196:199], a[12:15], v[76:79]
    ds_read_b64_tr_b16 v[162:163], v20 offset:1792
    v_mfma_f32_16x16x32_bf16 v[80:83], v[200:203], a[8:11], v[80:83]
    ds_read_b64_tr_b16 v[164:165], v21 offset:256
    ds_read_b64_tr_b16 v[166:167], v21 offset:1792
    v_mfma_f32_16x16x32_bf16 v[84:87], v[200:203], a[12:15], v[84:87]
    ds_read_b64_tr_b16 v[168:169], v22 offset:256
    v_mfma_f32_16x16x32_bf16 v[88:91], v[204:207], a[8:11], v[88:91]
    ds_read_b64_tr_b16 v[170:171], v22 offset:1792
    ds_read_b64_tr_b16 v[172:173], v23 offset:256
    v_mfma_f32_16x16x32_bf16 v[92:95], v[204:207], a[12:15], v[92:95]
    ds_read_b64_tr_b16 v[174:175], v23 offset:1792
    v_mfma_f32_16x16x32_bf16 v[96:99], v[208:211], a[8:11], v[96:99]
    v_mfma_f32_16x16x32_bf16 v[100:103], v[208:211], a[12:15], v[100:103]
    v_mfma_f32_16x16x32_bf16 v[104:107], v[212:215], a[8:11], v[104:107]
    v_mfma_f32_16x16x32_bf16 v[108:111], v[212:215], a[12:15], v[108:111]
    v_mfma_f32_16x16x32_bf16 v[112:115], v[216:219], a[8:11], v[112:115]
    v_mfma_f32_16x16x32_bf16 v[116:119], v[216:219], a[12:15], v[116:119]
    v_mfma_f32_16x16x32_bf16 v[120:123], v[220:223], a[8:11], v[120:123]
    v_mfma_f32_16x16x32_bf16 v[124:127], v[220:223], a[12:15], v[124:127]
    s_waitcnt vmcnt(2) lgkmcnt(0)
    v_mfma_f32_16x16x32_bf16 v[32:35], v[128:131], a[16:19], v[32:35]
    ds_read_b64_tr_b16 v[176:177], v20 offset:12288
    ds_read_b64_tr_b16 v[178:179], v20 offset:13824
    v_mfma_f32_16x16x32_bf16 v[36:39], v[128:131], a[20:23], v[36:39]
    ds_read_b64_tr_b16 v[180:181], v21 offset:12288
    v_mfma_f32_16x16x32_bf16 v[40:43], v[132:135], a[16:19], v[40:43]
    ds_read_b64_tr_b16 v[182:183], v21 offset:13824
    ds_read_b64_tr_b16 v[184:185], v22 offset:12288
    v_mfma_f32_16x16x32_bf16 v[44:47], v[132:135], a[20:23], v[44:47]
    ds_read_b64_tr_b16 v[186:187], v22 offset:13824
    v_mfma_f32_16x16x32_bf16 v[48:51], v[136:139], a[16:19], v[48:51]
    ds_read_b64_tr_b16 v[188:189], v23 offset:12288
    ds_read_b64_tr_b16 v[190:191], v23 offset:13824
    v_mfma_f32_16x16x32_bf16 v[52:55], v[136:139], a[20:23], v[52:55]
    ds_read_b64_tr_b16 v[192:193], v20 offset:12416
    v_mfma_f32_16x16x32_bf16 v[56:59], v[140:143], a[16:19], v[56:59]
    ds_read_b64_tr_b16 v[194:195], v20 offset:13952
    ds_read_b64_tr_b16 v[196:197], v21 offset:12416
    v_mfma_f32_16x16x32_bf16 v[60:63], v[140:143], a[20:23], v[60:63]
    ds_read_b64_tr_b16 v[198:199], v21 offset:13952
    v_mfma_f32_16x16x32_bf16 v[64:67], v[144:147], a[16:19], v[64:67]
    ds_read_b64_tr_b16 v[200:201], v22 offset:12416
    ds_read_b64_tr_b16 v[202:203], v22 offset:13952
    v_mfma_f32_16x16x32_bf16 v[68:71], v[144:147], a[20:23], v[68:71]
    ds_read_b64_tr_b16 v[204:205], v23 offset:12416
    v_mfma_f32_16x16x32_bf16 v[72:75], v[148:151], a[16:19], v[72:75]
    ds_read_b64_tr_b16 v[206:207], v23 offset:13952
    ds_read_b64_tr_b16 v[208:209], v20 offset:12544
    v_mfma_f32_16x16x32_bf16 v[76:79], v[148:151], a[20:23], v[76:79]
    ds_read_b64_tr_b16 v[210:211], v20 offset:14080
    v_mfma_f32_16x16x32_bf16 v[80:83], v[152:155], a[16:19], v[80:83]
    ds_read_b64_tr_b16 v[212:213], v21 offset:12544
    ds_read_b64_tr_b16 v[214:215], v21 offset:14080
    v_mfma_f32_16x16x32_bf16 v[84:87], v[152:155], a[20:23], v[84:87]
    ds_read_b64_tr_b16 v[216:217], v22 offset:12544
    v_mfma_f32_16x16x32_bf16 v[88:91], v[156:159], a[16:19], v[88:91]
    ds_read_b64_tr_b16 v[218:219], v22 offset:14080
    ds_read_b64_tr_b16 v[220:221], v23 offset:12544
    v_mfma_f32_16x16x32_bf16 v[92:95], v[156:159], a[20:23], v[92:95]
    ds_read_b64_tr_b16 v[222:223], v23 offset:14080
    v_mfma_f32_16x16x32_bf16 v[96:99], v[160:163], a[16:19], v[96:99]
    v_mfma_f32_16x16x32_bf16 v[100:103], v[160:163], a[20:23], v[100:103]
    v_mfma_f32_16x16x32_bf16 v[104:107], v[164:167], a[16:19], v[104:107]
    v_mfma_f32_16x16x32_bf16 v[108:111], v[164:167], a[20:23], v[108:111]
    v_mfma_f32_16x16x32_bf16 v[112:115], v[168:171], a[16:19], v[112:115]
    v_mfma_f32_16x16x32_bf16 v[116:119], v[168:171], a[20:23], v[116:119]
    v_mfma_f32_16x16x32_bf16 v[120:123], v[172:175], a[16:19], v[120:123]
    v_mfma_f32_16x16x32_bf16 v[124:127], v[172:175], a[20:23], v[124:127]
    s_waitcnt vmcnt(0) lgkmcnt(0)
    v_mfma_f32_16x16x32_bf16 v[32:35], v[176:179], a[24:27], v[32:35]
    v_mfma_f32_16x16x32_bf16 v[36:39], v[176:179], a[28:31], v[36:39]
    v_mfma_f32_16x16x32_bf16 v[40:43], v[180:183], a[24:27], v[40:43]
    v_mfma_f32_16x16x32_bf16 v[44:47], v[180:183], a[28:31], v[44:47]
    v_mfma_f32_16x16x32_bf16 v[48:51], v[184:187], a[24:27], v[48:51]
    v_mfma_f32_16x16x32_bf16 v[52:55], v[184:187], a[28:31], v[52:55]
    v_mfma_f32_16x16x32_bf16 v[56:59], v[188:191], a[24:27], v[56:59]
    v_mfma_f32_16x16x32_bf16 v[60:63], v[188:191], a[28:31], v[60:63]
    v_mfma_f32_16x16x32_bf16 v[64:67], v[192:195], a[24:27], v[64:67]
    v_mfma_f32_16x16x32_bf16 v[68:71], v[192:195], a[28:31], v[68:71]
    v_mfma_f32_16x16x32_bf16 v[72:75], v[196:199], a[24:27], v[72:75]
    v_mfma_f32_16x16x32_bf16 v[76:79], v[196:199], a[28:31], v[76:79]
    v_mfma_f32_16x16x32_bf16 v[80:83], v[200:203], a[24:27], v[80:83]
    v_mfma_f32_16x16x32_bf16 v[84:87], v[200:203], a[28:31], v[84:87]
    v_mfma_f32_16x16x32_bf16 v[88:91], v[204:207], a[24:27], v[88:91]
    v_mfma_f32_16x16x32_bf16 v[92:95], v[204:207], a[28:31], v[92:95]
    v_mfma_f32_16x16x32_bf16 v[96:99], v[208:211], a[24:27], v[96:99]
    v_mfma_f32_16x16x32_bf16 v[100:103], v[208:211], a[28:31], v[100:103]
    v_mfma_f32_16x16x32_bf16 v[104:107], v[212:215], a[24:27], v[104:107]
    v_mfma_f32_16x16x32_bf16 v[108:111], v[212:215], a[28:31], v[108:111]
    v_mfma_f32_16x16x32_bf16 v[112:115], v[216:219], a[24:27], v[112:115]
    v_mfma_f32_16x16x32_bf16 v[116:119], v[216:219], a[28:31], v[116:119]
    v_mfma_f32_16x16x32_bf16 v[120:123], v[220:223], a[24:27], v[120:123]
    v_mfma_f32_16x16x32_bf16 v[124:127], v[220:223], a[28:31], v[124:127]
    s_barrier
    s_add_u32 m0, s69, 0
    s_nop 0
    buffer_load_dwordx4 v28, s[64:67], s68 offen lds
    s_add_u32 m0, s69, 1024
    s_nop 0
    buffer_load_dwordx4 v29, s[64:67], s68 offen lds
    s_add_u32 m0, s69, 2048
    s_nop 0
    buffer_load_dwordx4 v30, s[64:67], s68 offen lds
    s_add_u32 m0, s69, 3072
    s_nop 0
    buffer_load_dwordx4 v31, s[64:67], s68 offen lds
    s_add_u32 s68, s68, 131072
    s_add_u32 m0, s69, 32768
    s_nop 0
    buffer_load_dwordx4 v28, s[64:67], s68 offen lds
    s_add_u32 m0, s69, 33792
    s_nop 0
    buffer_load_dwordx4 v29, s[64:67], s68 offen lds
    s_add_u32 m0, s69, 34816
    s_nop 0
    buffer_load_dwordx4 v30, s[64:67], s68 offen lds
    s_add_u32 m0, s69, 35840
    s_nop 0
    buffer_load_dwordx4 v31, s[64:67], s68 offen lds
    s_add_u32 s68, s68, 131072
    s_add_u32 m0, s69, 65536
    s_nop 0
    buffer_load_dwordx4 v28, s[64:67], s68 offen lds
    s_add_u32 m0, s69, 66560
    s_nop 0
    buffer_load_dwordx4 v29, s[64:67], s68 offen lds
    s_add_u32 m0, s69, 67584
    s_nop 0
    buffer_load_dwordx4 v30, s[64:67], s68 offen lds
    s_add_u32 m0, s69, 68608
    s_nop 0
    buffer_load_dwordx4 v31, s[64:67], s68 offen lds
    s_add_u32 s8, s40, 12582912
    s_addc_u32 s9, s41, 0
    s_mov_b32 s10, 14680064
    s_mov_b32 s11, 0x20000
    v_lshrrev_b32 v2, 4, v1
    s_lshl_b32 s87, s3, 10
    s_add_u32 s87, s87, 131072
    v_lshlrev_b32 v3, 3, v2
    v_add_u32 v3, s87, v3
    ds_read_b64 v[8:9], v3 offset:0
    ds_read_b64 v[10:11], v3 offset:32
    ds_read_b64 v[12:13], v3 offset:64
    ds_read_b64 v[14:15], v3 offset:96
    ds_read_b64 v[16:17], v3 offset:128
    ds_read_b64 v[18:19], v3 offset:160
    ds_read_b64 v[20:21], v3 offset:192
    ds_read_b64 v[22:23], v3 offset:224
    ds_read_b64 v[24:25], v3 offset:256
    ds_read_b64 v[26:27], v3 offset:288
    ds_read_b64 v[216:217], v3 offset:320
    ds_read_b64 v[218:219], v3 offset:352
    s_mov_b32 s90, 0xbdd2d3e8
    v_mov_b32 v5, 0xc0135761
    v_and_b32 v3, 1, v2
    v_lshlrev_b32 v3, 1, v3
    v_lshrrev_b32 v4, 1, v2
    v_or_b32 v3, v3, v4
    v_lshlrev_b32 v3, 8, v3
    v_and_b32 v4, 15, v1
    v_lshl_add_u32 v4, v4, 4, v3
    s_lshl_b32 s86, s83, 4
    s_lshl_b32 s87, s3, 1
    s_add_u32 s86, s86, s87
    s_mul_i32 s86, s86, 114688
    s_lshl_b32 s87, s85, 5
    s_add_u32 s86, s86, s87
    s_mov_b32 s91, s90
    v_mov_b32 v2, v5
    v_mov_b32 v3, v5
    s_waitcnt lgkmcnt(0)
    v_lshlrev_b32 v128, 16, v8
    v_and_b32 v129, 0xffff0000, v8
    v_lshlrev_b32 v130, 16, v9
    v_and_b32 v131, 0xffff0000, v9
    v_lshlrev_b32 v132, 16, v10
    v_and_b32 v133, 0xffff0000, v10
    v_lshlrev_b32 v134, 16, v11
    v_and_b32 v135, 0xffff0000, v11
    v_cvt_pk_bf16_f32 v136, v32, v33
    v_cvt_pk_bf16_f32 v137, v34, v35
    v_cvt_pk_bf16_f32 v138, v40, v41
    v_cvt_pk_bf16_f32 v139, v42, v43
    v_cvt_pk_bf16_f32 v140, v36, v37
    v_cvt_pk_bf16_f32 v141, v38, v39
    v_cvt_pk_bf16_f32 v142, v44, v45
    v_cvt_pk_bf16_f32 v143, v46, v47
    v_lshlrev_b32 v144, 16, v136
    v_and_b32 v145, 0xffff0000, v136
    v_lshlrev_b32 v146, 16, v137
    v_and_b32 v147, 0xffff0000, v137
    v_lshlrev_b32 v148, 16, v138
    v_and_b32 v149, 0xffff0000, v138
    v_lshlrev_b32 v150, 16, v139
    v_and_b32 v151, 0xffff0000, v139
    v_lshlrev_b32 v152, 16, v140
    v_and_b32 v153, 0xffff0000, v140
    v_lshlrev_b32 v154, 16, v141
    v_and_b32 v155, 0xffff0000, v141
    v_lshlrev_b32 v156, 16, v142
    v_and_b32 v157, 0xffff0000, v142
    v_lshlrev_b32 v158, 16, v143
    v_and_b32 v159, 0xffff0000, v143
    v_pk_add_f32 v[144:145], v[144:145], v[128:129]
    v_pk_add_f32 v[146:147], v[146:147], v[130:131]
    v_pk_add_f32 v[148:149], v[148:149], v[132:133]
    v_pk_add_f32 v[150:151], v[150:151], v[134:135]
    v_pk_add_f32 v[152:153], v[152:153], v[128:129]
    v_pk_add_f32 v[154:155], v[154:155], v[130:131]
    v_pk_add_f32 v[156:157], v[156:157], v[132:133]
    v_pk_add_f32 v[158:159], v[158:159], v[134:135]
    v_cvt_pk_bf16_f32 v136, v144, v145
    v_cvt_pk_bf16_f32 v137, v146, v147
    v_cvt_pk_bf16_f32 v138, v148, v149
    v_cvt_pk_bf16_f32 v139, v150, v151
    v_cvt_pk_bf16_f32 v140, v152, v153
    v_cvt_pk_bf16_f32 v141, v154, v155
    v_cvt_pk_bf16_f32 v142, v156, v157
    v_cvt_pk_bf16_f32 v143, v158, v159
    v_lshlrev_b32 v144, 16, v136
    v_and_b32 v145, 0xffff0000, v136
    v_lshlrev_b32 v146, 16, v137
    v_and_b32 v147, 0xffff0000, v137
    v_lshlrev_b32 v148, 16, v138
    v_and_b32 v149, 0xffff0000, v138
    v_lshlrev_b32 v150, 16, v139
    v_and_b32 v151, 0xffff0000, v139
    v_lshlrev_b32 v152, 16, v140
    v_and_b32 v153, 0xffff0000, v140
    v_lshlrev_b32 v154, 16, v141
    v_and_b32 v155, 0xffff0000, v141
    v_lshlrev_b32 v156, 16, v142
    v_and_b32 v157, 0xffff0000, v142
    v_lshlrev_b32 v158, 16, v143
    v_and_b32 v159, 0xffff0000, v143
    v_pk_mul_f32 v[160:161], v[144:145], v[144:145]
    v_pk_mul_f32 v[162:163], v[146:147], v[146:147]
    v_pk_mul_f32 v[164:165], v[148:149], v[148:149]
    v_pk_mul_f32 v[166:167], v[150:151], v[150:151]
    v_pk_mul_f32 v[168:169], v[152:153], v[152:153]
    v_pk_mul_f32 v[170:171], v[154:155], v[154:155]
    v_pk_mul_f32 v[172:173], v[156:157], v[156:157]
    v_pk_mul_f32 v[174:175], v[158:159], v[158:159]
    v_pk_fma_f32 v[160:161], v[160:161], s[90:91], v[2:3]
    v_pk_fma_f32 v[162:163], v[162:163], s[90:91], v[2:3]
    v_pk_fma_f32 v[164:165], v[164:165], s[90:91], v[2:3]
    v_pk_fma_f32 v[166:167], v[166:167], s[90:91], v[2:3]
    v_pk_fma_f32 v[168:169], v[168:169], s[90:91], v[2:3]
    v_pk_fma_f32 v[170:171], v[170:171], s[90:91], v[2:3]
    v_pk_fma_f32 v[172:173], v[172:173], s[90:91], v[2:3]
    v_pk_fma_f32 v[174:175], v[174:175], s[90:91], v[2:3]
    v_pk_mul_f32 v[160:161], v[160:161], v[144:145]
    v_pk_mul_f32 v[162:163], v[162:163], v[146:147]
    v_pk_mul_f32 v[164:165], v[164:165], v[148:149]
    v_pk_mul_f32 v[166:167], v[166:167], v[150:151]
    v_pk_mul_f32 v[168:169], v[168:169], v[152:153]
    v_pk_mul_f32 v[170:171], v[170:171], v[154:155]
    v_pk_mul_f32 v[172:173], v[172:173], v[156:157]
    v_pk_mul_f32 v[174:175], v[174:175], v[158:159]
    v_exp_f32 v160, v160
    v_exp_f32 v161, v161
    v_exp_f32 v162, v162
    v_exp_f32 v163, v163
    v_exp_f32 v164, v164
    v_exp_f32 v165, v165
    v_exp_f32 v166, v166
    v_exp_f32 v167, v167
    v_exp_f32 v168, v168
    v_exp_f32 v169, v169
    v_exp_f32 v170, v170
    v_exp_f32 v171, v171
    v_exp_f32 v172, v172
    v_exp_f32 v173, v173
    v_exp_f32 v174, v174
    v_exp_f32 v175, v175
    v_pk_add_f32 v[160:161], v[160:161], 1.0 op_sel_hi:[1,0]
    v_pk_add_f32 v[162:163], v[162:163], 1.0 op_sel_hi:[1,0]
    v_pk_add_f32 v[164:165], v[164:165], 1.0 op_sel_hi:[1,0]
    v_pk_add_f32 v[166:167], v[166:167], 1.0 op_sel_hi:[1,0]
    v_pk_add_f32 v[168:169], v[168:169], 1.0 op_sel_hi:[1,0]
    v_pk_add_f32 v[170:171], v[170:171], 1.0 op_sel_hi:[1,0]
    v_pk_add_f32 v[172:173], v[172:173], 1.0 op_sel_hi:[1,0]
    v_pk_add_f32 v[174:175], v[174:175], 1.0 op_sel_hi:[1,0]
    v_rcp_f32 v160, v160
    v_rcp_f32 v161, v161
    v_rcp_f32 v162, v162
    v_rcp_f32 v163, v163
    v_rcp_f32 v164, v164
    v_rcp_f32 v165, v165
    v_rcp_f32 v166, v166
    v_rcp_f32 v167, v167
    v_rcp_f32 v168, v168
    v_rcp_f32 v169, v169
    v_rcp_f32 v170, v170
    v_rcp_f32 v171, v171
    v_rcp_f32 v172, v172
    v_rcp_f32 v173, v173
    v_rcp_f32 v174, v174
    v_rcp_f32 v175, v175
    v_pk_mul_f32 v[160:161], v[160:161], v[144:145]
    v_pk_mul_f32 v[162:163], v[162:163], v[146:147]
    v_pk_mul_f32 v[164:165], v[164:165], v[148:149]
    v_pk_mul_f32 v[166:167], v[166:167], v[150:151]
    v_pk_mul_f32 v[168:169], v[168:169], v[152:153]
    v_pk_mul_f32 v[170:171], v[170:171], v[154:155]
    v_pk_mul_f32 v[172:173], v[172:173], v[156:157]
    v_pk_mul_f32 v[174:175], v[174:175], v[158:159]
    v_cvt_pk_bf16_f32 v136, v160, v161
    v_cvt_pk_bf16_f32 v137, v162, v163
    v_cvt_pk_bf16_f32 v138, v164, v165
    v_cvt_pk_bf16_f32 v139, v166, v167
    v_cvt_pk_bf16_f32 v140, v168, v169
    v_cvt_pk_bf16_f32 v141, v170, v171
    v_cvt_pk_bf16_f32 v142, v172, v173
    v_cvt_pk_bf16_f32 v143, v174, v175
    s_add_u32 s87, s86, 0
    s_nop 0
    v_permlane16_swap_b32 v136, v138
    v_permlane16_swap_b32 v137, v139
    buffer_store_dwordx4 v[136:139], v4, s[8:11], s87 offen sc1
    s_add_u32 s87, s86, 114688
    v_permlane16_swap_b32 v140, v142
    v_permlane16_swap_b32 v141, v143
    buffer_store_dwordx4 v[140:143], v4, s[8:11], s87 offen sc1
    v_lshlrev_b32 v128, 16, v12
    v_and_b32 v129, 0xffff0000, v12
    v_lshlrev_b32 v130, 16, v13
    v_and_b32 v131, 0xffff0000, v13
    v_lshlrev_b32 v132, 16, v14
    v_and_b32 v133, 0xffff0000, v14
    v_lshlrev_b32 v134, 16, v15
    v_and_b32 v135, 0xffff0000, v15
    v_cvt_pk_bf16_f32 v176, v48, v49
    v_cvt_pk_bf16_f32 v177, v50, v51
    v_cvt_pk_bf16_f32 v178, v56, v57
    v_cvt_pk_bf16_f32 v179, v58, v59
    v_cvt_pk_bf16_f32 v180, v52, v53
    v_cvt_pk_bf16_f32 v181, v54, v55
    v_cvt_pk_bf16_f32 v182, v60, v61
    v_cvt_pk_bf16_f32 v183, v62, v63
    v_lshlrev_b32 v184, 16, v176
    v_and_b32 v185, 0xffff0000, v176
    v_lshlrev_b32 v186, 16, v177
    v_and_b32 v187, 0xffff0000, v177
    v_lshlrev_b32 v188, 16, v178
    v_and_b32 v189, 0xffff0000, v178
    v_lshlrev_b32 v190, 16, v179
    v_and_b32 v191, 0xffff0000, v179
    v_lshlrev_b32 v192, 16, v180
    v_and_b32 v193, 0xffff0000, v180
    v_lshlrev_b32 v194, 16, v181
    v_and_b32 v195, 0xffff0000, v181
    v_lshlrev_b32 v196, 16, v182
    v_and_b32 v197, 0xffff0000, v182
    v_lshlrev_b32 v198, 16, v183
    v_and_b32 v199, 0xffff0000, v183
    v_pk_add_f32 v[184:185], v[184:185], v[128:129]
    v_pk_add_f32 v[186:187], v[186:187], v[130:131]
    v_pk_add_f32 v[188:189], v[188:189], v[132:133]
    v_pk_add_f32 v[190:191], v[190:191], v[134:135]
    v_pk_add_f32 v[192:193], v[192:193], v[128:129]
    v_pk_add_f32 v[194:195], v[194:195], v[130:131]
    v_pk_add_f32 v[196:197], v[196:197], v[132:133]
    v_pk_add_f32 v[198:199], v[198:199], v[134:135]
    v_cvt_pk_bf16_f32 v176, v184, v185
    v_cvt_pk_bf16_f32 v177, v186, v187
    v_cvt_pk_bf16_f32 v178, v188, v189
    v_cvt_pk_bf16_f32 v179, v190, v191
    v_cvt_pk_bf16_f32 v180, v192, v193
    v_cvt_pk_bf16_f32 v181, v194, v195
    v_cvt_pk_bf16_f32 v182, v196, v197
    v_cvt_pk_bf16_f32 v183, v198, v199
    v_lshlrev_b32 v184, 16, v176
    v_and_b32 v185, 0xffff0000, v176
    v_lshlrev_b32 v186, 16, v177
    v_and_b32 v187, 0xffff0000, v177
    v_lshlrev_b32 v188, 16, v178
    v_and_b32 v189, 0xffff0000, v178
    v_lshlrev_b32 v190, 16, v179
    v_and_b32 v191, 0xffff0000, v179
    v_lshlrev_b32 v192, 16, v180
    v_and_b32 v193, 0xffff0000, v180
    v_lshlrev_b32 v194, 16, v181
    v_and_b32 v195, 0xffff0000, v181
    v_lshlrev_b32 v196, 16, v182
    v_and_b32 v197, 0xffff0000, v182
    v_lshlrev_b32 v198, 16, v183
    v_and_b32 v199, 0xffff0000, v183
    v_pk_mul_f32 v[200:201], v[184:185], v[184:185]
    v_pk_mul_f32 v[202:203], v[186:187], v[186:187]
    v_pk_mul_f32 v[204:205], v[188:189], v[188:189]
    v_pk_mul_f32 v[206:207], v[190:191], v[190:191]
    v_pk_mul_f32 v[208:209], v[192:193], v[192:193]
    v_pk_mul_f32 v[210:211], v[194:195], v[194:195]
    v_pk_mul_f32 v[212:213], v[196:197], v[196:197]
    v_pk_mul_f32 v[214:215], v[198:199], v[198:199]
    v_pk_fma_f32 v[200:201], v[200:201], s[90:91], v[2:3]
    v_pk_fma_f32 v[202:203], v[202:203], s[90:91], v[2:3]
    v_pk_fma_f32 v[204:205], v[204:205], s[90:91], v[2:3]
    v_pk_fma_f32 v[206:207], v[206:207], s[90:91], v[2:3]
    v_pk_fma_f32 v[208:209], v[208:209], s[90:91], v[2:3]
    v_pk_fma_f32 v[210:211], v[210:211], s[90:91], v[2:3]
    v_pk_fma_f32 v[212:213], v[212:213], s[90:91], v[2:3]
    v_pk_fma_f32 v[214:215], v[214:215], s[90:91], v[2:3]
    v_pk_mul_f32 v[200:201], v[200:201], v[184:185]
    v_pk_mul_f32 v[202:203], v[202:203], v[186:187]
    v_pk_mul_f32 v[204:205], v[204:205], v[188:189]
    v_pk_mul_f32 v[206:207], v[206:207], v[190:191]
    v_pk_mul_f32 v[208:209], v[208:209], v[192:193]
    v_pk_mul_f32 v[210:211], v[210:211], v[194:195]
    v_pk_mul_f32 v[212:213], v[212:213], v[196:197]
    v_pk_mul_f32 v[214:215], v[214:215], v[198:199]
    v_exp_f32 v200, v200
    v_exp_f32 v201, v201
    v_exp_f32 v202, v202
    v_exp_f32 v203, v203
    v_exp_f32 v204, v204
    v_exp_f32 v205, v205
    v_exp_f32 v206, v206
    v_exp_f32 v207, v207
    v_exp_f32 v208, v208
    v_exp_f32 v209, v209
    v_exp_f32 v210, v210
    v_exp_f32 v211, v211
    v_exp_f32 v212, v212
    v_exp_f32 v213, v213
    v_exp_f32 v214, v214
    v_exp_f32 v215, v215
    v_pk_add_f32 v[200:201], v[200:201], 1.0 op_sel_hi:[1,0]
    v_pk_add_f32 v[202:203], v[202:203], 1.0 op_sel_hi:[1,0]
    v_pk_add_f32 v[204:205], v[204:205], 1.0 op_sel_hi:[1,0]
    v_pk_add_f32 v[206:207], v[206:207], 1.0 op_sel_hi:[1,0]
    v_pk_add_f32 v[208:209], v[208:209], 1.0 op_sel_hi:[1,0]
    v_pk_add_f32 v[210:211], v[210:211], 1.0 op_sel_hi:[1,0]
    v_pk_add_f32 v[212:213], v[212:213], 1.0 op_sel_hi:[1,0]
    v_pk_add_f32 v[214:215], v[214:215], 1.0 op_sel_hi:[1,0]
    v_rcp_f32 v200, v200
    v_rcp_f32 v201, v201
    v_rcp_f32 v202, v202
    v_rcp_f32 v203, v203
    v_rcp_f32 v204, v204
    v_rcp_f32 v205, v205
    v_rcp_f32 v206, v206
    v_rcp_f32 v207, v207
    v_rcp_f32 v208, v208
    v_rcp_f32 v209, v209
    v_rcp_f32 v210, v210
    v_rcp_f32 v211, v211
    v_rcp_f32 v212, v212
    v_rcp_f32 v213, v213
    v_rcp_f32 v214, v214
    v_rcp_f32 v215, v215
    v_pk_mul_f32 v[200:201], v[200:201], v[184:185]
    v_pk_mul_f32 v[202:203], v[202:203], v[186:187]
    v_pk_mul_f32 v[204:205], v[204:205], v[188:189]
    v_pk_mul_f32 v[206:207], v[206:207], v[190:191]
    v_pk_mul_f32 v[208:209], v[208:209], v[192:193]
    v_pk_mul_f32 v[210:211], v[210:211], v[194:195]
    v_pk_mul_f32 v[212:213], v[212:213], v[196:197]
    v_pk_mul_f32 v[214:215], v[214:215], v[198:199]
    v_cvt_pk_bf16_f32 v176, v200, v201
    v_cvt_pk_bf16_f32 v177, v202, v203
    v_cvt_pk_bf16_f32 v178, v204, v205
    v_cvt_pk_bf16_f32 v179, v206, v207
    v_cvt_pk_bf16_f32 v180, v208, v209
    v_cvt_pk_bf16_f32 v181, v210, v211
    v_cvt_pk_bf16_f32 v182, v212, v213
    v_cvt_pk_bf16_f32 v183, v214, v215
    s_add_u32 s87, s86, 1024
    s_nop 0
    v_permlane16_swap_b32 v176, v178
    v_permlane16_swap_b32 v177, v179
    buffer_store_dwordx4 v[176:179], v4, s[8:11], s87 offen sc1
    s_add_u32 s87, s86, 115712
    v_permlane16_swap_b32 v180, v182
    v_permlane16_swap_b32 v181, v183
    buffer_store_dwordx4 v[180:183], v4, s[8:11], s87 offen sc1
    v_lshlrev_b32 v128, 16, v16
    v_and_b32 v129, 0xffff0000, v16
    v_lshlrev_b32 v130, 16, v17
    v_and_b32 v131, 0xffff0000, v17
    v_lshlrev_b32 v132, 16, v18
    v_and_b32 v133, 0xffff0000, v18
    v_lshlrev_b32 v134, 16, v19
    v_and_b32 v135, 0xffff0000, v19
    v_cvt_pk_bf16_f32 v136, v64, v65
    v_cvt_pk_bf16_f32 v137, v66, v67
    v_cvt_pk_bf16_f32 v138, v72, v73
    v_cvt_pk_bf16_f32 v139, v74, v75
    v_cvt_pk_bf16_f32 v140, v68, v69
    v_cvt_pk_bf16_f32 v141, v70, v71
    v_cvt_pk_bf16_f32 v142, v76, v77
    v_cvt_pk_bf16_f32 v143, v78, v79
    v_lshlrev_b32 v144, 16, v136
    v_and_b32 v145, 0xffff0000, v136
    v_lshlrev_b32 v146, 16, v137
    v_and_b32 v147, 0xffff0000, v137
    v_lshlrev_b32 v148, 16, v138
    v_and_b32 v149, 0xffff0000, v138
    v_lshlrev_b32 v150, 16, v139
    v_and_b32 v151, 0xffff0000, v139
    v_lshlrev_b32 v152, 16, v140
    v_and_b32 v153, 0xffff0000, v140
    v_lshlrev_b32 v154, 16, v141
    v_and_b32 v155, 0xffff0000, v141
    v_lshlrev_b32 v156, 16, v142
    v_and_b32 v157, 0xffff0000, v142
    v_lshlrev_b32 v158, 16, v143
    v_and_b32 v159, 0xffff0000, v143
    v_pk_add_f32 v[144:145], v[144:145], v[128:129]
    v_pk_add_f32 v[146:147], v[146:147], v[130:131]
    v_pk_add_f32 v[148:149], v[148:149], v[132:133]
    v_pk_add_f32 v[150:151], v[150:151], v[134:135]
    v_pk_add_f32 v[152:153], v[152:153], v[128:129]
    v_pk_add_f32 v[154:155], v[154:155], v[130:131]
    v_pk_add_f32 v[156:157], v[156:157], v[132:133]
    v_pk_add_f32 v[158:159], v[158:159], v[134:135]
    v_cvt_pk_bf16_f32 v136, v144, v145
    v_cvt_pk_bf16_f32 v137, v146, v147
    v_cvt_pk_bf16_f32 v138, v148, v149
    v_cvt_pk_bf16_f32 v139, v150, v151
    v_cvt_pk_bf16_f32 v140, v152, v153
    v_cvt_pk_bf16_f32 v141, v154, v155
    v_cvt_pk_bf16_f32 v142, v156, v157
    v_cvt_pk_bf16_f32 v143, v158, v159
    v_lshlrev_b32 v144, 16, v136
    v_and_b32 v145, 0xffff0000, v136
    v_lshlrev_b32 v146, 16, v137
    v_and_b32 v147, 0xffff0000, v137
    v_lshlrev_b32 v148, 16, v138
    v_and_b32 v149, 0xffff0000, v138
    v_lshlrev_b32 v150, 16, v139
    v_and_b32 v151, 0xffff0000, v139
    v_lshlrev_b32 v152, 16, v140
    v_and_b32 v153, 0xffff0000, v140
    v_lshlrev_b32 v154, 16, v141
    v_and_b32 v155, 0xffff0000, v141
    v_lshlrev_b32 v156, 16, v142
    v_and_b32 v157, 0xffff0000, v142
    v_lshlrev_b32 v158, 16, v143
    v_and_b32 v159, 0xffff0000, v143
    v_pk_mul_f32 v[160:161], v[144:145], v[144:145]
    v_pk_mul_f32 v[162:163], v[146:147], v[146:147]
    v_pk_mul_f32 v[164:165], v[148:149], v[148:149]
    v_pk_mul_f32 v[166:167], v[150:151], v[150:151]
    v_pk_mul_f32 v[168:169], v[152:153], v[152:153]
    v_pk_mul_f32 v[170:171], v[154:155], v[154:155]
    v_pk_mul_f32 v[172:173], v[156:157], v[156:157]
    v_pk_mul_f32 v[174:175], v[158:159], v[158:159]
    v_pk_fma_f32 v[160:161], v[160:161], s[90:91], v[2:3]
    v_pk_fma_f32 v[162:163], v[162:163], s[90:91], v[2:3]
    v_pk_fma_f32 v[164:165], v[164:165], s[90:91], v[2:3]
    v_pk_fma_f32 v[166:167], v[166:167], s[90:91], v[2:3]
    v_pk_fma_f32 v[168:169], v[168:169], s[90:91], v[2:3]
    v_pk_fma_f32 v[170:171], v[170:171], s[90:91], v[2:3]
    v_pk_fma_f32 v[172:173], v[172:173], s[90:91], v[2:3]
    v_pk_fma_f32 v[174:175], v[174:175], s[90:91], v[2:3]
    v_pk_mul_f32 v[160:161], v[160:161], v[144:145]
    v_pk_mul_f32 v[162:163], v[162:163], v[146:147]
    v_pk_mul_f32 v[164:165], v[164:165], v[148:149]
    v_pk_mul_f32 v[166:167], v[166:167], v[150:151]
    v_pk_mul_f32 v[168:169], v[168:169], v[152:153]
    v_pk_mul_f32 v[170:171], v[170:171], v[154:155]
    v_pk_mul_f32 v[172:173], v[172:173], v[156:157]
    v_pk_mul_f32 v[174:175], v[174:175], v[158:159]
    v_exp_f32 v160, v160
    v_exp_f32 v161, v161
    v_exp_f32 v162, v162
    v_exp_f32 v163, v163
    v_exp_f32 v164, v164
    v_exp_f32 v165, v165
    v_exp_f32 v166, v166
    v_exp_f32 v167, v167
    v_exp_f32 v168, v168
    v_exp_f32 v169, v169
    v_exp_f32 v170, v170
    v_exp_f32 v171, v171
    v_exp_f32 v172, v172
    v_exp_f32 v173, v173
    v_exp_f32 v174, v174
    v_exp_f32 v175, v175
    v_pk_add_f32 v[160:161], v[160:161], 1.0 op_sel_hi:[1,0]
    v_pk_add_f32 v[162:163], v[162:163], 1.0 op_sel_hi:[1,0]
    v_pk_add_f32 v[164:165], v[164:165], 1.0 op_sel_hi:[1,0]
    v_pk_add_f32 v[166:167], v[166:167], 1.0 op_sel_hi:[1,0]
    v_pk_add_f32 v[168:169], v[168:169], 1.0 op_sel_hi:[1,0]
    v_pk_add_f32 v[170:171], v[170:171], 1.0 op_sel_hi:[1,0]
    v_pk_add_f32 v[172:173], v[172:173], 1.0 op_sel_hi:[1,0]
    v_pk_add_f32 v[174:175], v[174:175], 1.0 op_sel_hi:[1,0]
    v_rcp_f32 v160, v160
    v_rcp_f32 v161, v161
    v_rcp_f32 v162, v162
    v_rcp_f32 v163, v163
    v_rcp_f32 v164, v164
    v_rcp_f32 v165, v165
    v_rcp_f32 v166, v166
    v_rcp_f32 v167, v167
    v_rcp_f32 v168, v168
    v_rcp_f32 v169, v169
    v_rcp_f32 v170, v170
    v_rcp_f32 v171, v171
    v_rcp_f32 v172, v172
    v_rcp_f32 v173, v173
    v_rcp_f32 v174, v174
    v_rcp_f32 v175, v175
    v_pk_mul_f32 v[160:161], v[160:161], v[144:145]
    v_pk_mul_f32 v[162:163], v[162:163], v[146:147]
    v_pk_mul_f32 v[164:165], v[164:165], v[148:149]
    v_pk_mul_f32 v[166:167], v[166:167], v[150:151]
    v_pk_mul_f32 v[168:169], v[168:169], v[152:153]
    v_pk_mul_f32 v[170:171], v[170:171], v[154:155]
    v_pk_mul_f32 v[172:173], v[172:173], v[156:157]
    v_pk_mul_f32 v[174:175], v[174:175], v[158:159]
    v_cvt_pk_bf16_f32 v136, v160, v161
    v_cvt_pk_bf16_f32 v137, v162, v163
    v_cvt_pk_bf16_f32 v138, v164, v165
    v_cvt_pk_bf16_f32 v139, v166, v167
    v_cvt_pk_bf16_f32 v140, v168, v169
    v_cvt_pk_bf16_f32 v141, v170, v171
    v_cvt_pk_bf16_f32 v142, v172, v173
    v_cvt_pk_bf16_f32 v143, v174, v175
    s_add_u32 s87, s86, 2048
    s_nop 0
    v_permlane16_swap_b32 v136, v138
    v_permlane16_swap_b32 v137, v139
    buffer_store_dwordx4 v[136:139], v4, s[8:11], s87 offen sc1
    s_add_u32 s87, s86, 116736
    v_permlane16_swap_b32 v140, v142
    v_permlane16_swap_b32 v141, v143
    buffer_store_dwordx4 v[140:143], v4, s[8:11], s87 offen sc1
    v_lshlrev_b32 v128, 16, v20
    v_and_b32 v129, 0xffff0000, v20
    v_lshlrev_b32 v130, 16, v21
    v_and_b32 v131, 0xffff0000, v21
    v_lshlrev_b32 v132, 16, v22
    v_and_b32 v133, 0xffff0000, v22
    v_lshlrev_b32 v134, 16, v23
    v_and_b32 v135, 0xffff0000, v23
    v_cvt_pk_bf16_f32 v176, v80, v81
    v_cvt_pk_bf16_f32 v177, v82, v83
    v_cvt_pk_bf16_f32 v178, v88, v89
    v_cvt_pk_bf16_f32 v179, v90, v91
    v_cvt_pk_bf16_f32 v180, v84, v85
    v_cvt_pk_bf16_f32 v181, v86, v87
    v_cvt_pk_bf16_f32 v182, v92, v93
    v_cvt_pk_bf16_f32 v183, v94, v95
    v_lshlrev_b32 v184, 16, v176
    v_and_b32 v185, 0xffff0000, v176
    v_lshlrev_b32 v186, 16, v177
    v_and_b32 v187, 0xffff0000, v177
    v_lshlrev_b32 v188, 16, v178
    v_and_b32 v189, 0xffff0000, v178
    v_lshlrev_b32 v190, 16, v179
    v_and_b32 v191, 0xffff0000, v179
    v_lshlrev_b32 v192, 16, v180
    v_and_b32 v193, 0xffff0000, v180
    v_lshlrev_b32 v194, 16, v181
    v_and_b32 v195, 0xffff0000, v181
    v_lshlrev_b32 v196, 16, v182
    v_and_b32 v197, 0xffff0000, v182
    v_lshlrev_b32 v198, 16, v183
    v_and_b32 v199, 0xffff0000, v183
    v_pk_add_f32 v[184:185], v[184:185], v[128:129]
    v_pk_add_f32 v[186:187], v[186:187], v[130:131]
    v_pk_add_f32 v[188:189], v[188:189], v[132:133]
    v_pk_add_f32 v[190:191], v[190:191], v[134:135]
    v_pk_add_f32 v[192:193], v[192:193], v[128:129]
    v_pk_add_f32 v[194:195], v[194:195], v[130:131]
    v_pk_add_f32 v[196:197], v[196:197], v[132:133]
    v_pk_add_f32 v[198:199], v[198:199], v[134:135]
    v_cvt_pk_bf16_f32 v176, v184, v185
    v_cvt_pk_bf16_f32 v177, v186, v187
    v_cvt_pk_bf16_f32 v178, v188, v189
    v_cvt_pk_bf16_f32 v179, v190, v191
    v_cvt_pk_bf16_f32 v180, v192, v193
    v_cvt_pk_bf16_f32 v181, v194, v195
    v_cvt_pk_bf16_f32 v182, v196, v197
    v_cvt_pk_bf16_f32 v183, v198, v199
    v_lshlrev_b32 v184, 16, v176
    v_and_b32 v185, 0xffff0000, v176
    v_lshlrev_b32 v186, 16, v177
    v_and_b32 v187, 0xffff0000, v177
    v_lshlrev_b32 v188, 16, v178
    v_and_b32 v189, 0xffff0000, v178
    v_lshlrev_b32 v190, 16, v179
    v_and_b32 v191, 0xffff0000, v179
    v_lshlrev_b32 v192, 16, v180
    v_and_b32 v193, 0xffff0000, v180
    v_lshlrev_b32 v194, 16, v181
    v_and_b32 v195, 0xffff0000, v181
    v_lshlrev_b32 v196, 16, v182
    v_and_b32 v197, 0xffff0000, v182
    v_lshlrev_b32 v198, 16, v183
    v_and_b32 v199, 0xffff0000, v183
    v_pk_mul_f32 v[200:201], v[184:185], v[184:185]
    v_pk_mul_f32 v[202:203], v[186:187], v[186:187]
    v_pk_mul_f32 v[204:205], v[188:189], v[188:189]
    v_pk_mul_f32 v[206:207], v[190:191], v[190:191]
    v_pk_mul_f32 v[208:209], v[192:193], v[192:193]
    v_pk_mul_f32 v[210:211], v[194:195], v[194:195]
    v_pk_mul_f32 v[212:213], v[196:197], v[196:197]
    v_pk_mul_f32 v[214:215], v[198:199], v[198:199]
    v_pk_fma_f32 v[200:201], v[200:201], s[90:91], v[2:3]
    v_pk_fma_f32 v[202:203], v[202:203], s[90:91], v[2:3]
    v_pk_fma_f32 v[204:205], v[204:205], s[90:91], v[2:3]
    v_pk_fma_f32 v[206:207], v[206:207], s[90:91], v[2:3]
    v_pk_fma_f32 v[208:209], v[208:209], s[90:91], v[2:3]
    v_pk_fma_f32 v[210:211], v[210:211], s[90:91], v[2:3]
    v_pk_fma_f32 v[212:213], v[212:213], s[90:91], v[2:3]
    v_pk_fma_f32 v[214:215], v[214:215], s[90:91], v[2:3]
    v_pk_mul_f32 v[200:201], v[200:201], v[184:185]
    v_pk_mul_f32 v[202:203], v[202:203], v[186:187]
    v_pk_mul_f32 v[204:205], v[204:205], v[188:189]
    v_pk_mul_f32 v[206:207], v[206:207], v[190:191]
    v_pk_mul_f32 v[208:209], v[208:209], v[192:193]
    v_pk_mul_f32 v[210:211], v[210:211], v[194:195]
    v_pk_mul_f32 v[212:213], v[212:213], v[196:197]
    v_pk_mul_f32 v[214:215], v[214:215], v[198:199]
    v_exp_f32 v200, v200
    v_exp_f32 v201, v201
    v_exp_f32 v202, v202
    v_exp_f32 v203, v203
    v_exp_f32 v204, v204
    v_exp_f32 v205, v205
    v_exp_f32 v206, v206
    v_exp_f32 v207, v207
    v_exp_f32 v208, v208
    v_exp_f32 v209, v209
    v_exp_f32 v210, v210
    v_exp_f32 v211, v211
    v_exp_f32 v212, v212
    v_exp_f32 v213, v213
    v_exp_f32 v214, v214
    v_exp_f32 v215, v215
    v_pk_add_f32 v[200:201], v[200:201], 1.0 op_sel_hi:[1,0]
    v_pk_add_f32 v[202:203], v[202:203], 1.0 op_sel_hi:[1,0]
    v_pk_add_f32 v[204:205], v[204:205], 1.0 op_sel_hi:[1,0]
    v_pk_add_f32 v[206:207], v[206:207], 1.0 op_sel_hi:[1,0]
    v_pk_add_f32 v[208:209], v[208:209], 1.0 op_sel_hi:[1,0]
    v_pk_add_f32 v[210:211], v[210:211], 1.0 op_sel_hi:[1,0]
    v_pk_add_f32 v[212:213], v[212:213], 1.0 op_sel_hi:[1,0]
    v_pk_add_f32 v[214:215], v[214:215], 1.0 op_sel_hi:[1,0]
    v_rcp_f32 v200, v200
    v_rcp_f32 v201, v201
    v_rcp_f32 v202, v202
    v_rcp_f32 v203, v203
    v_rcp_f32 v204, v204
    v_rcp_f32 v205, v205
    v_rcp_f32 v206, v206
    v_rcp_f32 v207, v207
    v_rcp_f32 v208, v208
    v_rcp_f32 v209, v209
    v_rcp_f32 v210, v210
    v_rcp_f32 v211, v211
    v_rcp_f32 v212, v212
    v_rcp_f32 v213, v213
    v_rcp_f32 v214, v214
    v_rcp_f32 v215, v215
    v_pk_mul_f32 v[200:201], v[200:201], v[184:185]
    v_pk_mul_f32 v[202:203], v[202:203], v[186:187]
    v_pk_mul_f32 v[204:205], v[204:205], v[188:189]
    v_pk_mul_f32 v[206:207], v[206:207], v[190:191]
    v_pk_mul_f32 v[208:209], v[208:209], v[192:193]
    v_pk_mul_f32 v[210:211], v[210:211], v[194:195]
    v_pk_mul_f32 v[212:213], v[212:213], v[196:197]
    v_pk_mul_f32 v[214:215], v[214:215], v[198:199]
    v_cvt_pk_bf16_f32 v176, v200, v201
    v_cvt_pk_bf16_f32 v177, v202, v203
    v_cvt_pk_bf16_f32 v178, v204, v205
    v_cvt_pk_bf16_f32 v179, v206, v207
    v_cvt_pk_bf16_f32 v180, v208, v209
    v_cvt_pk_bf16_f32 v181, v210, v211
    v_cvt_pk_bf16_f32 v182, v212, v213
    v_cvt_pk_bf16_f32 v183, v214, v215
    s_add_u32 s87, s86, 3072
    s_nop 0
    v_permlane16_swap_b32 v176, v178
    v_permlane16_swap_b32 v177, v179
    buffer_store_dwordx4 v[176:179], v4, s[8:11], s87 offen sc1
    s_add_u32 s87, s86, 117760
    v_permlane16_swap_b32 v180, v182
    v_permlane16_swap_b32 v181, v183
    buffer_store_dwordx4 v[180:183], v4, s[8:11], s87 offen sc1
    v_lshlrev_b32 v128, 16, v24
    v_and_b32 v129, 0xffff0000, v24
    v_lshlrev_b32 v130, 16, v25
    v_and_b32 v131, 0xffff0000, v25
    v_lshlrev_b32 v132, 16, v26
    v_and_b32 v133, 0xffff0000, v26
    v_lshlrev_b32 v134, 16, v27
    v_and_b32 v135, 0xffff0000, v27
    v_cvt_pk_bf16_f32 v136, v96, v97
    v_cvt_pk_bf16_f32 v137, v98, v99
    v_cvt_pk_bf16_f32 v138, v104, v105
    v_cvt_pk_bf16_f32 v139, v106, v107
    v_cvt_pk_bf16_f32 v140, v100, v101
    v_cvt_pk_bf16_f32 v141, v102, v103
    v_cvt_pk_bf16_f32 v142, v108, v109
    v_cvt_pk_bf16_f32 v143, v110, v111
    v_lshlrev_b32 v144, 16, v136
    v_and_b32 v145, 0xffff0000, v136
    v_lshlrev_b32 v146, 16, v137
    v_and_b32 v147, 0xffff0000, v137
    v_lshlrev_b32 v148, 16, v138
    v_and_b32 v149, 0xffff0000, v138
    v_lshlrev_b32 v150, 16, v139
    v_and_b32 v151, 0xffff0000, v139
    v_lshlrev_b32 v152, 16, v140
    v_and_b32 v153, 0xffff0000, v140
    v_lshlrev_b32 v154, 16, v141
    v_and_b32 v155, 0xffff0000, v141
    v_lshlrev_b32 v156, 16, v142
    v_and_b32 v157, 0xffff0000, v142
    v_lshlrev_b32 v158, 16, v143
    v_and_b32 v159, 0xffff0000, v143
    v_pk_add_f32 v[144:145], v[144:145], v[128:129]
    v_pk_add_f32 v[146:147], v[146:147], v[130:131]
    v_pk_add_f32 v[148:149], v[148:149], v[132:133]
    v_pk_add_f32 v[150:151], v[150:151], v[134:135]
    v_pk_add_f32 v[152:153], v[152:153], v[128:129]
    v_pk_add_f32 v[154:155], v[154:155], v[130:131]
    v_pk_add_f32 v[156:157], v[156:157], v[132:133]
    v_pk_add_f32 v[158:159], v[158:159], v[134:135]
    v_cvt_pk_bf16_f32 v136, v144, v145
    v_cvt_pk_bf16_f32 v137, v146, v147
    v_cvt_pk_bf16_f32 v138, v148, v149
    v_cvt_pk_bf16_f32 v139, v150, v151
    v_cvt_pk_bf16_f32 v140, v152, v153
    v_cvt_pk_bf16_f32 v141, v154, v155
    v_cvt_pk_bf16_f32 v142, v156, v157
    v_cvt_pk_bf16_f32 v143, v158, v159
    v_lshlrev_b32 v144, 16, v136
    v_and_b32 v145, 0xffff0000, v136
    v_lshlrev_b32 v146, 16, v137
    v_and_b32 v147, 0xffff0000, v137
    v_lshlrev_b32 v148, 16, v138
    v_and_b32 v149, 0xffff0000, v138
    v_lshlrev_b32 v150, 16, v139
    v_and_b32 v151, 0xffff0000, v139
    v_lshlrev_b32 v152, 16, v140
    v_and_b32 v153, 0xffff0000, v140
    v_lshlrev_b32 v154, 16, v141
    v_and_b32 v155, 0xffff0000, v141
    v_lshlrev_b32 v156, 16, v142
    v_and_b32 v157, 0xffff0000, v142
    v_lshlrev_b32 v158, 16, v143
    v_and_b32 v159, 0xffff0000, v143
    v_pk_mul_f32 v[160:161], v[144:145], v[144:145]
    v_pk_mul_f32 v[162:163], v[146:147], v[146:147]
    v_pk_mul_f32 v[164:165], v[148:149], v[148:149]
    v_pk_mul_f32 v[166:167], v[150:151], v[150:151]
    v_pk_mul_f32 v[168:169], v[152:153], v[152:153]
    v_pk_mul_f32 v[170:171], v[154:155], v[154:155]
    v_pk_mul_f32 v[172:173], v[156:157], v[156:157]
    v_pk_mul_f32 v[174:175], v[158:159], v[158:159]
    v_pk_fma_f32 v[160:161], v[160:161], s[90:91], v[2:3]
    v_pk_fma_f32 v[162:163], v[162:163], s[90:91], v[2:3]
    v_pk_fma_f32 v[164:165], v[164:165], s[90:91], v[2:3]
    v_pk_fma_f32 v[166:167], v[166:167], s[90:91], v[2:3]
    v_pk_fma_f32 v[168:169], v[168:169], s[90:91], v[2:3]
    v_pk_fma_f32 v[170:171], v[170:171], s[90:91], v[2:3]
    v_pk_fma_f32 v[172:173], v[172:173], s[90:91], v[2:3]
    v_pk_fma_f32 v[174:175], v[174:175], s[90:91], v[2:3]
    v_pk_mul_f32 v[160:161], v[160:161], v[144:145]
    v_pk_mul_f32 v[162:163], v[162:163], v[146:147]
    v_pk_mul_f32 v[164:165], v[164:165], v[148:149]
    v_pk_mul_f32 v[166:167], v[166:167], v[150:151]
    v_pk_mul_f32 v[168:169], v[168:169], v[152:153]
    v_pk_mul_f32 v[170:171], v[170:171], v[154:155]
    v_pk_mul_f32 v[172:173], v[172:173], v[156:157]
    v_pk_mul_f32 v[174:175], v[174:175], v[158:159]
    v_exp_f32 v160, v160
    v_exp_f32 v161, v161
    v_exp_f32 v162, v162
    v_exp_f32 v163, v163
    v_exp_f32 v164, v164
    v_exp_f32 v165, v165
    v_exp_f32 v166, v166
    v_exp_f32 v167, v167
    v_exp_f32 v168, v168
    v_exp_f32 v169, v169
    v_exp_f32 v170, v170
    v_exp_f32 v171, v171
    v_exp_f32 v172, v172
    v_exp_f32 v173, v173
    v_exp_f32 v174, v174
    v_exp_f32 v175, v175
    v_pk_add_f32 v[160:161], v[160:161], 1.0 op_sel_hi:[1,0]
    v_pk_add_f32 v[162:163], v[162:163], 1.0 op_sel_hi:[1,0]
    v_pk_add_f32 v[164:165], v[164:165], 1.0 op_sel_hi:[1,0]
    v_pk_add_f32 v[166:167], v[166:167], 1.0 op_sel_hi:[1,0]
    v_pk_add_f32 v[168:169], v[168:169], 1.0 op_sel_hi:[1,0]
    v_pk_add_f32 v[170:171], v[170:171], 1.0 op_sel_hi:[1,0]
    v_pk_add_f32 v[172:173], v[172:173], 1.0 op_sel_hi:[1,0]
    v_pk_add_f32 v[174:175], v[174:175], 1.0 op_sel_hi:[1,0]
    v_rcp_f32 v160, v160
    v_rcp_f32 v161, v161
    v_rcp_f32 v162, v162
    v_rcp_f32 v163, v163
    v_rcp_f32 v164, v164
    v_rcp_f32 v165, v165
    v_rcp_f32 v166, v166
    v_rcp_f32 v167, v167
    v_rcp_f32 v168, v168
    v_rcp_f32 v169, v169
    v_rcp_f32 v170, v170
    v_rcp_f32 v171, v171
    v_rcp_f32 v172, v172
    v_rcp_f32 v173, v173
    v_rcp_f32 v174, v174
    v_rcp_f32 v175, v175
    v_pk_mul_f32 v[160:161], v[160:161], v[144:145]
    v_pk_mul_f32 v[162:163], v[162:163], v[146:147]
    v_pk_mul_f32 v[164:165], v[164:165], v[148:149]
    v_pk_mul_f32 v[166:167], v[166:167], v[150:151]
    v_pk_mul_f32 v[168:169], v[168:169], v[152:153]
    v_pk_mul_f32 v[170:171], v[170:171], v[154:155]
    v_pk_mul_f32 v[172:173], v[172:173], v[156:157]
    v_pk_mul_f32 v[174:175], v[174:175], v[158:159]
    v_cvt_pk_bf16_f32 v136, v160, v161
    v_cvt_pk_bf16_f32 v137, v162, v163
    v_cvt_pk_bf16_f32 v138, v164, v165
    v_cvt_pk_bf16_f32 v139, v166, v167
    v_cvt_pk_bf16_f32 v140, v168, v169
    v_cvt_pk_bf16_f32 v141, v170, v171
    v_cvt_pk_bf16_f32 v142, v172, v173
    v_cvt_pk_bf16_f32 v143, v174, v175
    s_add_u32 s87, s86, 4096
    s_nop 0
    v_permlane16_swap_b32 v136, v138
    v_permlane16_swap_b32 v137, v139
    buffer_store_dwordx4 v[136:139], v4, s[8:11], s87 offen sc1
    s_add_u32 s87, s86, 118784
    v_permlane16_swap_b32 v140, v142
    v_permlane16_swap_b32 v141, v143
    buffer_store_dwordx4 v[140:143], v4, s[8:11], s87 offen sc1
    v_lshlrev_b32 v128, 16, v216
    v_and_b32 v129, 0xffff0000, v216
    v_lshlrev_b32 v130, 16, v217
    v_and_b32 v131, 0xffff0000, v217
    v_lshlrev_b32 v132, 16, v218
    v_and_b32 v133, 0xffff0000, v218
    v_lshlrev_b32 v134, 16, v219
    v_and_b32 v135, 0xffff0000, v219
    v_cvt_pk_bf16_f32 v176, v112, v113
    v_cvt_pk_bf16_f32 v177, v114, v115
    v_cvt_pk_bf16_f32 v178, v120, v121
    v_cvt_pk_bf16_f32 v179, v122, v123
    v_cvt_pk_bf16_f32 v180, v116, v117
    v_cvt_pk_bf16_f32 v181, v118, v119
    v_cvt_pk_bf16_f32 v182, v124, v125
    v_cvt_pk_bf16_f32 v183, v126, v127
    v_lshlrev_b32 v184, 16, v176
    v_and_b32 v185, 0xffff0000, v176
    v_lshlrev_b32 v186, 16, v177
    v_and_b32 v187, 0xffff0000, v177
    v_lshlrev_b32 v188, 16, v178
    v_and_b32 v189, 0xffff0000, v178
    v_lshlrev_b32 v190, 16, v179
    v_and_b32 v191, 0xffff0000, v179
    v_lshlrev_b32 v192, 16, v180
    v_and_b32 v193, 0xffff0000, v180
    v_lshlrev_b32 v194, 16, v181
    v_and_b32 v195, 0xffff0000, v181
    v_lshlrev_b32 v196, 16, v182
    v_and_b32 v197, 0xffff0000, v182
    v_lshlrev_b32 v198, 16, v183
    v_and_b32 v199, 0xffff0000, v183
    v_pk_add_f32 v[184:185], v[184:185], v[128:129]
    v_pk_add_f32 v[186:187], v[186:187], v[130:131]
    v_pk_add_f32 v[188:189], v[188:189], v[132:133]
    v_pk_add_f32 v[190:191], v[190:191], v[134:135]
    v_pk_add_f32 v[192:193], v[192:193], v[128:129]
    v_pk_add_f32 v[194:195], v[194:195], v[130:131]
    v_pk_add_f32 v[196:197], v[196:197], v[132:133]
    v_pk_add_f32 v[198:199], v[198:199], v[134:135]
    v_cvt_pk_bf16_f32 v176, v184, v185
    v_cvt_pk_bf16_f32 v177, v186, v187
    v_cvt_pk_bf16_f32 v178, v188, v189
    v_cvt_pk_bf16_f32 v179, v190, v191
    v_cvt_pk_bf16_f32 v180, v192, v193
    v_cvt_pk_bf16_f32 v181, v194, v195
    v_cvt_pk_bf16_f32 v182, v196, v197
    v_cvt_pk_bf16_f32 v183, v198, v199
    v_lshlrev_b32 v184, 16, v176
    v_and_b32 v185, 0xffff0000, v176
    v_lshlrev_b32 v186, 16, v177
    v_and_b32 v187, 0xffff0000, v177
    v_lshlrev_b32 v188, 16, v178
    v_and_b32 v189, 0xffff0000, v178
    v_lshlrev_b32 v190, 16, v179
    v_and_b32 v191, 0xffff0000, v179
    v_lshlrev_b32 v192, 16, v180
    v_and_b32 v193, 0xffff0000, v180
    v_lshlrev_b32 v194, 16, v181
    v_and_b32 v195, 0xffff0000, v181
    v_lshlrev_b32 v196, 16, v182
    v_and_b32 v197, 0xffff0000, v182
    v_lshlrev_b32 v198, 16, v183
    v_and_b32 v199, 0xffff0000, v183
    v_pk_mul_f32 v[200:201], v[184:185], v[184:185]
    v_pk_mul_f32 v[202:203], v[186:187], v[186:187]
    v_pk_mul_f32 v[204:205], v[188:189], v[188:189]
    v_pk_mul_f32 v[206:207], v[190:191], v[190:191]
    v_pk_mul_f32 v[208:209], v[192:193], v[192:193]
    v_pk_mul_f32 v[210:211], v[194:195], v[194:195]
    v_pk_mul_f32 v[212:213], v[196:197], v[196:197]
    v_pk_mul_f32 v[214:215], v[198:199], v[198:199]
    v_pk_fma_f32 v[200:201], v[200:201], s[90:91], v[2:3]
    v_pk_fma_f32 v[202:203], v[202:203], s[90:91], v[2:3]
    v_pk_fma_f32 v[204:205], v[204:205], s[90:91], v[2:3]
    v_pk_fma_f32 v[206:207], v[206:207], s[90:91], v[2:3]
    v_pk_fma_f32 v[208:209], v[208:209], s[90:91], v[2:3]
    v_pk_fma_f32 v[210:211], v[210:211], s[90:91], v[2:3]
    v_pk_fma_f32 v[212:213], v[212:213], s[90:91], v[2:3]
    v_pk_fma_f32 v[214:215], v[214:215], s[90:91], v[2:3]
    v_pk_mul_f32 v[200:201], v[200:201], v[184:185]
    v_pk_mul_f32 v[202:203], v[202:203], v[186:187]
    v_pk_mul_f32 v[204:205], v[204:205], v[188:189]
    v_pk_mul_f32 v[206:207], v[206:207], v[190:191]
    v_pk_mul_f32 v[208:209], v[208:209], v[192:193]
    v_pk_mul_f32 v[210:211], v[210:211], v[194:195]
    v_pk_mul_f32 v[212:213], v[212:213], v[196:197]
    v_pk_mul_f32 v[214:215], v[214:215], v[198:199]
    v_exp_f32 v200, v200
    v_exp_f32 v201, v201
    v_exp_f32 v202, v202
    v_exp_f32 v203, v203
    v_exp_f32 v204, v204
    v_exp_f32 v205, v205
    v_exp_f32 v206, v206
    v_exp_f32 v207, v207
    v_exp_f32 v208, v208
    v_exp_f32 v209, v209
    v_exp_f32 v210, v210
    v_exp_f32 v211, v211
    v_exp_f32 v212, v212
    v_exp_f32 v213, v213
    v_exp_f32 v214, v214
    v_exp_f32 v215, v215
    v_pk_add_f32 v[200:201], v[200:201], 1.0 op_sel_hi:[1,0]
    v_pk_add_f32 v[202:203], v[202:203], 1.0 op_sel_hi:[1,0]
    v_pk_add_f32 v[204:205], v[204:205], 1.0 op_sel_hi:[1,0]
    v_pk_add_f32 v[206:207], v[206:207], 1.0 op_sel_hi:[1,0]
    v_pk_add_f32 v[208:209], v[208:209], 1.0 op_sel_hi:[1,0]
    v_pk_add_f32 v[210:211], v[210:211], 1.0 op_sel_hi:[1,0]
    v_pk_add_f32 v[212:213], v[212:213], 1.0 op_sel_hi:[1,0]
    v_pk_add_f32 v[214:215], v[214:215], 1.0 op_sel_hi:[1,0]
    v_rcp_f32 v200, v200
    v_rcp_f32 v201, v201
    v_rcp_f32 v202, v202
    v_rcp_f32 v203, v203
    v_rcp_f32 v204, v204
    v_rcp_f32 v205, v205
    v_rcp_f32 v206, v206
    v_rcp_f32 v207, v207
    v_rcp_f32 v208, v208
    v_rcp_f32 v209, v209
    v_rcp_f32 v210, v210
    v_rcp_f32 v211, v211
    v_rcp_f32 v212, v212
    v_rcp_f32 v213, v213
    v_rcp_f32 v214, v214
    v_rcp_f32 v215, v215
    v_pk_mul_f32 v[200:201], v[200:201], v[184:185]
    v_pk_mul_f32 v[202:203], v[202:203], v[186:187]
    v_pk_mul_f32 v[204:205], v[204:205], v[188:189]
    v_pk_mul_f32 v[206:207], v[206:207], v[190:191]
    v_pk_mul_f32 v[208:209], v[208:209], v[192:193]
    v_pk_mul_f32 v[210:211], v[210:211], v[194:195]
    v_pk_mul_f32 v[212:213], v[212:213], v[196:197]
    v_pk_mul_f32 v[214:215], v[214:215], v[198:199]
    v_cvt_pk_bf16_f32 v176, v200, v201
    v_cvt_pk_bf16_f32 v177, v202, v203
    v_cvt_pk_bf16_f32 v178, v204, v205
    v_cvt_pk_bf16_f32 v179, v206, v207
    v_cvt_pk_bf16_f32 v180, v208, v209
    v_cvt_pk_bf16_f32 v181, v210, v211
    v_cvt_pk_bf16_f32 v182, v212, v213
    v_cvt_pk_bf16_f32 v183, v214, v215
    s_add_u32 s87, s86, 5120
    s_nop 0
    v_permlane16_swap_b32 v176, v178
    v_permlane16_swap_b32 v177, v179
    buffer_store_dwordx4 v[176:179], v4, s[8:11], s87 offen sc1
    s_add_u32 s87, s86, 119808
    v_permlane16_swap_b32 v180, v182
    v_permlane16_swap_b32 v181, v183
    buffer_store_dwordx4 v[180:183], v4, s[8:11], s87 offen sc1
    s_waitcnt vmcnt(0)
    s_barrier
    s_cmp_lg_u32 s3, 0
    s_cbranch_scc1 sf_6
    v_mov_b32 v6, s78
    v_mov_b32 v7, s79
    s_mov_b64 exec, 1
    s_lshl_b32 s86, s83, 8
    s_lshl_b32 s87, s84, 3
    s_add_u32 s86, s86, s87
    s_add_u32 s86, s86, 8320
    v_mov_b32 v5, s86
    buffer_store_dwordx2 v[6:7], v5, s[48:51], 0 offen sc1
    s_mov_b64 exec, -1
sf_6:
    s_mul_i32 s80, s72, 57344
    s_add_u32 s4, s40, 12582912
    s_addc_u32 s5, s41, 0
    s_mov_b32 s6, 14680064
    s_mov_b32 s7, 0x20000
    s_lshl_b32 s86, s71, 3
    s_lshl_b32 s87, s76, 1
    s_add_u32 s86, s86, s87
    s_mul_i32 s86, s86, 114688
    v_lshlrev_b32 v8, 4, v1
    v_add_u32 v8, s86, v8
    v_add_u32 v9, 114688, v8
    s_lshl_b32 s86, s72, 14
    v_lshrrev_b32 v2, 4, v1
    v_bfe_u32 v3, v1, 2, 2
    v_lshl_add_u32 v4, v2, 3, v3
    v_mul_u32_u24 v4, 128, v4
    v_and_b32 v2, 1, v2
    v_lshlrev_b32 v2, 1, v2
    v_lshrrev_b32 v3, 1, v3
    v_or_b32 v2, v2, v3
    v_lshlrev_b32 v2, 5, v2
    v_bfe_u32 v3, v1, 1, 1
    v_lshlrev_b32 v3, 4, v3
    v_or_b32 v2, v2, v3
    v_and_b32 v3, 1, v1
    v_lshl_add_u32 v4, v3, 3, v4
    v_xor_b32 v3, 0, v2
    v_add_u32 v20, v3, v4
    v_xor_b32 v3, 32, v2
    v_add_u32 v21, v3, v4
    v_xor_b32 v3, 64, v2
    v_add_u32 v22, v3, v4
    v_xor_b32 v3, 96, v2
    v_add_u32 v23, v3, v4
    v_add_u32 v20, s86, v20
    v_add_u32 v21, s86, v21
    v_add_u32 v22, s86, v22
    v_add_u32 v23, s86, v23
    v_lshrrev_b32 v2, 4, v1
    v_bfe_u32 v3, v1, 2, 2
    v_lshl_add_u32 v4, v2, 3, v3
    v_mul_u32_u24 v4, 128, v4
    v_and_b32 v2, 1, v2
    v_lshlrev_b32 v2, 1, v2
    v_lshrrev_b32 v3, 1, v3
    v_or_b32 v2, v2, v3
    v_lshlrev_b32 v2, 5, v2
    v_bfe_u32 v3, v1, 1, 1
    v_lshlrev_b32 v3, 4, v3
    v_or_b32 v2, v2, v3
    v_and_b32 v3, 1, v1
    v_lshl_add_u32 v4, v3, 3, v4
    v_add_u32 v4, 65536, v4
    v_xor_b32 v3, 0, v2
    v_add_u32 v24, v3, v4
    v_xor_b32 v3, 32, v2
    v_add_u32 v25, v3, v4
    v_xor_b32 v3, 64, v2
    v_add_u32 v26, v3, v4
    v_xor_b32 v3, 96, v2
    v_add_u32 v27, v3, v4
    v_add_u32 v24, s86, v24
    v_add_u32 v25, s86, v25
    v_add_u32 v26, s86, v26
    v_add_u32 v27, s86, v27
    s_cmp_lg_u32 s3, 0
    s_cbranch_scc1 kf_O2_w
    v_and_b32 v2, 31, v1
    v_lshlrev_b32 v2, 3, v2
    s_lshr_b32 s86, s71, 1
    s_lshl_b32 s86, s86, 8
    s_add_u32 s86, s86, 8192
    v_add_u32 v2, s86, v2
    s_mov_b32 s93, 400000
kf_O2_p:
    buffer_load_dwordx2 v[4:5], v2, s[48:51], 0 offen sc1
    s_waitcnt vmcnt(0)
    v_cmp_ne_u64 vcc, s[78:79], v[4:5]
    s_cbranch_vccz kf_O2_w
    s_sleep 1
    s_sub_u32 s93, s93, 1
    s_cmp_lg_u32 s93, 0
    s_cbranch_scc1 kf_O2_p
kf_O2_w:
    s_barrier
    buffer_load_dwordx4 v[160:163], v8, s[4:7], s80 offen offset:0 sc1
    buffer_load_dwordx4 v[164:167], v9, s[4:7], s80 offen offset:0 sc1
    buffer_load_dwordx4 v[168:171], v8, s[4:7], s80 offen offset:1024 sc1
    buffer_load_dwordx4 v[172:175], v9, s[4:7], s80 offen offset:1024 sc1
    s_waitcnt vmcnt(12)
    s_barrier
    buffer_load_dwordx4 v[176:179], v8, s[4:7], s80 offen offset:2048 sc1
    s_add_u32 s68, s68, 131072
    s_add_u32 m0, s69, 98304
    s_nop 0
    buffer_load_dwordx4 v28, s[64:67], s68 offen lds
    buffer_load_dwordx4 v[180:183], v9, s[4:7], s80 offen offset:2048 sc1
    s_add_u32 m0, s69, 99328
    s_nop 0
    buffer_load_dwordx4 v29, s[64:67], s68 offen lds
    ds_read_b64_tr_b16 v[96:97], v20 offset:0
    ds_read_b64_tr_b16 v[98:99], v20 offset:512
    ds_read_b64_tr_b16 v[100:101], v21 offset:0
    ds_read_b64_tr_b16 v[102:103], v21 offset:512
    ds_read_b64_tr_b16 v[104:105], v22 offset:0
    ds_read_b64_tr_b16 v[106:107], v22 offset:512
    ds_read_b64_tr_b16 v[108:109], v23 offset:0
    ds_read_b64_tr_b16 v[110:111], v23 offset:512
    ds_read_b64_tr_b16 v[112:113], v20 offset:8192
    ds_read_b64_tr_b16 v[114:115], v20 offset:8704
    ds_read_b64_tr_b16 v[116:117], v21 offset:8192
    ds_read_b64_tr_b16 v[118:119], v21 offset:8704
    ds_read_b64_tr_b16 v[120:121], v22 offset:8192
    ds_read_b64_tr_b16 v[122:123], v22 offset:8704
    ds_read_b64_tr_b16 v[124:125], v23 offset:8192
    ds_read_b64_tr_b16 v[126:127], v23 offset:8704
    s_waitcnt vmcnt(6) lgkmcnt(0)
    v_mfma_f32_16x16x32_bf16 v[32:35], v[96:99], v[160:163], 0
    ds_read_b64_tr_b16 v[128:129], v20 offset:4096
    ds_read_b64_tr_b16 v[130:131], v20 offset:4608
    v_mfma_f32_16x16x32_bf16 v[36:39], v[96:99], v[164:167], 0
    ds_read_b64_tr_b16 v[132:133], v21 offset:4096
    v_mfma_f32_16x16x32_bf16 v[40:43], v[100:103], v[160:163], 0
    ds_read_b64_tr_b16 v[134:135], v21 offset:4608
    ds_read_b64_tr_b16 v[136:137], v22 offset:4096
    buffer_load_dwordx4 v[184:187], v8, s[4:7], s80 offen offset:3072 sc1
    v_mfma_f32_16x16x32_bf16 v[44:47], v[100:103], v[164:167], 0
    ds_read_b64_tr_b16 v[138:139], v22 offset:4608
    v_mfma_f32_16x16x32_bf16 v[48:51], v[104:107], v[160:163], 0
    ds_read_b64_tr_b16 v[140:141], v23 offset:4096
    ds_read_b64_tr_b16 v[142:143], v23 offset:4608
    v_mfma_f32_16x16x32_bf16 v[52:55], v[104:107], v[164:167], 0
    ds_read_b64_tr_b16 v[144:145], v20 offset:12288
    s_add_u32 m0, s69, 100352
    v_mfma_f32_16x16x32_bf16 v[56:59], v[108:111], v[160:163], 0
    ds_read_b64_tr_b16 v[146:147], v20 offset:12800
    ds_read_b64_tr_b16 v[148:149], v21 offset:12288
    buffer_load_dwordx4 v30, s[64:67], s68 offen lds
    v_mfma_f32_16x16x32_bf16 v[60:63], v[108:111], v[164:167], 0
    ds_read_b64_tr_b16 v[150:151], v21 offset:12800
    v_mfma_f32_16x16x32_bf16 v[64:67], v[112:115], v[160:163], 0
    ds_read_b64_tr_b16 v[152:153], v22 offset:12288
    ds_read_b64_tr_b16 v[154:155], v22 offset:12800
    v_mfma_f32_16x16x32_bf16 v[68:71], v[112:115], v[164:167], 0
    ds_read_b64_tr_b16 v[156:157], v23 offset:12288
    v_mfma_f32_16x16x32_bf16 v[72:75], v[116:119], v[160:163], 0
    ds_read_b64_tr_b16 v[158:159], v23 offset:12800
    buffer_load_dwordx4 v[188:191], v9, s[4:7], s80 offen offset:3072 sc1
    v_mfma_f32_16x16x32_bf16 v[76:79], v[116:119], v[164:167], 0
    v_mfma_f32_16x16x32_bf16 v[80:83], v[120:123], v[160:163], 0
    v_mfma_f32_16x16x32_bf16 v[84:87], v[120:123], v[164:167], 0
    s_add_u32 m0, s69, 101376
    v_mfma_f32_16x16x32_bf16 v[88:91], v[124:127], v[160:163], 0
    buffer_load_dwordx4 v31, s[64:67], s68 offen lds
    v_mfma_f32_16x16x32_bf16 v[92:95], v[124:127], v[164:167], 0
    s_waitcnt vmcnt(8) lgkmcnt(0)
    s_barrier
    v_mfma_f32_16x16x32_bf16 v[32:35], v[128:131], v[168:171], v[32:35]
    ds_read_b64_tr_b16 v[96:97], v20 offset:32768
    ds_read_b64_tr_b16 v[98:99], v20 offset:33280
    v_mfma_f32_16x16x32_bf16 v[36:39], v[128:131], v[172:175], v[36:39]
    ds_read_b64_tr_b16 v[100:101], v21 offset:32768
    s_add_u32 s80, s80, 4096
    v_mfma_f32_16x16x32_bf16 v[40:43], v[132:135], v[168:171], v[40:43]
    ds_read_b64_tr_b16 v[102:103], v21 offset:33280
    ds_read_b64_tr_b16 v[104:105], v22 offset:32768
    buffer_load_dwordx4 v[160:163], v8, s[4:7], s80 offen offset:0 sc1
    v_mfma_f32_16x16x32_bf16 v[44:47], v[132:135], v[172:175], v[44:47]
    ds_read_b64_tr_b16 v[106:107], v22 offset:33280
    v_mfma_f32_16x16x32_bf16 v[48:51], v[136:139], v[168:171], v[48:51]
    ds_read_b64_tr_b16 v[108:109], v23 offset:32768
    ds_read_b64_tr_b16 v[110:111], v23 offset:33280
    v_mfma_f32_16x16x32_bf16 v[52:55], v[136:139], v[172:175], v[52:55]
    ds_read_b64_tr_b16 v[112:113], v20 offset:40960
    s_add_u32 s68, s68, 131072
    s_add_u32 m0, s69, 0
    v_mfma_f32_16x16x32_bf16 v[56:59], v[140:143], v[168:171], v[56:59]
    ds_read_b64_tr_b16 v[114:115], v20 offset:41472
    ds_read_b64_tr_b16 v[116:117], v21 offset:40960
    buffer_load_dwordx4 v28, s[64:67], s68 offen lds
    v_mfma_f32_16x16x32_bf16 v[60:63], v[140:143], v[172:175], v[60:63]
    ds_read_b64_tr_b16 v[118:119], v21 offset:41472
    v_mfma_f32_16x16x32_bf16 v[64:67], v[144:147], v[168:171], v[64:67]
    ds_read_b64_tr_b16 v[120:121], v22 offset:40960
    ds_read_b64_tr_b16 v[122:123], v22 offset:41472
    v_mfma_f32_16x16x32_bf16 v[68:71], v[144:147], v[172:175], v[68:71]
    ds_read_b64_tr_b16 v[124:125], v23 offset:40960
    v_mfma_f32_16x16x32_bf16 v[72:75], v[148:151], v[168:171], v[72:75]
    ds_read_b64_tr_b16 v[126:127], v23 offset:41472
    buffer_load_dwordx4 v[164:167], v9, s[4:7], s80 offen offset:0 sc1
    v_mfma_f32_16x16x32_bf16 v[76:79], v[148:151], v[172:175], v[76:79]
    v_mfma_f32_16x16x32_bf16 v[80:83], v[152:155], v[168:171], v[80:83]
    v_mfma_f32_16x16x32_bf16 v[84:87], v[152:155], v[172:175], v[84:87]
    s_add_u32 m0, s69, 1024
    v_mfma_f32_16x16x32_bf16 v[88:91], v[156:159], v[168:171], v[88:91]
    buffer_load_dwordx4 v29, s[64:67], s68 offen lds
    v_mfma_f32_16x16x32_bf16 v[92:95], v[156:159], v[172:175], v[92:95]
    s_waitcnt vmcnt(9) lgkmcnt(0)
    v_mfma_f32_16x16x32_bf16 v[32:35], v[96:99], v[176:179], v[32:35]
    ds_read_b64_tr_b16 v[128:129], v20 offset:36864
    ds_read_b64_tr_b16 v[130:131], v20 offset:37376
    v_mfma_f32_16x16x32_bf16 v[36:39], v[96:99], v[180:183], v[36:39]
    ds_read_b64_tr_b16 v[132:133], v21 offset:36864
    v_mfma_f32_16x16x32_bf16 v[40:43], v[100:103], v[176:179], v[40:43]
    ds_read_b64_tr_b16 v[134:135], v21 offset:37376
    ds_read_b64_tr_b16 v[136:137], v22 offset:36864
    buffer_load_dwordx4 v[168:171], v8, s[4:7], s80 offen offset:1024 sc1
    v_mfma_f32_16x16x32_bf16 v[44:47], v[100:103], v[180:183], v[44:47]
    ds_read_b64_tr_b16 v[138:139], v22 offset:37376
    v_mfma_f32_16x16x32_bf16 v[48:51], v[104:107], v[176:179], v[48:51]
    ds_read_b64_tr_b16 v[140:141], v23 offset:36864
    ds_read_b64_tr_b16 v[142:143], v23 offset:37376
    v_mfma_f32_16x16x32_bf16 v[52:55], v[104:107], v[180:183], v[52:55]
    ds_read_b64_tr_b16 v[144:145], v20 offset:45056
    s_add_u32 m0, s69, 2048
    v_mfma_f32_16x16x32_bf16 v[56:59], v[108:111], v[176:179], v[56:59]
    ds_read_b64_tr_b16 v[146:147], v20 offset:45568
    ds_read_b64_tr_b16 v[148:149], v21 offset:45056
    buffer_load_dwordx4 v30, s[64:67], s68 offen lds
    v_mfma_f32_16x16x32_bf16 v[60:63], v[108:111], v[180:183], v[60:63]
    ds_read_b64_tr_b16 v[150:151], v21 offset:45568
    v_mfma_f32_16x16x32_bf16 v[64:67], v[112:115], v[176:179], v[64:67]
    ds_read_b64_tr_b16 v[152:153], v22 offset:45056
    ds_read_b64_tr_b16 v[154:155], v22 offset:45568
    v_mfma_f32_16x16x32_bf16 v[68:71], v[112:115], v[180:183], v[68:71]
    ds_read_b64_tr_b16 v[156:157], v23 offset:45056
    v_mfma_f32_16x16x32_bf16 v[72:75], v[116:119], v[176:179], v[72:75]
    ds_read_b64_tr_b16 v[158:159], v23 offset:45568
    buffer_load_dwordx4 v[172:175], v9, s[4:7], s80 offen offset:1024 sc1
    v_mfma_f32_16x16x32_bf16 v[76:79], v[116:119], v[180:183], v[76:79]
    v_mfma_f32_16x16x32_bf16 v[80:83], v[120:123], v[176:179], v[80:83]
    v_mfma_f32_16x16x32_bf16 v[84:87], v[120:123], v[180:183], v[84:87]
    s_add_u32 m0, s69, 3072
    v_mfma_f32_16x16x32_bf16 v[88:91], v[124:127], v[176:179], v[88:91]
    buffer_load_dwordx4 v31, s[64:67], s68 offen lds
    v_mfma_f32_16x16x32_bf16 v[92:95], v[124:127], v[180:183], v[92:95]
    s_waitcnt vmcnt(9) lgkmcnt(0)
    s_barrier
    v_mfma_f32_16x16x32_bf16 v[32:35], v[128:131], v[184:187], v[32:35]
    ds_read_b64_tr_b16 v[96:97], v24 offset:0
    ds_read_b64_tr_b16 v[98:99], v24 offset:512
    v_mfma_f32_16x16x32_bf16 v[36:39], v[128:131], v[188:191], v[36:39]
    ds_read_b64_tr_b16 v[100:101], v25 offset:0
    v_mfma_f32_16x16x32_bf16 v[40:43], v[132:135], v[184:187], v[40:43]
    ds_read_b64_tr_b16 v[102:103], v25 offset:512
    ds_read_b64_tr_b16 v[104:105], v26 offset:0
    buffer_load_dwordx4 v[176:179], v8, s[4:7], s80 offen offset:2048 sc1
    v_mfma_f32_16x16x32_bf16 v[44:47], v[132:135], v[188:191], v[44:47]
    ds_read_b64_tr_b16 v[106:107], v26 offset:512
    v_mfma_f32_16x16x32_bf16 v[48:51], v[136:139], v[184:187], v[48:51]
    ds_read_b64_tr_b16 v[108:109], v27 offset:0
    ds_read_b64_tr_b16 v[110:111], v27 offset:512
    v_mfma_f32_16x16x32_bf16 v[52:55], v[136:139], v[188:191], v[52:55]
    ds_read_b64_tr_b16 v[112:113], v24 offset:8192
    s_add_u32 s68, s68, 131072
    s_add_u32 m0, s69, 32768
    v_mfma_f32_16x16x32_bf16 v[56:59], v[140:143], v[184:187], v[56:59]
    ds_read_b64_tr_b16 v[114:115], v24 offset:8704
    ds_read_b64_tr_b16 v[116:117], v25 offset:8192
    buffer_load_dwordx4 v28, s[64:67], s68 offen lds
    v_mfma_f32_16x16x32_bf16 v[60:63], v[140:143], v[188:191], v[60:63]
    ds_read_b64_tr_b16 v[118:119], v25 offset:8704
    v_mfma_f32_16x16x32_bf16 v[64:67], v[144:147], v[184:187], v[64:67]
    ds_read_b64_tr_b16 v[120:121], v26 offset:8192
    ds_read_b64_tr_b16 v[122:123], v26 offset:8704
    v_mfma_f32_16x16x32_bf16 v[68:71], v[144:147], v[188:191], v[68:71]
    ds_read_b64_tr_b16 v[124:125], v27 offset:8192
    v_mfma_f32_16x16x32_bf16 v[72:75], v[148:151], v[184:187], v[72:75]
    ds_read_b64_tr_b16 v[126:127], v27 offset:8704
    buffer_load_dwordx4 v[180:183], v9, s[4:7], s80 offen offset:2048 sc1
    v_mfma_f32_16x16x32_bf16 v[76:79], v[148:151], v[188:191], v[76:79]
    v_mfma_f32_16x16x32_bf16 v[80:83], v[152:155], v[184:187], v[80:83]
    v_mfma_f32_16x16x32_bf16 v[84:87], v[152:155], v[188:191], v[84:87]
    s_add_u32 m0, s69, 33792
    v_mfma_f32_16x16x32_bf16 v[88:91], v[156:159], v[184:187], v[88:91]
    buffer_load_dwordx4 v29, s[64:67], s68 offen lds
    v_mfma_f32_16x16x32_bf16 v[92:95], v[156:159], v[188:191], v[92:95]
    s_waitcnt vmcnt(9) lgkmcnt(0)
    v_mfma_f32_16x16x32_bf16 v[32:35], v[96:99], v[160:163], v[32:35]
    ds_read_b64_tr_b16 v[128:129], v24 offset:4096
    ds_read_b64_tr_b16 v[130:131], v24 offset:4608
    v_mfma_f32_16x16x32_bf16 v[36:39], v[96:99], v[164:167], v[36:39]
    ds_read_b64_tr_b16 v[132:133], v25 offset:4096
    v_mfma_f32_16x16x32_bf16 v[40:43], v[100:103], v[160:163], v[40:43]
    ds_read_b64_tr_b16 v[134:135], v25 offset:4608
    ds_read_b64_tr_b16 v[136:137], v26 offset:4096
    buffer_load_dwordx4 v[184:187], v8, s[4:7], s80 offen offset:3072 sc1
    v_mfma_f32_16x16x32_bf16 v[44:47], v[100:103], v[164:167], v[44:47]
    ds_read_b64_tr_b16 v[138:139], v26 offset:4608
    v_mfma_f32_16x16x32_bf16 v[48:51], v[104:107], v[160:163], v[48:51]
    ds_read_b64_tr_b16 v[140:141], v27 offset:4096
    ds_read_b64_tr_b16 v[142:143], v27 offset:4608
    v_mfma_f32_16x16x32_bf16 v[52:55], v[104:107], v[164:167], v[52:55]
    ds_read_b64_tr_b16 v[144:145], v24 offset:12288
    s_add_u32 m0, s69, 34816
    v_mfma_f32_16x16x32_bf16 v[56:59], v[108:111], v[160:163], v[56:59]
    ds_read_b64_tr_b16 v[146:147], v24 offset:12800
    ds_read_b64_tr_b16 v[148:149], v25 offset:12288
    buffer_load_dwordx4 v30, s[64:67], s68 offen lds
    v_mfma_f32_16x16x32_bf16 v[60:63], v[108:111], v[164:167], v[60:63]
    ds_read_b64_tr_b16 v[150:151], v25 offset:12800
    v_mfma_f32_16x16x32_bf16 v[64:67], v[112:115], v[160:163], v[64:67]
    ds_read_b64_tr_b16 v[152:153], v26 offset:12288
    ds_read_b64_tr_b16 v[154:155], v26 offset:12800
    v_mfma_f32_16x16x32_bf16 v[68:71], v[112:115], v[164:167], v[68:71]
    ds_read_b64_tr_b16 v[156:157], v27 offset:12288
    v_mfma_f32_16x16x32_bf16 v[72:75], v[116:119], v[160:163], v[72:75]
    ds_read_b64_tr_b16 v[158:159], v27 offset:12800
    buffer_load_dwordx4 v[188:191], v9, s[4:7], s80 offen offset:3072 sc1
    v_mfma_f32_16x16x32_bf16 v[76:79], v[116:119], v[164:167], v[76:79]
    v_mfma_f32_16x16x32_bf16 v[80:83], v[120:123], v[160:163], v[80:83]
    v_mfma_f32_16x16x32_bf16 v[84:87], v[120:123], v[164:167], v[84:87]
    s_add_u32 m0, s69, 35840
    v_mfma_f32_16x16x32_bf16 v[88:91], v[124:127], v[160:163], v[88:91]
    buffer_load_dwordx4 v31, s[64:67], s68 offen lds
    v_mfma_f32_16x16x32_bf16 v[92:95], v[124:127], v[164:167], v[92:95]
    s_waitcnt vmcnt(9) lgkmcnt(0)
    s_barrier
    v_mfma_f32_16x16x32_bf16 v[32:35], v[128:131], v[168:171], v[32:35]
    ds_read_b64_tr_b16 v[96:97], v24 offset:32768
    ds_read_b64_tr_b16 v[98:99], v24 offset:33280
    v_mfma_f32_16x16x32_bf16 v[36:39], v[128:131], v[172:175], v[36:39]
    ds_read_b64_tr_b16 v[100:101], v25 offset:32768
    s_add_u32 s80, s80, 4096
    v_mfma_f32_16x16x32_bf16 v[40:43], v[132:135], v[168:171], v[40:43]
    ds_read_b64_tr_b16 v[102:103], v25 offset:33280
    ds_read_b64_tr_b16 v[104:105], v26 offset:32768
    buffer_load_dwordx4 v[160:163], v8, s[4:7], s80 offen offset:0 sc1
    v_mfma_f32_16x16x32_bf16 v[44:47], v[132:135], v[172:175], v[44:47]
    ds_read_b64_tr_b16 v[106:107], v26 offset:33280
    v_mfma_f32_16x16x32_bf16 v[48:51], v[136:139], v[168:171], v[48:51]
    ds_read_b64_tr_b16 v[108:109], v27 offset:32768
    ds_read_b64_tr_b16 v[110:111], v27 offset:33280
    v_mfma_f32_16x16x32_bf16 v[52:55], v[136:139], v[172:175], v[52:55]
    ds_read_b64_tr_b16 v[112:113], v24 offset:40960
    s_add_u32 s68, s68, 131072
    s_add_u32 m0, s69, 65536
    v_mfma_f32_16x16x32_bf16 v[56:59], v[140:143], v[168:171], v[56:59]
    ds_read_b64_tr_b16 v[114:115], v24 offset:41472
    ds_read_b64_tr_b16 v[116:117], v25 offset:40960
    buffer_load_dwordx4 v28, s[64:67], s68 offen lds
    v_mfma_f32_16x16x32_bf16 v[60:63], v[140:143], v[172:175], v[60:63]
    ds_read_b64_tr_b16 v[118:119], v25 offset:41472
    v_mfma_f32_16x16x32_bf16 v[64:67], v[144:147], v[168:171], v[64:67]
    ds_read_b64_tr_b16 v[120:121], v26 offset:40960
    ds_read_b64_tr_b16 v[122:123], v26 offset:41472
    v_mfma_f32_16x16x32_bf16 v[68:71], v[144:147], v[172:175], v[68:71]
    ds_read_b64_tr_b16 v[124:125], v27 offset:40960
    v_mfma_f32_16x16x32_bf16 v[72:75], v[148:151], v[168:171], v[72:75]
    ds_read_b64_tr_b16 v[126:127], v27 offset:41472
    buffer_load_dwordx4 v[164:167], v9, s[4:7], s80 offen offset:0 sc1
    v_mfma_f32_16x16x32_bf16 v[76:79], v[148:151], v[172:175], v[76:79]
    v_mfma_f32_16x16x32_bf16 v[80:83], v[152:155], v[168:171], v[80:83]
    v_mfma_f32_16x16x32_bf16 v[84:87], v[152:155], v[172:175], v[84:87]
    s_add_u32 m0, s69, 66560
    v_mfma_f32_16x16x32_bf16 v[88:91], v[156:159], v[168:171], v[88:91]
    buffer_load_dwordx4 v29, s[64:67], s68 offen lds
    v_mfma_f32_16x16x32_bf16 v[92:95], v[156:159], v[172:175], v[92:95]
    s_waitcnt vmcnt(9) lgkmcnt(0)
    v_mfma_f32_16x16x32_bf16 v[32:35], v[96:99], v[176:179], v[32:35]
    ds_read_b64_tr_b16 v[128:129], v24 offset:36864
    ds_read_b64_tr_b16 v[130:131], v24 offset:37376
    v_mfma_f32_16x16x32_bf16 v[36:39], v[96:99], v[180:183], v[36:39]
    ds_read_b64_tr_b16 v[132:133], v25 offset:36864
    v_mfma_f32_16x16x32_bf16 v[40:43], v[100:103], v[176:179], v[40:43]
    ds_read_b64_tr_b16 v[134:135], v25 offset:37376
    ds_read_b64_tr_b16 v[136:137], v26 offset:36864
    buffer_load_dwordx4 v[168:171], v8, s[4:7], s80 offen offset:1024 sc1
    v_mfma_f32_16x16x32_bf16 v[44:47], v[100:103], v[180:183], v[44:47]
    ds_read_b64_tr_b16 v[138:139], v26 offset:37376
    v_mfma_f32_16x16x32_bf16 v[48:51], v[104:107], v[176:179], v[48:51]
    ds_read_b64_tr_b16 v[140:141], v27 offset:36864
    ds_read_b64_tr_b16 v[142:143], v27 offset:37376
    v_mfma_f32_16x16x32_bf16 v[52:55], v[104:107], v[180:183], v[52:55]
    ds_read_b64_tr_b16 v[144:145], v24 offset:45056
    s_add_u32 m0, s69, 67584
    v_mfma_f32_16x16x32_bf16 v[56:59], v[108:111], v[176:179], v[56:59]
    ds_read_b64_tr_b16 v[146:147], v24 offset:45568
    ds_read_b64_tr_b16 v[148:149], v25 offset:45056
    buffer_load_dwordx4 v30, s[64:67], s68 offen lds
    v_mfma_f32_16x16x32_bf16 v[60:63], v[108:111], v[180:183], v[60:63]
    ds_read_b64_tr_b16 v[150:151], v25 offset:45568
    v_mfma_f32_16x16x32_bf16 v[64:67], v[112:115], v[176:179], v[64:67]
    ds_read_b64_tr_b16 v[152:153], v26 offset:45056
    ds_read_b64_tr_b16 v[154:155], v26 offset:45568
    v_mfma_f32_16x16x32_bf16 v[68:71], v[112:115], v[180:183], v[68:71]
    ds_read_b64_tr_b16 v[156:157], v27 offset:45056
    v_mfma_f32_16x16x32_bf16 v[72:75], v[116:119], v[176:179], v[72:75]
    ds_read_b64_tr_b16 v[158:159], v27 offset:45568
    buffer_load_dwordx4 v[172:175], v9, s[4:7], s80 offen offset:1024 sc1
    v_mfma_f32_16x16x32_bf16 v[76:79], v[116:119], v[180:183], v[76:79]
    v_mfma_f32_16x16x32_bf16 v[80:83], v[120:123], v[176:179], v[80:83]
    v_mfma_f32_16x16x32_bf16 v[84:87], v[120:123], v[180:183], v[84:87]
    s_add_u32 m0, s69, 68608
    v_mfma_f32_16x16x32_bf16 v[88:91], v[124:127], v[176:179], v[88:91]
    buffer_load_dwordx4 v31, s[64:67], s68 offen lds
    v_mfma_f32_16x16x32_bf16 v[92:95], v[124:127], v[180:183], v[92:95]
    s_waitcnt vmcnt(9) lgkmcnt(0)
    s_barrier
    v_mfma_f32_16x16x32_bf16 v[32:35], v[128:131], v[184:187], v[32:35]
    ds_read_b64_tr_b16 v[96:97], v20 offset:0
    ds_read_b64_tr_b16 v[98:99], v20 offset:512
    v_mfma_f32_16x16x32_bf16 v[36:39], v[128:131], v[188:191], v[36:39]
    ds_read_b64_tr_b16 v[100:101], v21 offset:0
    v_mfma_f32_16x16x32_bf16 v[40:43], v[132:135], v[184:187], v[40:43]
    ds_read_b64_tr_b16 v[102:103], v21 offset:512
    ds_read_b64_tr_b16 v[104:105], v22 offset:0
    buffer_load_dwordx4 v[176:179], v8, s[4:7], s80 offen offset:2048 sc1
    v_mfma_f32_16x16x32_bf16 v[44:47], v[132:135], v[188:191], v[44:47]
    ds_read_b64_tr_b16 v[106:107], v22 offset:512
    v_mfma_f32_16x16x32_bf16 v[48:51], v[136:139], v[184:187], v[48:51]
    ds_read_b64_tr_b16 v[108:109], v23 offset:0
    ds_read_b64_tr_b16 v[110:111], v23 offset:512
    v_mfma_f32_16x16x32_bf16 v[52:55], v[136:139], v[188:191], v[52:55]
    ds_read_b64_tr_b16 v[112:113], v20 offset:8192
    s_add_u32 s68, s68, 131072
    s_add_u32 m0, s69, 98304
    v_mfma_f32_16x16x32_bf16 v[56:59], v[140:143], v[184:187], v[56:59]
    ds_read_b64_tr_b16 v[114:115], v20 offset:8704
    ds_read_b64_tr_b16 v[116:117], v21 offset:8192
    buffer_load_dwordx4 v28, s[64:67], s68 offen lds
    v_mfma_f32_16x16x32_bf16 v[60:63], v[140:143], v[188:191], v[60:63]
    ds_read_b64_tr_b16 v[118:119], v21 offset:8704
    v_mfma_f32_16x16x32_bf16 v[64:67], v[144:147], v[184:187], v[64:67]
    ds_read_b64_tr_b16 v[120:121], v22 offset:8192
    ds_read_b64_tr_b16 v[122:123], v22 offset:8704
    v_mfma_f32_16x16x32_bf16 v[68:71], v[144:147], v[188:191], v[68:71]
    ds_read_b64_tr_b16 v[124:125], v23 offset:8192
    v_mfma_f32_16x16x32_bf16 v[72:75], v[148:151], v[184:187], v[72:75]
    ds_read_b64_tr_b16 v[126:127], v23 offset:8704
    buffer_load_dwordx4 v[180:183], v9, s[4:7], s80 offen offset:2048 sc1
    v_mfma_f32_16x16x32_bf16 v[76:79], v[148:151], v[188:191], v[76:79]
    v_mfma_f32_16x16x32_bf16 v[80:83], v[152:155], v[184:187], v[80:83]
    v_mfma_f32_16x16x32_bf16 v[84:87], v[152:155], v[188:191], v[84:87]
    s_add_u32 m0, s69, 99328
    v_mfma_f32_16x16x32_bf16 v[88:91], v[156:159], v[184:187], v[88:91]
    buffer_load_dwordx4 v29, s[64:67], s68 offen lds
    v_mfma_f32_16x16x32_bf16 v[92:95], v[156:159], v[188:191], v[92:95]
    s_mov_b32 s82, 5
.p2align 6
kfo_loop_7:
    s_waitcnt vmcnt(9) lgkmcnt(0)
    v_mfma_f32_16x16x32_bf16 v[32:35], v[96:99], v[160:163], v[32:35]
    ds_read_b64_tr_b16 v[128:129], v20 offset:4096
    ds_read_b64_tr_b16 v[130:131], v20 offset:4608
    v_mfma_f32_16x16x32_bf16 v[36:39], v[96:99], v[164:167], v[36:39]
    ds_read_b64_tr_b16 v[132:133], v21 offset:4096
    v_mfma_f32_16x16x32_bf16 v[40:43], v[100:103], v[160:163], v[40:43]
    ds_read_b64_tr_b16 v[134:135], v21 offset:4608
    ds_read_b64_tr_b16 v[136:137], v22 offset:4096
    buffer_load_dwordx4 v[184:187], v8, s[4:7], s80 offen offset:3072 sc1
    v_mfma_f32_16x16x32_bf16 v[44:47], v[100:103], v[164:167], v[44:47]
    ds_read_b64_tr_b16 v[138:139], v22 offset:4608
    v_mfma_f32_16x16x32_bf16 v[48:51], v[104:107], v[160:163], v[48:51]
    ds_read_b64_tr_b16 v[140:141], v23 offset:4096
    ds_read_b64_tr_b16 v[142:143], v23 offset:4608
    v_mfma_f32_16x16x32_bf16 v[52:55], v[104:107], v[164:167], v[52:55]
    ds_read_b64_tr_b16 v[144:145], v20 offset:12288
    s_add_u32 m0, s69, 100352
    v_mfma_f32_16x16x32_bf16 v[56:59], v[108:111], v[160:163], v[56:59]
    ds_read_b64_tr_b16 v[146:147], v20 offset:12800
    ds_read_b64_tr_b16 v[148:149], v21 offset:12288
    buffer_load_dwordx4 v30, s[64:67], s68 offen lds
    v_mfma_f32_16x16x32_bf16 v[60:63], v[108:111], v[164:167], v[60:63]
    ds_read_b64_tr_b16 v[150:151], v21 offset:12800
    v_mfma_f32_16x16x32_bf16 v[64:67], v[112:115], v[160:163], v[64:67]
    ds_read_b64_tr_b16 v[152:153], v22 offset:12288
    ds_read_b64_tr_b16 v[154:155], v22 offset:12800
    v_mfma_f32_16x16x32_bf16 v[68:71], v[112:115], v[164:167], v[68:71]
    ds_read_b64_tr_b16 v[156:157], v23 offset:12288
    v_mfma_f32_16x16x32_bf16 v[72:75], v[116:119], v[160:163], v[72:75]
    ds_read_b64_tr_b16 v[158:159], v23 offset:12800
    buffer_load_dwordx4 v[188:191], v9, s[4:7], s80 offen offset:3072 sc1
    v_mfma_f32_16x16x32_bf16 v[76:79], v[116:119], v[164:167], v[76:79]
    v_mfma_f32_16x16x32_bf16 v[80:83], v[120:123], v[160:163], v[80:83]
    v_mfma_f32_16x16x32_bf16 v[84:87], v[120:123], v[164:167], v[84:87]
    s_add_u32 m0, s69, 101376
    v_mfma_f32_16x16x32_bf16 v[88:91], v[124:127], v[160:163], v[88:91]
    buffer_load_dwordx4 v31, s[64:67], s68 offen lds
    v_mfma_f32_16x16x32_bf16 v[92:95], v[124:127], v[164:167], v[92:95]
    s_waitcnt vmcnt(9) lgkmcnt(0)
    s_barrier
    v_mfma_f32_16x16x32_bf16 v[32:35], v[128:131], v[168:171], v[32:35]
    ds_read_b64_tr_b16 v[96:97], v20 offset:32768
    ds_read_b64_tr_b16 v[98:99], v20 offset:33280
    v_mfma_f32_16x16x32_bf16 v[36:39], v[128:131], v[172:175], v[36:39]
    ds_read_b64_tr_b16 v[100:101], v21 offset:32768
    s_add_u32 s80, s80, 4096
    v_mfma_f32_16x16x32_bf16 v[40:43], v[132:135], v[168:171], v[40:43]
    ds_read_b64_tr_b16 v[102:103], v21 offset:33280
    ds_read_b64_tr_b16 v[104:105], v22 offset:32768
    buffer_load_dwordx4 v[160:163], v8, s[4:7], s80 offen offset:0 sc1
    v_mfma_f32_16x16x32_bf16 v[44:47], v[132:135], v[172:175], v[44:47]
    ds_read_b64_tr_b16 v[106:107], v22 offset:33280
    v_mfma_f32_16x16x32_bf16 v[48:51], v[136:139], v[168:171], v[48:51]
    ds_read_b64_tr_b16 v[108:109], v23 offset:32768
    ds_read_b64_tr_b16 v[110:111], v23 offset:33280
    v_mfma_f32_16x16x32_bf16 v[52:55], v[136:139], v[172:175], v[52:55]
    ds_read_b64_tr_b16 v[112:113], v20 offset:40960
    s_add_u32 s68, s68, 131072
    s_add_u32 m0, s69, 0
    v_mfma_f32_16x16x32_bf16 v[56:59], v[140:143], v[168:171], v[56:59]
    ds_read_b64_tr_b16 v[114:115], v20 offset:41472
    ds_read_b64_tr_b16 v[116:117], v21 offset:40960
    buffer_load_dwordx4 v28, s[64:67], s68 offen lds
    v_mfma_f32_16x16x32_bf16 v[60:63], v[140:143], v[172:175], v[60:63]
    ds_read_b64_tr_b16 v[118:119], v21 offset:41472
    v_mfma_f32_16x16x32_bf16 v[64:67], v[144:147], v[168:171], v[64:67]
    ds_read_b64_tr_b16 v[120:121], v22 offset:40960
    ds_read_b64_tr_b16 v[122:123], v22 offset:41472
    v_mfma_f32_16x16x32_bf16 v[68:71], v[144:147], v[172:175], v[68:71]
    ds_read_b64_tr_b16 v[124:125], v23 offset:40960
    v_mfma_f32_16x16x32_bf16 v[72:75], v[148:151], v[168:171], v[72:75]
    ds_read_b64_tr_b16 v[126:127], v23 offset:41472
    buffer_load_dwordx4 v[164:167], v9, s[4:7], s80 offen offset:0 sc1
    v_mfma_f32_16x16x32_bf16 v[76:79], v[148:151], v[172:175], v[76:79]
    v_mfma_f32_16x16x32_bf16 v[80:83], v[152:155], v[168:171], v[80:83]
    v_mfma_f32_16x16x32_bf16 v[84:87], v[152:155], v[172:175], v[84:87]
    s_add_u32 m0, s69, 1024
    v_mfma_f32_16x16x32_bf16 v[88:91], v[156:159], v[168:171], v[88:91]
    buffer_load_dwordx4 v29, s[64:67], s68 offen lds
    v_mfma_f32_16x16x32_bf16 v[92:95], v[156:159], v[172:175], v[92:95]
    s_waitcnt vmcnt(9) lgkmcnt(0)
    v_mfma_f32_16x16x32_bf16 v[32:35], v[96:99], v[176:179], v[32:35]
    ds_read_b64_tr_b16 v[128:129], v20 offset:36864
    ds_read_b64_tr_b16 v[130:131], v20 offset:37376
    v_mfma_f32_16x16x32_bf16 v[36:39], v[96:99], v[180:183], v[36:39]
    ds_read_b64_tr_b16 v[132:133], v21 offset:36864
    v_mfma_f32_16x16x32_bf16 v[40:43], v[100:103], v[176:179], v[40:43]
    ds_read_b64_tr_b16 v[134:135], v21 offset:37376
    ds_read_b64_tr_b16 v[136:137], v22 offset:36864
    buffer_load_dwordx4 v[168:171], v8, s[4:7], s80 offen offset:1024 sc1
    v_mfma_f32_16x16x32_bf16 v[44:47], v[100:103], v[180:183], v[44:47]
    ds_read_b64_tr_b16 v[138:139], v22 offset:37376
    v_mfma_f32_16x16x32_bf16 v[48:51], v[104:107], v[176:179], v[48:51]
    ds_read_b64_tr_b16 v[140:141], v23 offset:36864
    ds_read_b64_tr_b16 v[142:143], v23 offset:37376
    v_mfma_f32_16x16x32_bf16 v[52:55], v[104:107], v[180:183], v[52:55]
    ds_read_b64_tr_b16 v[144:145], v20 offset:45056
    s_add_u32 m0, s69, 2048
    v_mfma_f32_16x16x32_bf16 v[56:59], v[108:111], v[176:179], v[56:59]
    ds_read_b64_tr_b16 v[146:147], v20 offset:45568
    ds_read_b64_tr_b16 v[148:149], v21 offset:45056
    buffer_load_dwordx4 v30, s[64:67], s68 offen lds
    v_mfma_f32_16x16x32_bf16 v[60:63], v[108:111], v[180:183], v[60:63]
    ds_read_b64_tr_b16 v[150:151], v21 offset:45568
    v_mfma_f32_16x16x32_bf16 v[64:67], v[112:115], v[176:179], v[64:67]
    ds_read_b64_tr_b16 v[152:153], v22 offset:45056
    ds_read_b64_tr_b16 v[154:155], v22 offset:45568
    v_mfma_f32_16x16x32_bf16 v[68:71], v[112:115], v[180:183], v[68:71]
    ds_read_b64_tr_b16 v[156:157], v23 offset:45056
    v_mfma_f32_16x16x32_bf16 v[72:75], v[116:119], v[176:179], v[72:75]
    ds_read_b64_tr_b16 v[158:159], v23 offset:45568
    buffer_load_dwordx4 v[172:175], v9, s[4:7], s80 offen offset:1024 sc1
    v_mfma_f32_16x16x32_bf16 v[76:79], v[116:119], v[180:183], v[76:79]
    v_mfma_f32_16x16x32_bf16 v[80:83], v[120:123], v[176:179], v[80:83]
    v_mfma_f32_16x16x32_bf16 v[84:87], v[120:123], v[180:183], v[84:87]
    s_add_u32 m0, s69, 3072
    v_mfma_f32_16x16x32_bf16 v[88:91], v[124:127], v[176:179], v[88:91]
    buffer_load_dwordx4 v31, s[64:67], s68 offen lds
    v_mfma_f32_16x16x32_bf16 v[92:95], v[124:127], v[180:183], v[92:95]
    s_waitcnt vmcnt(9) lgkmcnt(0)
    s_barrier
    v_mfma_f32_16x16x32_bf16 v[32:35], v[128:131], v[184:187], v[32:35]
    ds_read_b64_tr_b16 v[96:97], v24 offset:0
    ds_read_b64_tr_b16 v[98:99], v24 offset:512
    v_mfma_f32_16x16x32_bf16 v[36:39], v[128:131], v[188:191], v[36:39]
    ds_read_b64_tr_b16 v[100:101], v25 offset:0
    v_mfma_f32_16x16x32_bf16 v[40:43], v[132:135], v[184:187], v[40:43]
    ds_read_b64_tr_b16 v[102:103], v25 offset:512
    ds_read_b64_tr_b16 v[104:105], v26 offset:0
    buffer_load_dwordx4 v[176:179], v8, s[4:7], s80 offen offset:2048 sc1
    v_mfma_f32_16x16x32_bf16 v[44:47], v[132:135], v[188:191], v[44:47]
    ds_read_b64_tr_b16 v[106:107], v26 offset:512
    v_mfma_f32_16x16x32_bf16 v[48:51], v[136:139], v[184:187], v[48:51]
    ds_read_b64_tr_b16 v[108:109], v27 offset:0
    ds_read_b64_tr_b16 v[110:111], v27 offset:512
    v_mfma_f32_16x16x32_bf16 v[52:55], v[136:139], v[188:191], v[52:55]
    ds_read_b64_tr_b16 v[112:113], v24 offset:8192
    s_add_u32 s68, s68, 131072
    s_add_u32 m0, s69, 32768
    v_mfma_f32_16x16x32_bf16 v[56:59], v[140:143], v[184:187], v[56:59]
    ds_read_b64_tr_b16 v[114:115], v24 offset:8704
    ds_read_b64_tr_b16 v[116:117], v25 offset:8192
    buffer_load_dwordx4 v28, s[64:67], s68 offen lds
    v_mfma_f32_16x16x32_bf16 v[60:63], v[140:143], v[188:191], v[60:63]
    ds_read_b64_tr_b16 v[118:119], v25 offset:8704
    v_mfma_f32_16x16x32_bf16 v[64:67], v[144:147], v[184:187], v[64:67]
    ds_read_b64_tr_b16 v[120:121], v26 offset:8192
    ds_read_b64_tr_b16 v[122:123], v26 offset:8704
    v_mfma_f32_16x16x32_bf16 v[68:71], v[144:147], v[188:191], v[68:71]
    ds_read_b64_tr_b16 v[124:125], v27 offset:8192
    v_mfma_f32_16x16x32_bf16 v[72:75], v[148:151], v[184:187], v[72:75]
    ds_read_b64_tr_b16 v[126:127], v27 offset:8704
    buffer_load_dwordx4 v[180:183], v9, s[4:7], s80 offen offset:2048 sc1
    v_mfma_f32_16x16x32_bf16 v[76:79], v[148:151], v[188:191], v[76:79]
    v_mfma_f32_16x16x32_bf16 v[80:83], v[152:155], v[184:187], v[80:83]
    v_mfma_f32_16x16x32_bf16 v[84:87], v[152:155], v[188:191], v[84:87]
    s_add_u32 m0, s69, 33792
    v_mfma_f32_16x16x32_bf16 v[88:91], v[156:159], v[184:187], v[88:91]
    buffer_load_dwordx4 v29, s[64:67], s68 offen lds
    v_mfma_f32_16x16x32_bf16 v[92:95], v[156:159], v[188:191], v[92:95]
    s_waitcnt vmcnt(9) lgkmcnt(0)
    v_mfma_f32_16x16x32_bf16 v[32:35], v[96:99], v[160:163], v[32:35]
    ds_read_b64_tr_b16 v[128:129], v24 offset:4096
    ds_read_b64_tr_b16 v[130:131], v24 offset:4608
    v_mfma_f32_16x16x32_bf16 v[36:39], v[96:99], v[164:167], v[36:39]
    ds_read_b64_tr_b16 v[132:133], v25 offset:4096
    v_mfma_f32_16x16x32_bf16 v[40:43], v[100:103], v[160:163], v[40:43]
    ds_read_b64_tr_b16 v[134:135], v25 offset:4608
    ds_read_b64_tr_b16 v[136:137], v26 offset:4096
    buffer_load_dwordx4 v[184:187], v8, s[4:7], s80 offen offset:3072 sc1
    v_mfma_f32_16x16x32_bf16 v[44:47], v[100:103], v[164:167], v[44:47]
    ds_read_b64_tr_b16 v[138:139], v26 offset:4608
    v_mfma_f32_16x16x32_bf16 v[48:51], v[104:107], v[160:163], v[48:51]
    ds_read_b64_tr_b16 v[140:141], v27 offset:4096
    ds_read_b64_tr_b16 v[142:143], v27 offset:4608
    v_mfma_f32_16x16x32_bf16 v[52:55], v[104:107], v[164:167], v[52:55]
    ds_read_b64_tr_b16 v[144:145], v24 offset:12288
    s_add_u32 m0, s69, 34816
    v_mfma_f32_16x16x32_bf16 v[56:59], v[108:111], v[160:163], v[56:59]
    ds_read_b64_tr_b16 v[146:147], v24 offset:12800
    ds_read_b64_tr_b16 v[148:149], v25 offset:12288
    buffer_load_dwordx4 v30, s[64:67], s68 offen lds
    v_mfma_f32_16x16x32_bf16 v[60:63], v[108:111], v[164:167], v[60:63]
    ds_read_b64_tr_b16 v[150:151], v25 offset:12800
    v_mfma_f32_16x16x32_bf16 v[64:67], v[112:115], v[160:163], v[64:67]
    ds_read_b64_tr_b16 v[152:153], v26 offset:12288
    ds_read_b64_tr_b16 v[154:155], v26 offset:12800
    v_mfma_f32_16x16x32_bf16 v[68:71], v[112:115], v[164:167], v[68:71]
    ds_read_b64_tr_b16 v[156:157], v27 offset:12288
    v_mfma_f32_16x16x32_bf16 v[72:75], v[116:119], v[160:163], v[72:75]
    ds_read_b64_tr_b16 v[158:159], v27 offset:12800
    buffer_load_dwordx4 v[188:191], v9, s[4:7], s80 offen offset:3072 sc1
    v_mfma_f32_16x16x32_bf16 v[76:79], v[116:119], v[164:167], v[76:79]
    v_mfma_f32_16x16x32_bf16 v[80:83], v[120:123], v[160:163], v[80:83]
    v_mfma_f32_16x16x32_bf16 v[84:87], v[120:123], v[164:167], v[84:87]
    s_add_u32 m0, s69, 35840
    v_mfma_f32_16x16x32_bf16 v[88:91], v[124:127], v[160:163], v[88:91]
    buffer_load_dwordx4 v31, s[64:67], s68 offen lds
    v_mfma_f32_16x16x32_bf16 v[92:95], v[124:127], v[164:167], v[92:95]
    s_waitcnt vmcnt(9) lgkmcnt(0)
    s_barrier
    v_mfma_f32_16x16x32_bf16 v[32:35], v[128:131], v[168:171], v[32:35]
    ds_read_b64_tr_b16 v[96:97], v24 offset:32768
    ds_read_b64_tr_b16 v[98:99], v24 offset:33280
    v_mfma_f32_16x16x32_bf16 v[36:39], v[128:131], v[172:175], v[36:39]
    ds_read_b64_tr_b16 v[100:101], v25 offset:32768
    s_add_u32 s80, s80, 4096
    v_mfma_f32_16x16x32_bf16 v[40:43], v[132:135], v[168:171], v[40:43]
    ds_read_b64_tr_b16 v[102:103], v25 offset:33280
    ds_read_b64_tr_b16 v[104:105], v26 offset:32768
    buffer_load_dwordx4 v[160:163], v8, s[4:7], s80 offen offset:0 sc1
    v_mfma_f32_16x16x32_bf16 v[44:47], v[132:135], v[172:175], v[44:47]
    ds_read_b64_tr_b16 v[106:107], v26 offset:33280
    v_mfma_f32_16x16x32_bf16 v[48:51], v[136:139], v[168:171], v[48:51]
    ds_read_b64_tr_b16 v[108:109], v27 offset:32768
    ds_read_b64_tr_b16 v[110:111], v27 offset:33280
    v_mfma_f32_16x16x32_bf16 v[52:55], v[136:139], v[172:175], v[52:55]
    ds_read_b64_tr_b16 v[112:113], v24 offset:40960
    s_add_u32 s68, s68, 131072
    s_add_u32 m0, s69, 65536
    v_mfma_f32_16x16x32_bf16 v[56:59], v[140:143], v[168:171], v[56:59]
    ds_read_b64_tr_b16 v[114:115], v24 offset:41472
    ds_read_b64_tr_b16 v[116:117], v25 offset:40960
    buffer_load_dwordx4 v28, s[64:67], s68 offen lds
    v_mfma_f32_16x16x32_bf16 v[60:63], v[140:143], v[172:175], v[60:63]
    ds_read_b64_tr_b16 v[118:119], v25 offset:41472
    v_mfma_f32_16x16x32_bf16 v[64:67], v[144:147], v[168:171], v[64:67]
    ds_read_b64_tr_b16 v[120:121], v26 offset:40960
    ds_read_b64_tr_b16 v[122:123], v26 offset:41472
    v_mfma_f32_16x16x32_bf16 v[68:71], v[144:147], v[172:175], v[68:71]
    ds_read_b64_tr_b16 v[124:125], v27 offset:40960
    v_mfma_f32_16x16x32_bf16 v[72:75], v[148:151], v[168:171], v[72:75]
    ds_read_b64_tr_b16 v[126:127], v27 offset:41472
    buffer_load_dwordx4 v[164:167], v9, s[4:7], s80 offen offset:0 sc1
    v_mfma_f32_16x16x32_bf16 v[76:79], v[148:151], v[172:175], v[76:79]
    v_mfma_f32_16x16x32_bf16 v[80:83], v[152:155], v[168:171], v[80:83]
    v_mfma_f32_16x16x32_bf16 v[84:87], v[152:155], v[172:175], v[84:87]
    s_add_u32 m0, s69, 66560
    v_mfma_f32_16x16x32_bf16 v[88:91], v[156:159], v[168:171], v[88:91]
    buffer_load_dwordx4 v29, s[64:67], s68 offen lds
    v_mfma_f32_16x16x32_bf16 v[92:95], v[156:159], v[172:175], v[92:95]
    s_waitcnt vmcnt(9) lgkmcnt(0)
    v_mfma_f32_16x16x32_bf16 v[32:35], v[96:99], v[176:179], v[32:35]
    ds_read_b64_tr_b16 v[128:129], v24 offset:36864
    ds_read_b64_tr_b16 v[130:131], v24 offset:37376
    v_mfma_f32_16x16x32_bf16 v[36:39], v[96:99], v[180:183], v[36:39]
    ds_read_b64_tr_b16 v[132:133], v25 offset:36864
    v_mfma_f32_16x16x32_bf16 v[40:43], v[100:103], v[176:179], v[40:43]
    ds_read_b64_tr_b16 v[134:135], v25 offset:37376
    ds_read_b64_tr_b16 v[136:137], v26 offset:36864
    buffer_load_dwordx4 v[168:171], v8, s[4:7], s80 offen offset:1024 sc1
    v_mfma_f32_16x16x32_bf16 v[44:47], v[100:103], v[180:183], v[44:47]
    ds_read_b64_tr_b16 v[138:139], v26 offset:37376
    v_mfma_f32_16x16x32_bf16 v[48:51], v[104:107], v[176:179], v[48:51]
    ds_read_b64_tr_b16 v[140:141], v27 offset:36864
    ds_read_b64_tr_b16 v[142:143], v27 offset:37376
    v_mfma_f32_16x16x32_bf16 v[52:55], v[104:107], v[180:183], v[52:55]
    ds_read_b64_tr_b16 v[144:145], v24 offset:45056
    s_add_u32 m0, s69, 67584
    v_mfma_f32_16x16x32_bf16 v[56:59], v[108:111], v[176:179], v[56:59]
    ds_read_b64_tr_b16 v[146:147], v24 offset:45568
    ds_read_b64_tr_b16 v[148:149], v25 offset:45056
    buffer_load_dwordx4 v30, s[64:67], s68 offen lds
    v_mfma_f32_16x16x32_bf16 v[60:63], v[108:111], v[180:183], v[60:63]
    ds_read_b64_tr_b16 v[150:151], v25 offset:45568
    v_mfma_f32_16x16x32_bf16 v[64:67], v[112:115], v[176:179], v[64:67]
    ds_read_b64_tr_b16 v[152:153], v26 offset:45056
    ds_read_b64_tr_b16 v[154:155], v26 offset:45568
    v_mfma_f32_16x16x32_bf16 v[68:71], v[112:115], v[180:183], v[68:71]
    ds_read_b64_tr_b16 v[156:157], v27 offset:45056
    v_mfma_f32_16x16x32_bf16 v[72:75], v[116:119], v[176:179], v[72:75]
    ds_read_b64_tr_b16 v[158:159], v27 offset:45568
    buffer_load_dwordx4 v[172:175], v9, s[4:7], s80 offen offset:1024 sc1
    v_mfma_f32_16x16x32_bf16 v[76:79], v[116:119], v[180:183], v[76:79]
    v_mfma_f32_16x16x32_bf16 v[80:83], v[120:123], v[176:179], v[80:83]
    v_mfma_f32_16x16x32_bf16 v[84:87], v[120:123], v[180:183], v[84:87]
    s_add_u32 m0, s69, 68608
    v_mfma_f32_16x16x32_bf16 v[88:91], v[124:127], v[176:179], v[88:91]
    buffer_load_dwordx4 v31, s[64:67], s68 offen lds
    v_mfma_f32_16x16x32_bf16 v[92:95], v[124:127], v[180:183], v[92:95]
    s_waitcnt vmcnt(9) lgkmcnt(0)
    s_barrier
    v_mfma_f32_16x16x32_bf16 v[32:35], v[128:131], v[184:187], v[32:35]
    ds_read_b64_tr_b16 v[96:97], v20 offset:0
    ds_read_b64_tr_b16 v[98:99], v20 offset:512
    v_mfma_f32_16x16x32_bf16 v[36:39], v[128:131], v[188:191], v[36:39]
    ds_read_b64_tr_b16 v[100:101], v21 offset:0
    v_mfma_f32_16x16x32_bf16 v[40:43], v[132:135], v[184:187], v[40:43]
    ds_read_b64_tr_b16 v[102:103], v21 offset:512
    ds_read_b64_tr_b16 v[104:105], v22 offset:0
    buffer_load_dwordx4 v[176:179], v8, s[4:7], s80 offen offset:2048 sc1
    v_mfma_f32_16x16x32_bf16 v[44:47], v[132:135], v[188:191], v[44:47]
    ds_read_b64_tr_b16 v[106:107], v22 offset:512
    v_mfma_f32_16x16x32_bf16 v[48:51], v[136:139], v[184:187], v[48:51]
    ds_read_b64_tr_b16 v[108:109], v23 offset:0
    ds_read_b64_tr_b16 v[110:111], v23 offset:512
    v_mfma_f32_16x16x32_bf16 v[52:55], v[136:139], v[188:191], v[52:55]
    ds_read_b64_tr_b16 v[112:113], v20 offset:8192
    s_add_u32 s68, s68, 131072
    s_add_u32 m0, s69, 98304
    v_mfma_f32_16x16x32_bf16 v[56:59], v[140:143], v[184:187], v[56:59]
    ds_read_b64_tr_b16 v[114:115], v20 offset:8704
    ds_read_b64_tr_b16 v[116:117], v21 offset:8192
    buffer_load_dwordx4 v28, s[64:67], s68 offen lds
    v_mfma_f32_16x16x32_bf16 v[60:63], v[140:143], v[188:191], v[60:63]
    ds_read_b64_tr_b16 v[118:119], v21 offset:8704
    v_mfma_f32_16x16x32_bf16 v[64:67], v[144:147], v[184:187], v[64:67]
    ds_read_b64_tr_b16 v[120:121], v22 offset:8192
    ds_read_b64_tr_b16 v[122:123], v22 offset:8704
    v_mfma_f32_16x16x32_bf16 v[68:71], v[144:147], v[188:191], v[68:71]
    ds_read_b64_tr_b16 v[124:125], v23 offset:8192
    v_mfma_f32_16x16x32_bf16 v[72:75], v[148:151], v[184:187], v[72:75]
    ds_read_b64_tr_b16 v[126:127], v23 offset:8704
    buffer_load_dwordx4 v[180:183], v9, s[4:7], s80 offen offset:2048 sc1
    v_mfma_f32_16x16x32_bf16 v[76:79], v[148:151], v[188:191], v[76:79]
    v_mfma_f32_16x16x32_bf16 v[80:83], v[152:155], v[184:187], v[80:83]
    v_mfma_f32_16x16x32_bf16 v[84:87], v[152:155], v[188:191], v[84:87]
    s_add_u32 m0, s69, 99328
    v_mfma_f32_16x16x32_bf16 v[88:91], v[156:159], v[184:187], v[88:91]
    buffer_load_dwordx4 v29, s[64:67], s68 offen lds
    v_mfma_f32_16x16x32_bf16 v[92:95], v[156:159], v[188:191], v[92:95]
    s_sub_u32 s82, s82, 1
    s_cmp_lg_u32 s82, 0
    s_cbranch_scc1 kfo_loop_7
    s_waitcnt vmcnt(9) lgkmcnt(0)
    v_mfma_f32_16x16x32_bf16 v[32:35], v[96:99], v[160:163], v[32:35]
    ds_read_b64_tr_b16 v[128:129], v20 offset:4096
    ds_read_b64_tr_b16 v[130:131], v20 offset:4608
    v_mfma_f32_16x16x32_bf16 v[36:39], v[96:99], v[164:167], v[36:39]
    ds_read_b64_tr_b16 v[132:133], v21 offset:4096
    v_mfma_f32_16x16x32_bf16 v[40:43], v[100:103], v[160:163], v[40:43]
    ds_read_b64_tr_b16 v[134:135], v21 offset:4608
    ds_read_b64_tr_b16 v[136:137], v22 offset:4096
    buffer_load_dwordx4 v[184:187], v8, s[4:7], s80 offen offset:3072 sc1
    v_mfma_f32_16x16x32_bf16 v[44:47], v[100:103], v[164:167], v[44:47]
    ds_read_b64_tr_b16 v[138:139], v22 offset:4608
    v_mfma_f32_16x16x32_bf16 v[48:51], v[104:107], v[160:163], v[48:51]
    ds_read_b64_tr_b16 v[140:141], v23 offset:4096
    ds_read_b64_tr_b16 v[142:143], v23 offset:4608
    v_mfma_f32_16x16x32_bf16 v[52:55], v[104:107], v[164:167], v[52:55]
    ds_read_b64_tr_b16 v[144:145], v20 offset:12288
    s_add_u32 m0, s69, 100352
    v_mfma_f32_16x16x32_bf16 v[56:59], v[108:111], v[160:163], v[56:59]
    ds_read_b64_tr_b16 v[146:147], v20 offset:12800
    ds_read_b64_tr_b16 v[148:149], v21 offset:12288
    buffer_load_dwordx4 v30, s[64:67], s68 offen lds
    v_mfma_f32_16x16x32_bf16 v[60:63], v[108:111], v[164:167], v[60:63]
    ds_read_b64_tr_b16 v[150:151], v21 offset:12800
    v_mfma_f32_16x16x32_bf16 v[64:67], v[112:115], v[160:163], v[64:67]
    ds_read_b64_tr_b16 v[152:153], v22 offset:12288
    ds_read_b64_tr_b16 v[154:155], v22 offset:12800
    v_mfma_f32_16x16x32_bf16 v[68:71], v[112:115], v[164:167], v[68:71]
    ds_read_b64_tr_b16 v[156:157], v23 offset:12288
    v_mfma_f32_16x16x32_bf16 v[72:75], v[116:119], v[160:163], v[72:75]
    ds_read_b64_tr_b16 v[158:159], v23 offset:12800
    buffer_load_dwordx4 v[188:191], v9, s[4:7], s80 offen offset:3072 sc1
    v_mfma_f32_16x16x32_bf16 v[76:79], v[116:119], v[164:167], v[76:79]
    v_mfma_f32_16x16x32_bf16 v[80:83], v[120:123], v[160:163], v[80:83]
    v_mfma_f32_16x16x32_bf16 v[84:87], v[120:123], v[164:167], v[84:87]
    s_add_u32 m0, s69, 101376
    v_mfma_f32_16x16x32_bf16 v[88:91], v[124:127], v[160:163], v[88:91]
    buffer_load_dwordx4 v31, s[64:67], s68 offen lds
    v_mfma_f32_16x16x32_bf16 v[92:95], v[124:127], v[164:167], v[92:95]
    s_waitcnt vmcnt(9) lgkmcnt(0)
    s_barrier
    v_mfma_f32_16x16x32_bf16 v[32:35], v[128:131], v[168:171], v[32:35]
    ds_read_b64_tr_b16 v[96:97], v20 offset:32768
    ds_read_b64_tr_b16 v[98:99], v20 offset:33280
    v_mfma_f32_16x16x32_bf16 v[36:39], v[128:131], v[172:175], v[36:39]
    ds_read_b64_tr_b16 v[100:101], v21 offset:32768
    v_mfma_f32_16x16x32_bf16 v[40:43], v[132:135], v[168:171], v[40:43]
    ds_read_b64_tr_b16 v[102:103], v21 offset:33280
    ds_read_b64_tr_b16 v[104:105], v22 offset:32768
    v_mfma_f32_16x16x32_bf16 v[44:47], v[132:135], v[172:175], v[44:47]
    ds_read_b64_tr_b16 v[106:107], v22 offset:33280
    s_add_u32 s80, s80, 4096
    v_mfma_f32_16x16x32_bf16 v[48:51], v[136:139], v[168:171], v[48:51]
    ds_read_b64_tr_b16 v[108:109], v23 offset:32768
    ds_read_b64_tr_b16 v[110:111], v23 offset:33280
    buffer_load_dwordx4 v[160:163], v8, s[4:7], s80 offen offset:0 sc1
    v_mfma_f32_16x16x32_bf16 v[52:55], v[136:139], v[172:175], v[52:55]
    ds_read_b64_tr_b16 v[112:113], v20 offset:40960
    v_mfma_f32_16x16x32_bf16 v[56:59], v[140:143], v[168:171], v[56:59]
    ds_read_b64_tr_b16 v[114:115], v20 offset:41472
    ds_read_b64_tr_b16 v[116:117], v21 offset:40960
    v_mfma_f32_16x16x32_bf16 v[60:63], v[140:143], v[172:175], v[60:63]
    ds_read_b64_tr_b16 v[118:119], v21 offset:41472
    v_mfma_f32_16x16x32_bf16 v[64:67], v[144:147], v[168:171], v[64:67]
    ds_read_b64_tr_b16 v[120:121], v22 offset:40960
    ds_read_b64_tr_b16 v[122:123], v22 offset:41472
    v_mfma_f32_16x16x32_bf16 v[68:71], v[144:147], v[172:175], v[68:71]
    ds_read_b64_tr_b16 v[124:125], v23 offset:40960
    v_mfma_f32_16x16x32_bf16 v[72:75], v[148:151], v[168:171], v[72:75]
    ds_read_b64_tr_b16 v[126:127], v23 offset:41472
    v_mfma_f32_16x16x32_bf16 v[76:79], v[148:151], v[172:175], v[76:79]
    v_mfma_f32_16x16x32_bf16 v[80:83], v[152:155], v[168:171], v[80:83]
    buffer_load_dwordx4 v[164:167], v9, s[4:7], s80 offen offset:0 sc1
    v_mfma_f32_16x16x32_bf16 v[84:87], v[152:155], v[172:175], v[84:87]
    v_mfma_f32_16x16x32_bf16 v[88:91], v[156:159], v[168:171], v[88:91]
    v_mfma_f32_16x16x32_bf16 v[92:95], v[156:159], v[172:175], v[92:95]
    s_waitcnt vmcnt(7) lgkmcnt(0)
    v_mfma_f32_16x16x32_bf16 v[32:35], v[96:99], v[176:179], v[32:35]
    ds_read_b64_tr_b16 v[128:129], v20 offset:36864
    ds_read_b64_tr_b16 v[130:131], v20 offset:37376
    v_mfma_f32_16x16x32_bf16 v[36:39], v[96:99], v[180:183], v[36:39]
    ds_read_b64_tr_b16 v[132:133], v21 offset:36864
    v_mfma_f32_16x16x32_bf16 v[40:43], v[100:103], v[176:179], v[40:43]
    ds_read_b64_tr_b16 v[134:135], v21 offset:37376
    ds_read_b64_tr_b16 v[136:137], v22 offset:36864
    v_mfma_f32_16x16x32_bf16 v[44:47], v[100:103], v[180:183], v[44:47]
    ds_read_b64_tr_b16 v[138:139], v22 offset:37376
    v_mfma_f32_16x16x32_bf16 v[48:51], v[104:107], v[176:179], v[48:51]
    ds_read_b64_tr_b16 v[140:141], v23 offset:36864
    ds_read_b64_tr_b16 v[142:143], v23 offset:37376
    buffer_load_dwordx4 v[168:171], v8, s[4:7], s80 offen offset:1024 sc1
    v_mfma_f32_16x16x32_bf16 v[52:55], v[104:107], v[180:183], v[52:55]
    ds_read_b64_tr_b16 v[144:145], v20 offset:45056
    v_mfma_f32_16x16x32_bf16 v[56:59], v[108:111], v[176:179], v[56:59]
    ds_read_b64_tr_b16 v[146:147], v20 offset:45568
    ds_read_b64_tr_b16 v[148:149], v21 offset:45056
    v_mfma_f32_16x16x32_bf16 v[60:63], v[108:111], v[180:183], v[60:63]
    ds_read_b64_tr_b16 v[150:151], v21 offset:45568
    v_mfma_f32_16x16x32_bf16 v[64:67], v[112:115], v[176:179], v[64:67]
    ds_read_b64_tr_b16 v[152:153], v22 offset:45056
    ds_read_b64_tr_b16 v[154:155], v22 offset:45568
    v_mfma_f32_16x16x32_bf16 v[68:71], v[112:115], v[180:183], v[68:71]
    ds_read_b64_tr_b16 v[156:157], v23 offset:45056
    v_mfma_f32_16x16x32_bf16 v[72:75], v[116:119], v[176:179], v[72:75]
    ds_read_b64_tr_b16 v[158:159], v23 offset:45568
    v_mfma_f32_16x16x32_bf16 v[76:79], v[116:119], v[180:183], v[76:79]
    v_mfma_f32_16x16x32_bf16 v[80:83], v[120:123], v[176:179], v[80:83]
    buffer_load_dwordx4 v[172:175], v9, s[4:7], s80 offen offset:1024 sc1
    v_mfma_f32_16x16x32_bf16 v[84:87], v[120:123], v[180:183], v[84:87]
    v_mfma_f32_16x16x32_bf16 v[88:91], v[124:127], v[176:179], v[88:91]
    v_mfma_f32_16x16x32_bf16 v[92:95], v[124:127], v[180:183], v[92:95]
    s_waitcnt vmcnt(5) lgkmcnt(0)
    s_barrier
    v_mfma_f32_16x16x32_bf16 v[32:35], v[128:131], v[184:187], v[32:35]
    ds_read_b64_tr_b16 v[96:97], v24 offset:0
    ds_read_b64_tr_b16 v[98:99], v24 offset:512
    v_mfma_f32_16x16x32_bf16 v[36:39], v[128:131], v[188:191], v[36:39]
    ds_read_b64_tr_b16 v[100:101], v25 offset:0
    v_mfma_f32_16x16x32_bf16 v[40:43], v[132:135], v[184:187], v[40:43]
    ds_read_b64_tr_b16 v[102:103], v25 offset:512
    ds_read_b64_tr_b16 v[104:105], v26 offset:0
    v_mfma_f32_16x16x32_bf16 v[44:47], v[132:135], v[188:191], v[44:47]
    ds_read_b64_tr_b16 v[106:107], v26 offset:512
    v_mfma_f32_16x16x32_bf16 v[48:51], v[136:139], v[184:187], v[48:51]
    ds_read_b64_tr_b16 v[108:109], v27 offset:0
    ds_read_b64_tr_b16 v[110:111], v27 offset:512
    buffer_load_dwordx4 v[176:179], v8, s[4:7], s80 offen offset:2048 sc1
    v_mfma_f32_16x16x32_bf16 v[52:55], v[136:139], v[188:191], v[52:55]
    ds_read_b64_tr_b16 v[112:113], v24 offset:8192
    v_mfma_f32_16x16x32_bf16 v[56:59], v[140:143], v[184:187], v[56:59]
    ds_read_b64_tr_b16 v[114:115], v24 offset:8704
    ds_read_b64_tr_b16 v[116:117], v25 offset:8192
    v_mfma_f32_16x16x32_bf16 v[60:63], v[140:143], v[188:191], v[60:63]
    ds_read_b64_tr_b16 v[118:119], v25 offset:8704
    v_mfma_f32_16x16x32_bf16 v[64:67], v[144:147], v[184:187], v[64:67]
    ds_read_b64_tr_b16 v[120:121], v26 offset:8192
    ds_read_b64_tr_b16 v[122:123], v26 offset:8704
    v_mfma_f32_16x16x32_bf16 v[68:71], v[144:147], v[188:191], v[68:71]
    ds_read_b64_tr_b16 v[124:125], v27 offset:8192
    v_mfma_f32_16x16x32_bf16 v[72:75], v[148:151], v[184:187], v[72:75]
    ds_read_b64_tr_b16 v[126:127], v27 offset:8704
    v_mfma_f32_16x16x32_bf16 v[76:79], v[148:151], v[188:191], v[76:79]
    v_mfma_f32_16x16x32_bf16 v[80:83], v[152:155], v[184:187], v[80:83]
    buffer_load_dwordx4 v[180:183], v9, s[4:7], s80 offen offset:2048 sc1
    v_mfma_f32_16x16x32_bf16 v[84:87], v[152:155], v[188:191], v[84:87]
    v_mfma_f32_16x16x32_bf16 v[88:91], v[156:159], v[184:187], v[88:91]
    v_mfma_f32_16x16x32_bf16 v[92:95], v[156:159], v[188:191], v[92:95]
    s_waitcnt vmcnt(4) lgkmcnt(0)
    v_mfma_f32_16x16x32_bf16 v[32:35], v[96:99], v[160:163], v[32:35]
    ds_read_b64_tr_b16 v[128:129], v24 offset:4096
    ds_read_b64_tr_b16 v[130:131], v24 offset:4608
    v_mfma_f32_16x16x32_bf16 v[36:39], v[96:99], v[164:167], v[36:39]
    ds_read_b64_tr_b16 v[132:133], v25 offset:4096
    v_mfma_f32_16x16x32_bf16 v[40:43], v[100:103], v[160:163], v[40:43]
    ds_read_b64_tr_b16 v[134:135], v25 offset:4608
    ds_read_b64_tr_b16 v[136:137], v26 offset:4096
    v_mfma_f32_16x16x32_bf16 v[44:47], v[100:103], v[164:167], v[44:47]
    ds_read_b64_tr_b16 v[138:139], v26 offset:4608
    v_mfma_f32_16x16x32_bf16 v[48:51], v[104:107], v[160:163], v[48:51]
    ds_read_b64_tr_b16 v[140:141], v27 offset:4096
    ds_read_b64_tr_b16 v[142:143], v27 offset:4608
    buffer_load_dwordx4 v[184:187], v8, s[4:7], s80 offen offset:3072 sc1
    v_mfma_f32_16x16x32_bf16 v[52:55], v[104:107], v[164:167], v[52:55]
    ds_read_b64_tr_b16 v[144:145], v24 offset:12288
    v_mfma_f32_16x16x32_bf16 v[56:59], v[108:111], v[160:163], v[56:59]
    ds_read_b64_tr_b16 v[146:147], v24 offset:12800
    ds_read_b64_tr_b16 v[148:149], v25 offset:12288
    v_mfma_f32_16x16x32_bf16 v[60:63], v[108:111], v[164:167], v[60:63]
    ds_read_b64_tr_b16 v[150:151], v25 offset:12800
    v_mfma_f32_16x16x32_bf16 v[64:67], v[112:115], v[160:163], v[64:67]
    ds_read_b64_tr_b16 v[152:153], v26 offset:12288
    ds_read_b64_tr_b16 v[154:155], v26 offset:12800
    v_mfma_f32_16x16x32_bf16 v[68:71], v[112:115], v[164:167], v[68:71]
    ds_read_b64_tr_b16 v[156:157], v27 offset:12288
    v_mfma_f32_16x16x32_bf16 v[72:75], v[116:119], v[160:163], v[72:75]
    ds_read_b64_tr_b16 v[158:159], v27 offset:12800
    v_mfma_f32_16x16x32_bf16 v[76:79], v[116:119], v[164:167], v[76:79]
    v_mfma_f32_16x16x32_bf16 v[80:83], v[120:123], v[160:163], v[80:83]
    buffer_load_dwordx4 v[188:191], v9, s[4:7], s80 offen offset:3072 sc1
    v_mfma_f32_16x16x32_bf16 v[84:87], v[120:123], v[164:167], v[84:87]
    v_mfma_f32_16x16x32_bf16 v[88:91], v[124:127], v[160:163], v[88:91]
    v_mfma_f32_16x16x32_bf16 v[92:95], v[124:127], v[164:167], v[92:95]
    s_waitcnt vmcnt(4) lgkmcnt(0)
    s_barrier
    v_mfma_f32_16x16x32_bf16 v[32:35], v[128:131], v[168:171], v[32:35]
    ds_read_b64_tr_b16 v[96:97], v24 offset:32768
    ds_read_b64_tr_b16 v[98:99], v24 offset:33280
    v_mfma_f32_16x16x32_bf16 v[36:39], v[128:131], v[172:175], v[36:39]
    ds_read_b64_tr_b16 v[100:101], v25 offset:32768
    v_mfma_f32_16x16x32_bf16 v[40:43], v[132:135], v[168:171], v[40:43]
    ds_read_b64_tr_b16 v[102:103], v25 offset:33280
    ds_read_b64_tr_b16 v[104:105], v26 offset:32768
    v_mfma_f32_16x16x32_bf16 v[44:47], v[132:135], v[172:175], v[44:47]
    ds_read_b64_tr_b16 v[106:107], v26 offset:33280
    v_mfma_f32_16x16x32_bf16 v[48:51], v[136:139], v[168:171], v[48:51]
    ds_read_b64_tr_b16 v[108:109], v27 offset:32768
    ds_read_b64_tr_b16 v[110:111], v27 offset:33280
    v_mfma_f32_16x16x32_bf16 v[52:55], v[136:139], v[172:175], v[52:55]
    ds_read_b64_tr_b16 v[112:113], v24 offset:40960
    v_mfma_f32_16x16x32_bf16 v[56:59], v[140:143], v[168:171], v[56:59]
    ds_read_b64_tr_b16 v[114:115], v24 offset:41472
    ds_read_b64_tr_b16 v[116:117], v25 offset:40960
    v_mfma_f32_16x16x32_bf16 v[60:63], v[140:143], v[172:175], v[60:63]
    ds_read_b64_tr_b16 v[118:119], v25 offset:41472
    v_mfma_f32_16x16x32_bf16 v[64:67], v[144:147], v[168:171], v[64:67]
    ds_read_b64_tr_b16 v[120:121], v26 offset:40960
    ds_read_b64_tr_b16 v[122:123], v26 offset:41472
    v_mfma_f32_16x16x32_bf16 v[68:71], v[144:147], v[172:175], v[68:71]
    ds_read_b64_tr_b16 v[124:125], v27 offset:40960
    v_mfma_f32_16x16x32_bf16 v[72:75], v[148:151], v[168:171], v[72:75]
    ds_read_b64_tr_b16 v[126:127], v27 offset:41472
    v_mfma_f32_16x16x32_bf16 v[76:79], v[148:151], v[172:175], v[76:79]
    v_mfma_f32_16x16x32_bf16 v[80:83], v[152:155], v[168:171], v[80:83]
    v_mfma_f32_16x16x32_bf16 v[84:87], v[152:155], v[172:175], v[84:87]
    v_mfma_f32_16x16x32_bf16 v[88:91], v[156:159], v[168:171], v[88:91]
    v_mfma_f32_16x16x32_bf16 v[92:95], v[156:159], v[172:175], v[92:95]
    s_waitcnt vmcnt(2) lgkmcnt(0)
    v_mfma_f32_16x16x32_bf16 v[32:35], v[96:99], v[176:179], v[32:35]
    ds_read_b64_tr_b16 v[128:129], v24 offset:36864
    ds_read_b64_tr_b16 v[130:131], v24 offset:37376
    v_mfma_f32_16x16x32_bf16 v[36:39], v[96:99], v[180:183], v[36:39]
    ds_read_b64_tr_b16 v[132:133], v25 offset:36864
    v_mfma_f32_16x16x32_bf16 v[40:43], v[100:103], v[176:179], v[40:43]
    ds_read_b64_tr_b16 v[134:135], v25 offset:37376
    ds_read_b64_tr_b16 v[136:137], v26 offset:36864
    v_mfma_f32_16x16x32_bf16 v[44:47], v[100:103], v[180:183], v[44:47]
    ds_read_b64_tr_b16 v[138:139], v26 offset:37376
    v_mfma_f32_16x16x32_bf16 v[48:51], v[104:107], v[176:179], v[48:51]
    ds_read_b64_tr_b16 v[140:141], v27 offset:36864
    ds_read_b64_tr_b16 v[142:143], v27 offset:37376
    v_mfma_f32_16x16x32_bf16 v[52:55], v[104:107], v[180:183], v[52:55]
    ds_read_b64_tr_b16 v[144:145], v24 offset:45056
    v_mfma_f32_16x16x32_bf16 v[56:59], v[108:111], v[176:179], v[56:59]
    ds_read_b64_tr_b16 v[146:147], v24 offset:45568
    ds_read_b64_tr_b16 v[148:149], v25 offset:45056
    v_mfma_f32_16x16x32_bf16 v[60:63], v[108:111], v[180:183], v[60:63]
    ds_read_b64_tr_b16 v[150:151], v25 offset:45568
    v_mfma_f32_16x16x32_bf16 v[64:67], v[112:115], v[176:179], v[64:67]
    ds_read_b64_tr_b16 v[152:153], v26 offset:45056
    ds_read_b64_tr_b16 v[154:155], v26 offset:45568
    v_mfma_f32_16x16x32_bf16 v[68:71], v[112:115], v[180:183], v[68:71]
    ds_read_b64_tr_b16 v[156:157], v27 offset:45056
    v_mfma_f32_16x16x32_bf16 v[72:75], v[116:119], v[176:179], v[72:75]
    ds_read_b64_tr_b16 v[158:159], v27 offset:45568
    v_mfma_f32_16x16x32_bf16 v[76:79], v[116:119], v[180:183], v[76:79]
    v_mfma_f32_16x16x32_bf16 v[80:83], v[120:123], v[176:179], v[80:83]
    v_mfma_f32_16x16x32_bf16 v[84:87], v[120:123], v[180:183], v[84:87]
    v_mfma_f32_16x16x32_bf16 v[88:91], v[124:127], v[176:179], v[88:91]
    v_mfma_f32_16x16x32_bf16 v[92:95], v[124:127], v[180:183], v[92:95]
    s_waitcnt vmcnt(0) lgkmcnt(0)
    v_mfma_f32_16x16x32_bf16 v[32:35], v[128:131], v[184:187], v[32:35]
    v_mfma_f32_16x16x32_bf16 v[36:39], v[128:131], v[188:191], v[36:39]
    v_mfma_f32_16x16x32_bf16 v[40:43], v[132:135], v[184:187], v[40:43]
    v_mfma_f32_16x16x32_bf16 v[44:47], v[132:135], v[188:191], v[44:47]
    v_mfma_f32_16x16x32_bf16 v[48:51], v[136:139], v[184:187], v[48:51]
    v_mfma_f32_16x16x32_bf16 v[52:55], v[136:139], v[188:191], v[52:55]
    v_mfma_f32_16x16x32_bf16 v[56:59], v[140:143], v[184:187], v[56:59]
    v_mfma_f32_16x16x32_bf16 v[60:63], v[140:143], v[188:191], v[60:63]
    v_mfma_f32_16x16x32_bf16 v[64:67], v[144:147], v[184:187], v[64:67]
    v_mfma_f32_16x16x32_bf16 v[68:71], v[144:147], v[188:191], v[68:71]
    v_mfma_f32_16x16x32_bf16 v[72:75], v[148:151], v[184:187], v[72:75]
    v_mfma_f32_16x16x32_bf16 v[76:79], v[148:151], v[188:191], v[76:79]
    v_mfma_f32_16x16x32_bf16 v[80:83], v[152:155], v[184:187], v[80:83]
    v_mfma_f32_16x16x32_bf16 v[84:87], v[152:155], v[188:191], v[84:87]
    v_mfma_f32_16x16x32_bf16 v[88:91], v[156:159], v[184:187], v[88:91]
    v_mfma_f32_16x16x32_bf16 v[92:95], v[156:159], v[188:191], v[92:95]
    s_lshl_b32 s86, s72, 4
    s_lshl_b32 s87, s76, 1
    s_add_u32 s86, s86, s87
    s_lshl_b32 s60, s86, 10
    s_mov_b32 s61, 1024
    s_mov_b32 s62, 8192
    s_mov_b32 s63, 9216
    s_lshl_b32 s86, s76, 16
    s_lshl_b32 s87, s72, 7
    s_add_u32 s56, s86, s87
    s_mov_b32 s57, 32768
    s_mov_b32 s58, 64
    s_mov_b32 s59, 32832
    s_mov_b32 s52, 33554432
    s_mov_b32 s53, 29360128
    s_mov_b32 s4, s16
    s_mov_b32 s5, s17
    s_mov_b32 s6, 4194304
    s_mov_b32 s7, 0x20000
    s_mov_b32 s64, s36
    s_mov_b32 s65, s37
    s_mov_b32 s66, 4194304
    s_mov_b32 s67, 0x20000
    s_add_u32 s8, s40, s52
    s_addc_u32 s9, s41, 0
    s_mov_b32 s10, 4194304
    s_mov_b32 s11, 0x20000
    s_add_u32 s44, s40, s53
    s_addc_u32 s45, s41, 0
    s_mov_b32 s46, 4194304
    s_mov_b32 s47, 0x20000
    s_lshl_b32 s86, s77, 7
    s_add_u32 s86, s86, 16384
    s_lshl_b32 s87, s75, 6
    s_add_u32 s86, s86, s87
    v_mov_b32 v204, s86
    v_xor_b32 v205, 64, v204
    v_mov_b32 v206, 65536
    s_cmp_lg_u32 s3, 0
    s_cbranch_scc1 fs_8
    buffer_load_dwordx2 v[200:201], v205, s[48:51], 0 offen sc1
fs_8:
    v_lshrrev_b32 v2, 4, v1
    v_and_b32 v3, 1, v2
    v_lshlrev_b32 v3, 5, v3
    v_lshrrev_b32 v2, 1, v2
    v_lshl_add_u32 v3, v2, 4, v3
    v_and_b32 v2, 15, v1
    v_lshl_add_u32 v3, v2, 11, v3
    s_lshl_b32 s86, s71, 18
    s_lshl_b32 s87, s70, 8
    s_add_u32 s86, s86, s87
    s_add_u32 s86, s86, s56
    v_add_u32 v202, s86, v3
    s_lshl_b32 s86, s77, 15
    s_add_u32 s86, s86, s60
    v_lshlrev_b32 v2, 4, v1
    v_add_u32 v203, s86, v2
    buffer_load_dwordx4 v[160:163], v202, s[4:7], 0 offen
    buffer_load_dwordx4 v[164:167], v202, s[4:7], s57 offen
    buffer_load_dwordx4 v[168:171], v202, s[4:7], s58 offen
    buffer_load_dwordx4 v[172:175], v202, s[4:7], s59 offen
    s_mov_b32 s12, s34
    s_mov_b32 s13, s35
    s_mov_b32 s14, 2048
    s_mov_b32 s15, 0x20000
    v_lshrrev_b32 v2, 4, v1
    v_lshlrev_b32 v2, 3, v2
    s_lshl_b32 s86, s70, 8
    s_lshl_b32 s87, s72, 7
    s_add_u32 s86, s86, s87
    v_add_u32 v2, s86, v2
    buffer_load_dwordx2 v[8:9], v2, s[12:15], 0 offen offset:0
    buffer_load_dwordx2 v[10:11], v2, s[12:15], 0 offen offset:32
    buffer_load_dwordx2 v[12:13], v2, s[12:15], 0 offen offset:64
    buffer_load_dwordx2 v[14:15], v2, s[12:15], 0 offen offset:96
    v_lshlrev_b32 v2, 4, v1
    s_lshl_b32 s86, s3, 13
    v_add_u32 v3, s86, v2
    s_xor_b32 s86, s86, 32768
    v_add_u32 v2, s86, v2
    s_barrier
    ds_write_b128 v3, v[64:67] offset:0
    ds_write_b128 v3, v[68:71] offset:1024
    ds_write_b128 v3, v[72:75] offset:2048
    ds_write_b128 v3, v[76:79] offset:3072
    ds_write_b128 v3, v[80:83] offset:4096
    ds_write_b128 v3, v[84:87] offset:5120
    ds_write_b128 v3, v[88:91] offset:6144
    ds_write_b128 v3, v[92:95] offset:7168
    s_cmp_lg_u32 s3, 0
    s_cbranch_scc1 dw_9
    s_waitcnt vmcnt(8)
    v_cmp_eq_u64 vcc, s[78:79], v[200:201]
    s_nop 1
    v_cndmask_b32 v200, 0, 1, vcc
    ds_write_b32 v206, v200
dw_9:
    s_waitcnt vmcnt(0) lgkmcnt(0)
    s_barrier
    ds_read_b128 v[64:67], v2 offset:0
    ds_read_b128 v[68:71], v2 offset:1024
    ds_read_b128 v[72:75], v2 offset:2048
    ds_read_b128 v[76:79], v2 offset:3072
    ds_read_b128 v[80:83], v2 offset:4096
    ds_read_b128 v[84:87], v2 offset:5120
    ds_read_b128 v[88:91], v2 offset:6144
    ds_read_b128 v[92:95], v2 offset:7168
    s_mov_b32 s92, 0xbfb8aa3b
    ds_read_b32 v200, v206
    s_waitcnt lgkmcnt(0)
    v_readfirstlane_b32 s55, v200
    s_cmp_eq_u32 s55, 0
    s_cbranch_scc1 dr_10
    buffer_load_dwordx4 v[176:179], v203, s[44:47], 0 offen sc1
    buffer_load_dwordx4 v[180:183], v203, s[44:47], s61 offen sc1
    buffer_load_dwordx4 v[184:187], v203, s[44:47], s62 offen sc1
    buffer_load_dwordx4 v[188:191], v203, s[44:47], s63 offen sc1
dr_10:
    v_add_f32 v96, v32, v64
    v_add_f32 v97, v33, v65
    v_add_f32 v98, v34, v66
    v_add_f32 v99, v35, v67
    v_add_f32 v100, v36, v68
    v_add_f32 v101, v37, v69
    v_add_f32 v102, v38, v70
    v_add_f32 v103, v39, v71
    v_add_f32 v104, v40, v72
    v_add_f32 v105, v41, v73
    v_add_f32 v106, v42, v74
    v_add_f32 v107, v43, v75
    v_add_f32 v108, v44, v76
    v_add_f32 v109, v45, v77
    v_add_f32 v110, v46, v78
    v_add_f32 v111, v47, v79
    v_add_f32 v112, v48, v80
    v_add_f32 v113, v49, v81
    v_add_f32 v114, v50, v82
    v_add_f32 v115, v51, v83
    v_add_f32 v116, v52, v84
    v_add_f32 v117, v53, v85
    v_add_f32 v118, v54, v86
    v_add_f32 v119, v55, v87
    v_add_f32 v120, v56, v88
    v_add_f32 v121, v57, v89
    v_add_f32 v122, v58, v90
    v_add_f32 v123, v59, v91
    v_add_f32 v124, v60, v92
    v_add_f32 v125, v61, v93
    v_add_f32 v126, v62, v94
    v_add_f32 v127, v63, v95
    v_lshlrev_b32 v16, 16, v8
    v_and_b32 v17, 0xffff0000, v8
    v_lshlrev_b32 v18, 16, v9
    v_and_b32 v19, 0xffff0000, v9
    v_lshlrev_b32 v20, 16, v10
    v_and_b32 v21, 0xffff0000, v10
    v_lshlrev_b32 v22, 16, v11
    v_and_b32 v23, 0xffff0000, v11
    v_lshlrev_b32 v24, 16, v12
    v_and_b32 v25, 0xffff0000, v12
    v_lshlrev_b32 v26, 16, v13
    v_and_b32 v27, 0xffff0000, v13
    v_lshlrev_b32 v28, 16, v14
    v_and_b32 v29, 0xffff0000, v14
    v_lshlrev_b32 v30, 16, v15
    v_and_b32 v31, 0xffff0000, v15
    v_cvt_pk_bf16_f32 v32, v96, v97
    v_cvt_pk_bf16_f32 v33, v98, v99
    v_cvt_pk_bf16_f32 v34, v104, v105
    v_cvt_pk_bf16_f32 v35, v106, v107
    v_cvt_pk_bf16_f32 v36, v100, v101
    v_cvt_pk_bf16_f32 v37, v102, v103
    v_cvt_pk_bf16_f32 v38, v108, v109
    v_cvt_pk_bf16_f32 v39, v110, v111
    v_lshlrev_b32 v64, 16, v32
    v_and_b32 v65, 0xffff0000, v32
    v_lshlrev_b32 v66, 16, v33
    v_and_b32 v67, 0xffff0000, v33
    v_lshlrev_b32 v68, 16, v34
    v_and_b32 v69, 0xffff0000, v34
    v_lshlrev_b32 v70, 16, v35
    v_and_b32 v71, 0xffff0000, v35
    v_lshlrev_b32 v72, 16, v36
    v_and_b32 v73, 0xffff0000, v36
    v_lshlrev_b32 v74, 16, v37
    v_and_b32 v75, 0xffff0000, v37
    v_lshlrev_b32 v76, 16, v38
    v_and_b32 v77, 0xffff0000, v38
    v_lshlrev_b32 v78, 16, v39
    v_and_b32 v79, 0xffff0000, v39
    v_add_f32 v64, v64, v16
    v_add_f32 v65, v65, v17
    v_add_f32 v66, v66, v18
    v_add_f32 v67, v67, v19
    v_add_f32 v68, v68, v20
    v_add_f32 v69, v69, v21
    v_add_f32 v70, v70, v22
    v_add_f32 v71, v71, v23
    v_add_f32 v72, v72, v16
    v_add_f32 v73, v73, v17
    v_add_f32 v74, v74, v18
    v_add_f32 v75, v75, v19
    v_add_f32 v76, v76, v20
    v_add_f32 v77, v77, v21
    v_add_f32 v78, v78, v22
    v_add_f32 v79, v79, v23
    v_cvt_pk_bf16_f32 v32, v64, v65
    v_cvt_pk_bf16_f32 v33, v66, v67
    v_cvt_pk_bf16_f32 v34, v68, v69
    v_cvt_pk_bf16_f32 v35, v70, v71
    v_cvt_pk_bf16_f32 v36, v72, v73
    v_cvt_pk_bf16_f32 v37, v74, v75
    v_cvt_pk_bf16_f32 v38, v76, v77
    v_cvt_pk_bf16_f32 v39, v78, v79
    v_lshlrev_b32 v64, 16, v32
    v_and_b32 v65, 0xffff0000, v32
    v_lshlrev_b32 v66, 16, v33
    v_and_b32 v67, 0xffff0000, v33
    v_lshlrev_b32 v68, 16, v34
    v_and_b32 v69, 0xffff0000, v34
    v_lshlrev_b32 v70, 16, v35
    v_and_b32 v71, 0xffff0000, v35
    v_lshlrev_b32 v72, 16, v36
    v_and_b32 v73, 0xffff0000, v36
    v_lshlrev_b32 v74, 16, v37
    v_and_b32 v75, 0xffff0000, v37
    v_lshlrev_b32 v76, 16, v38
    v_and_b32 v77, 0xffff0000, v38
    v_lshlrev_b32 v78, 16, v39
    v_and_b32 v79, 0xffff0000, v39
    v_mul_f32 v80, s92, v64
    v_mul_f32 v81, s92, v65
    v_mul_f32 v82, s92, v66
    v_mul_f32 v83, s92, v67
    v_mul_f32 v84, s92, v68
    v_mul_f32 v85, s92, v69
    v_mul_f32 v86, s92, v70
    v_mul_f32 v87, s92, v71
    v_mul_f32 v88, s92, v72
    v_mul_f32 v89, s92, v73
    v_mul_f32 v90, s92, v74
    v_mul_f32 v91, s92, v75
    v_mul_f32 v92, s92, v76
    v_mul_f32 v93, s92, v77
    v_mul_f32 v94, s92, v78
    v_mul_f32 v95, s92, v79
    v_exp_f32 v80, v80
    v_exp_f32 v81, v81
    v_exp_f32 v82, v82
    v_exp_f32 v83, v83
    v_exp_f32 v84, v84
    v_exp_f32 v85, v85
    v_exp_f32 v86, v86
    v_exp_f32 v87, v87
    v_exp_f32 v88, v88
    v_exp_f32 v89, v89
    v_exp_f32 v90, v90
    v_exp_f32 v91, v91
    v_exp_f32 v92, v92
    v_exp_f32 v93, v93
    v_exp_f32 v94, v94
    v_exp_f32 v95, v95
    v_add_f32 v80, 1.0, v80
    v_add_f32 v81, 1.0, v81
    v_add_f32 v82, 1.0, v82
    v_add_f32 v83, 1.0, v83
    v_add_f32 v84, 1.0, v84
    v_add_f32 v85, 1.0, v85
    v_add_f32 v86, 1.0, v86
    v_add_f32 v87, 1.0, v87
    v_add_f32 v88, 1.0, v88
    v_add_f32 v89, 1.0, v89
    v_add_f32 v90, 1.0, v90
    v_add_f32 v91, 1.0, v91
    v_add_f32 v92, 1.0, v92
    v_add_f32 v93, 1.0, v93
    v_add_f32 v94, 1.0, v94
    v_add_f32 v95, 1.0, v95
    v_rcp_f32 v80, v80
    v_rcp_f32 v81, v81
    v_rcp_f32 v82, v82
    v_rcp_f32 v83, v83
    v_rcp_f32 v84, v84
    v_rcp_f32 v85, v85
    v_rcp_f32 v86, v86
    v_rcp_f32 v87, v87
    v_rcp_f32 v88, v88
    v_rcp_f32 v89, v89
    v_rcp_f32 v90, v90
    v_rcp_f32 v91, v91
    v_rcp_f32 v92, v92
    v_rcp_f32 v93, v93
    v_rcp_f32 v94, v94
    v_rcp_f32 v95, v95
    v_mul_f32 v80, v80, v64
    v_mul_f32 v81, v81, v65
    v_mul_f32 v82, v82, v66
    v_mul_f32 v83, v83, v67
    v_mul_f32 v84, v84, v68
    v_mul_f32 v85, v85, v69
    v_mul_f32 v86, v86, v70
    v_mul_f32 v87, v87, v71
    v_mul_f32 v88, v88, v72
    v_mul_f32 v89, v89, v73
    v_mul_f32 v90, v90, v74
    v_mul_f32 v91, v91, v75
    v_mul_f32 v92, v92, v76
    v_mul_f32 v93, v93, v77
    v_mul_f32 v94, v94, v78
    v_mul_f32 v95, v95, v79
    v_cvt_pk_bf16_f32 v32, v80, v81
    v_cvt_pk_bf16_f32 v33, v82, v83
    v_cvt_pk_bf16_f32 v34, v84, v85
    v_cvt_pk_bf16_f32 v35, v86, v87
    v_cvt_pk_bf16_f32 v36, v88, v89
    v_cvt_pk_bf16_f32 v37, v90, v91
    v_cvt_pk_bf16_f32 v38, v92, v93
    v_cvt_pk_bf16_f32 v39, v94, v95
    v_cvt_pk_bf16_f32 v40, v112, v113
    v_cvt_pk_bf16_f32 v41, v114, v115
    v_cvt_pk_bf16_f32 v42, v120, v121
    v_cvt_pk_bf16_f32 v43, v122, v123
    v_cvt_pk_bf16_f32 v44, v116, v117
    v_cvt_pk_bf16_f32 v45, v118, v119
    v_cvt_pk_bf16_f32 v46, v124, v125
    v_cvt_pk_bf16_f32 v47, v126, v127
    v_lshlrev_b32 v64, 16, v40
    v_and_b32 v65, 0xffff0000, v40
    v_lshlrev_b32 v66, 16, v41
    v_and_b32 v67, 0xffff0000, v41
    v_lshlrev_b32 v68, 16, v42
    v_and_b32 v69, 0xffff0000, v42
    v_lshlrev_b32 v70, 16, v43
    v_and_b32 v71, 0xffff0000, v43
    v_lshlrev_b32 v72, 16, v44
    v_and_b32 v73, 0xffff0000, v44
    v_lshlrev_b32 v74, 16, v45
    v_and_b32 v75, 0xffff0000, v45
    v_lshlrev_b32 v76, 16, v46
    v_and_b32 v77, 0xffff0000, v46
    v_lshlrev_b32 v78, 16, v47
    v_and_b32 v79, 0xffff0000, v47
    v_add_f32 v64, v64, v24
    v_add_f32 v65, v65, v25
    v_add_f32 v66, v66, v26
    v_add_f32 v67, v67, v27
    v_add_f32 v68, v68, v28
    v_add_f32 v69, v69, v29
    v_add_f32 v70, v70, v30
    v_add_f32 v71, v71, v31
    v_add_f32 v72, v72, v24
    v_add_f32 v73, v73, v25
    v_add_f32 v74, v74, v26
    v_add_f32 v75, v75, v27
    v_add_f32 v76, v76, v28
    v_add_f32 v77, v77, v29
    v_add_f32 v78, v78, v30
    v_add_f32 v79, v79, v31
    v_cvt_pk_bf16_f32 v40, v64, v65
    v_cvt_pk_bf16_f32 v41, v66, v67
    v_cvt_pk_bf16_f32 v42, v68, v69
    v_cvt_pk_bf16_f32 v43, v70, v71
    v_cvt_pk_bf16_f32 v44, v72, v73
    v_cvt_pk_bf16_f32 v45, v74, v75
    v_cvt_pk_bf16_f32 v46, v76, v77
    v_cvt_pk_bf16_f32 v47, v78, v79
    v_lshlrev_b32 v64, 16, v40
    v_and_b32 v65, 0xffff0000, v40
    v_lshlrev_b32 v66, 16, v41
    v_and_b32 v67, 0xffff0000, v41
    v_lshlrev_b32 v68, 16, v42
    v_and_b32 v69, 0xffff0000, v42
    v_lshlrev_b32 v70, 16, v43
    v_and_b32 v71, 0xffff0000, v43
    v_lshlrev_b32 v72, 16, v44
    v_and_b32 v73, 0xffff0000, v44
    v_lshlrev_b32 v74, 16, v45
    v_and_b32 v75, 0xffff0000, v45
    v_lshlrev_b32 v76, 16, v46
    v_and_b32 v77, 0xffff0000, v46
    v_lshlrev_b32 v78, 16, v47
    v_and_b32 v79, 0xffff0000, v47
    v_mul_f32 v80, s92, v64
    v_mul_f32 v81, s92, v65
    v_mul_f32 v82, s92, v66
    v_mul_f32 v83, s92, v67
    v_mul_f32 v84, s92, v68
    v_mul_f32 v85, s92, v69
    v_mul_f32 v86, s92, v70
    v_mul_f32 v87, s92, v71
    v_mul_f32 v88, s92, v72
    v_mul_f32 v89, s92, v73
    v_mul_f32 v90, s92, v74
    v_mul_f32 v91, s92, v75
    v_mul_f32 v92, s92, v76
    v_mul_f32 v93, s92, v77
    v_mul_f32 v94, s92, v78
    v_mul_f32 v95, s92, v79
    v_exp_f32 v80, v80
    v_exp_f32 v81, v81
    v_exp_f32 v82, v82
    v_exp_f32 v83, v83
    v_exp_f32 v84, v84
    v_exp_f32 v85, v85
    v_exp_f32 v86, v86
    v_exp_f32 v87, v87
    v_exp_f32 v88, v88
    v_exp_f32 v89, v89
    v_exp_f32 v90, v90
    v_exp_f32 v91, v91
    v_exp_f32 v92, v92
    v_exp_f32 v93, v93
    v_exp_f32 v94, v94
    v_exp_f32 v95, v95
    v_add_f32 v80, 1.0, v80
    v_add_f32 v81, 1.0, v81
    v_add_f32 v82, 1.0, v82
    v_add_f32 v83, 1.0, v83
    v_add_f32 v84, 1.0, v84
    v_add_f32 v85, 1.0, v85
    v_add_f32 v86, 1.0, v86
    v_add_f32 v87, 1.0, v87
    v_add_f32 v88, 1.0, v88
    v_add_f32 v89, 1.0, v89
    v_add_f32 v90, 1.0, v90
    v_add_f32 v91, 1.0, v91
    v_add_f32 v92, 1.0, v92
    v_add_f32 v93, 1.0, v93
    v_add_f32 v94, 1.0, v94
    v_add_f32 v95, 1.0, v95
    v_rcp_f32 v80, v80
    v_rcp_f32 v81, v81
    v_rcp_f32 v82, v82
    v_rcp_f32 v83, v83
    v_rcp_f32 v84, v84
    v_rcp_f32 v85, v85
    v_rcp_f32 v86, v86
    v_rcp_f32 v87, v87
    v_rcp_f32 v88, v88
    v_rcp_f32 v89, v89
    v_rcp_f32 v90, v90
    v_rcp_f32 v91, v91
    v_rcp_f32 v92, v92
    v_rcp_f32 v93, v93
    v_rcp_f32 v94, v94
    v_rcp_f32 v95, v95
    v_mul_f32 v80, v80, v64
    v_mul_f32 v81, v81, v65
    v_mul_f32 v82, v82, v66
    v_mul_f32 v83, v83, v67
    v_mul_f32 v84, v84, v68
    v_mul_f32 v85, v85, v69
    v_mul_f32 v86, v86, v70
    v_mul_f32 v87, v87, v71
    v_mul_f32 v88, v88, v72
    v_mul_f32 v89, v89, v73
    v_mul_f32 v90, v90, v74
    v_mul_f32 v91, v91, v75
    v_mul_f32 v92, v92, v76
    v_mul_f32 v93, v93, v77
    v_mul_f32 v94, v94, v78
    v_mul_f32 v95, v95, v79
    v_cvt_pk_bf16_f32 v40, v80, v81
    v_cvt_pk_bf16_f32 v41, v82, v83
    v_cvt_pk_bf16_f32 v42, v84, v85
    v_cvt_pk_bf16_f32 v43, v86, v87
    v_cvt_pk_bf16_f32 v44, v88, v89
    v_cvt_pk_bf16_f32 v45, v90, v91
    v_cvt_pk_bf16_f32 v46, v92, v93
    v_cvt_pk_bf16_f32 v47, v94, v95
    s_nop 1
    v_permlane16_swap_b32 v32, v34
    v_permlane16_swap_b32 v33, v35
    v_permlane16_swap_b32 v36, v38
    v_permlane16_swap_b32 v37, v39
    v_permlane16_swap_b32 v40, v42
    v_permlane16_swap_b32 v41, v43
    v_permlane16_swap_b32 v44, v46
    v_permlane16_swap_b32 v45, v47
kf_final:
    s_cmp_lg_u32 s55, 0
    s_cbranch_scc1 kf_combine2
    s_cmp_lg_u32 s3, 0
    s_cbranch_scc1 kf_f1
    buffer_load_dwordx2 v[8:9], v205, s[48:51], 0 offen sc1
    s_waitcnt vmcnt(0)
    v_cmp_eq_u64 vcc, s[78:79], v[8:9]
    s_nop 1
    v_cndmask_b32 v8, 0, 1, vcc
    ds_write_b32 v206, v8 offset:8
    s_waitcnt lgkmcnt(0)
kf_f1:
    s_barrier
    ds_read_b32 v8, v206 offset:8
    s_waitcnt lgkmcnt(0)
    v_readfirstlane_b32 s86, v8
    s_cmp_lg_u32 s86, 0
    s_cbranch_scc1 kf_combine1
    buffer_store_dwordx4 v[32:35], v203, s[8:11], 0 offen sc1
    buffer_store_dwordx4 v[36:39], v203, s[8:11], s61 offen sc1
    buffer_store_dwordx4 v[40:43], v203, s[8:11], s62 offen sc1
    buffer_store_dwordx4 v[44:47], v203, s[8:11], s63 offen sc1
    s_waitcnt vmcnt(0)
    s_barrier
    s_cmp_lg_u32 s3, 0
    s_cbranch_scc1 kf_f2
    v_mov_b32 v8, s78
    v_mov_b32 v9, s79
    s_mov_b64 exec, 1
    buffer_store_dwordx2 v[8:9], v204, s[48:51], 0 offen sc1
    s_mov_b64 exec, -1
    s_waitcnt vmcnt(0)
    buffer_load_dwordx2 v[8:9], v205, s[48:51], 0 offen sc1
    s_waitcnt vmcnt(0)
    v_cmp_eq_u64 vcc, s[78:79], v[8:9]
    s_nop 1
    v_cndmask_b32 v8, 0, 1, vcc
    ds_write_b32 v206, v8 offset:4
    s_waitcnt lgkmcnt(0)
kf_f2:
    s_barrier
    ds_read_b32 v8, v206 offset:4
    s_waitcnt lgkmcnt(0)
    v_readfirstlane_b32 s86, v8
    s_cmp_eq_u32 s86, 0
    s_cbranch_scc1 kf_done
kf_combine1:
    buffer_load_dwordx4 v[176:179], v203, s[44:47], 0 offen sc1
    buffer_load_dwordx4 v[180:183], v203, s[44:47], s61 offen sc1
    buffer_load_dwordx4 v[184:187], v203, s[44:47], s62 offen sc1
    buffer_load_dwordx4 v[188:191], v203, s[44:47], s63 offen sc1
kf_combine2:
    v_lshlrev_b32 v96, 16, v32
    v_and_b32 v97, 0xffff0000, v32
    v_lshlrev_b32 v98, 16, v33
    v_and_b32 v99, 0xffff0000, v33
    v_lshlrev_b32 v100, 16, v34
    v_and_b32 v101, 0xffff0000, v34
    v_lshlrev_b32 v102, 16, v35
    v_and_b32 v103, 0xffff0000, v35
    v_lshlrev_b32 v104, 16, v36
    v_and_b32 v105, 0xffff0000, v36
    v_lshlrev_b32 v106, 16, v37
    v_and_b32 v107, 0xffff0000, v37
    v_lshlrev_b32 v108, 16, v38
    v_and_b32 v109, 0xffff0000, v38
    v_lshlrev_b32 v110, 16, v39
    v_and_b32 v111, 0xffff0000, v39
    v_lshlrev_b32 v112, 16, v40
    v_and_b32 v113, 0xffff0000, v40
    v_lshlrev_b32 v114, 16, v41
    v_and_b32 v115, 0xffff0000, v41
    v_lshlrev_b32 v116, 16, v42
    v_and_b32 v117, 0xffff0000, v42
    v_lshlrev_b32 v118, 16, v43
    v_and_b32 v119, 0xffff0000, v43
    v_lshlrev_b32 v120, 16, v44
    v_and_b32 v121, 0xffff0000, v44
    v_lshlrev_b32 v122, 16, v45
    v_and_b32 v123, 0xffff0000, v45
    v_lshlrev_b32 v124, 16, v46
    v_and_b32 v125, 0xffff0000, v46
    v_lshlrev_b32 v126, 16, v47
    v_and_b32 v127, 0xffff0000, v47
    s_waitcnt vmcnt(4)
    v_lshlrev_b32 v48, 16, v160
    v_and_b32 v49, 0xffff0000, v160
    v_lshlrev_b32 v50, 16, v161
    v_and_b32 v51, 0xffff0000, v161
    v_lshlrev_b32 v52, 16, v162
    v_and_b32 v53, 0xffff0000, v162
    v_lshlrev_b32 v54, 16, v163
    v_and_b32 v55, 0xffff0000, v163
    v_lshlrev_b32 v56, 16, v164
    v_and_b32 v57, 0xffff0000, v164
    v_lshlrev_b32 v58, 16, v165
    v_and_b32 v59, 0xffff0000, v165
    v_lshlrev_b32 v60, 16, v166
    v_and_b32 v61, 0xffff0000, v166
    v_lshlrev_b32 v62, 16, v167
    v_and_b32 v63, 0xffff0000, v167
    v_lshlrev_b32 v64, 16, v168
    v_and_b32 v65, 0xffff0000, v168
    v_lshlrev_b32 v66, 16, v169
    v_and_b32 v67, 0xffff0000, v169
    v_lshlrev_b32 v68, 16, v170
    v_and_b32 v69, 0xffff0000, v170
    v_lshlrev_b32 v70, 16, v171
    v_and_b32 v71, 0xffff0000, v171
    v_lshlrev_b32 v72, 16, v172
    v_and_b32 v73, 0xffff0000, v172
    v_lshlrev_b32 v74, 16, v173
    v_and_b32 v75, 0xffff0000, v173
    v_lshlrev_b32 v76, 16, v174
    v_and_b32 v77, 0xffff0000, v174
    v_lshlrev_b32 v78, 16, v175
    v_and_b32 v79, 0xffff0000, v175
    s_waitcnt vmcnt(0)
    v_lshlrev_b32 v128, 16, v176
    v_and_b32 v129, 0xffff0000, v176
    v_lshlrev_b32 v130, 16, v177
    v_and_b32 v131, 0xffff0000, v177
    v_lshlrev_b32 v132, 16, v178
    v_and_b32 v133, 0xffff0000, v178
    v_lshlrev_b32 v134, 16, v179
    v_and_b32 v135, 0xffff0000, v179
    v_lshlrev_b32 v136, 16, v180
    v_and_b32 v137, 0xffff0000, v180
    v_lshlrev_b32 v138, 16, v181
    v_and_b32 v139, 0xffff0000, v181
    v_lshlrev_b32 v140, 16, v182
    v_and_b32 v141, 0xffff0000, v182
    v_lshlrev_b32 v142, 16, v183
    v_and_b32 v143, 0xffff0000, v183
    v_lshlrev_b32 v144, 16, v184
    v_and_b32 v145, 0xffff0000, v184
    v_lshlrev_b32 v146, 16, v185
    v_and_b32 v147, 0xffff0000, v185
    v_lshlrev_b32 v148, 16, v186
    v_and_b32 v149, 0xffff0000, v186
    v_lshlrev_b32 v150, 16, v187
    v_and_b32 v151, 0xffff0000, v187
    v_lshlrev_b32 v152, 16, v188
    v_and_b32 v153, 0xffff0000, v188
    v_lshlrev_b32 v154, 16, v189
    v_and_b32 v155, 0xffff0000, v189
    v_lshlrev_b32 v156, 16, v190
    v_and_b32 v157, 0xffff0000, v190
    v_lshlrev_b32 v158, 16, v191
    v_and_b32 v159, 0xffff0000, v191
    v_pk_mul_f32 v[96:97], v[96:97], v[128:129]
    v_pk_mul_f32 v[98:99], v[98:99], v[130:131]
    v_pk_mul_f32 v[100:101], v[100:101], v[132:133]
    v_pk_mul_f32 v[102:103], v[102:103], v[134:135]
    v_pk_mul_f32 v[104:105], v[104:105], v[136:137]
    v_pk_mul_f32 v[106:107], v[106:107], v[138:139]
    v_pk_mul_f32 v[108:109], v[108:109], v[140:141]
    v_pk_mul_f32 v[110:111], v[110:111], v[142:143]
    v_pk_mul_f32 v[112:113], v[112:113], v[144:145]
    v_pk_mul_f32 v[114:115], v[114:115], v[146:147]
    v_pk_mul_f32 v[116:117], v[116:117], v[148:149]
    v_pk_mul_f32 v[118:119], v[118:119], v[150:151]
    v_pk_mul_f32 v[120:121], v[120:121], v[152:153]
    v_pk_mul_f32 v[122:123], v[122:123], v[154:155]
    v_pk_mul_f32 v[124:125], v[124:125], v[156:157]
    v_pk_mul_f32 v[126:127], v[126:127], v[158:159]
    v_cvt_pk_bf16_f32 v32, v96, v97
    v_cvt_pk_bf16_f32 v33, v98, v99
    v_cvt_pk_bf16_f32 v34, v100, v101
    v_cvt_pk_bf16_f32 v35, v102, v103
    v_cvt_pk_bf16_f32 v36, v104, v105
    v_cvt_pk_bf16_f32 v37, v106, v107
    v_cvt_pk_bf16_f32 v38, v108, v109
    v_cvt_pk_bf16_f32 v39, v110, v111
    v_cvt_pk_bf16_f32 v40, v112, v113
    v_cvt_pk_bf16_f32 v41, v114, v115
    v_cvt_pk_bf16_f32 v42, v116, v117
    v_cvt_pk_bf16_f32 v43, v118, v119
    v_cvt_pk_bf16_f32 v44, v120, v121
    v_cvt_pk_bf16_f32 v45, v122, v123
    v_cvt_pk_bf16_f32 v46, v124, v125
    v_cvt_pk_bf16_f32 v47, v126, v127
    v_lshlrev_b32 v96, 16, v32
    v_and_b32 v97, 0xffff0000, v32
    v_lshlrev_b32 v98, 16, v33
    v_and_b32 v99, 0xffff0000, v33
    v_lshlrev_b32 v100, 16, v34
    v_and_b32 v101, 0xffff0000, v34
    v_lshlrev_b32 v102, 16, v35
    v_and_b32 v103, 0xffff0000, v35
    v_lshlrev_b32 v104, 16, v36
    v_and_b32 v105, 0xffff0000, v36
    v_lshlrev_b32 v106, 16, v37
    v_and_b32 v107, 0xffff0000, v37
    v_lshlrev_b32 v108, 16, v38
    v_and_b32 v109, 0xffff0000, v38
    v_lshlrev_b32 v110, 16, v39
    v_and_b32 v111, 0xffff0000, v39
    v_lshlrev_b32 v112, 16, v40
    v_and_b32 v113, 0xffff0000, v40
    v_lshlrev_b32 v114, 16, v41
    v_and_b32 v115, 0xffff0000, v41
    v_lshlrev_b32 v116, 16, v42
    v_and_b32 v117, 0xffff0000, v42
    v_lshlrev_b32 v118, 16, v43
    v_and_b32 v119, 0xffff0000, v43
    v_lshlrev_b32 v120, 16, v44
    v_and_b32 v121, 0xffff0000, v44
    v_lshlrev_b32 v122, 16, v45
    v_and_b32 v123, 0xffff0000, v45
    v_lshlrev_b32 v124, 16, v46
    v_and_b32 v125, 0xffff0000, v46
    v_lshlrev_b32 v126, 16, v47
    v_and_b32 v127, 0xffff0000, v47
    v_pk_add_f32 v[96:97], v[96:97], v[48:49]
    v_pk_add_f32 v[98:99], v[98:99], v[50:51]
    v_pk_add_f32 v[100:101], v[100:101], v[52:53]
    v_pk_add_f32 v[102:103], v[102:103], v[54:55]
    v_pk_add_f32 v[104:105], v[104:105], v[56:57]
    v_pk_add_f32 v[106:107], v[106:107], v[58:59]
    v_pk_add_f32 v[108:109], v[108:109], v[60:61]
    v_pk_add_f32 v[110:111], v[110:111], v[62:63]
    v_pk_add_f32 v[112:113], v[112:113], v[64:65]
    v_pk_add_f32 v[114:115], v[114:115], v[66:67]
    v_pk_add_f32 v[116:117], v[116:117], v[68:69]
    v_pk_add_f32 v[118:119], v[118:119], v[70:71]
    v_pk_add_f32 v[120:121], v[120:121], v[72:73]
    v_pk_add_f32 v[122:123], v[122:123], v[74:75]
    v_pk_add_f32 v[124:125], v[124:125], v[76:77]
    v_pk_add_f32 v[126:127], v[126:127], v[78:79]
    v_cvt_pk_bf16_f32 v32, v96, v97
    v_cvt_pk_bf16_f32 v33, v98, v99
    v_cvt_pk_bf16_f32 v34, v100, v101
    v_cvt_pk_bf16_f32 v35, v102, v103
    v_cvt_pk_bf16_f32 v36, v104, v105
    v_cvt_pk_bf16_f32 v37, v106, v107
    v_cvt_pk_bf16_f32 v38, v108, v109
    v_cvt_pk_bf16_f32 v39, v110, v111
    v_cvt_pk_bf16_f32 v40, v112, v113
    v_cvt_pk_bf16_f32 v41, v114, v115
    v_cvt_pk_bf16_f32 v42, v116, v117
    v_cvt_pk_bf16_f32 v43, v118, v119
    v_cvt_pk_bf16_f32 v44, v120, v121
    v_cvt_pk_bf16_f32 v45, v122, v123
    v_cvt_pk_bf16_f32 v46, v124, v125
    v_cvt_pk_bf16_f32 v47, v126, v127
    buffer_store_dwordx4 v[32:35], v202, s[64:67], 0 offen
    buffer_store_dwordx4 v[36:39], v202, s[64:67], s57 offen
    buffer_store_dwordx4 v[40:43], v202, s[64:67], s58 offen
    buffer_store_dwordx4 v[44:47], v202, s[64:67], s59 offen
kf_done:
kf_end:
    s_endpgm
kf_codeend:
.section .rodata,"a"
.p2align 6
.amdhsa_kernel kf_kernel
  .amdhsa_next_free_vgpr 256
  .amdhsa_next_free_sgpr 102
  .amdhsa_accum_offset 224
  .amdhsa_group_segment_fixed_size 0
  .amdhsa_kernarg_size 104
  .amdhsa_user_sgpr_count 2
  .amdhsa_user_sgpr_kernarg_segment_ptr 1
  .amdhsa_system_sgpr_workgroup_id_x 1
.end_amdhsa_kernel
```
